```python
import torch

def _softmax(x, axis=-1):
    return torch.softmax(x, dim=axis)
def _gelu(x):
    return torch.nn.functional.gelu(x, approximate="tanh")
def _silu(x):
    return torch.nn.functional.silu(x)
def _sigmoid(x):
    return torch.sigmoid(x)
def _layernorm(x, axis=-1, eps=1e-5):
    m = x.mean(dim=axis, keepdim=True)
    v = x.var(dim=axis, keepdim=True, unbiased=False)
    return (x - m) / torch.sqrt(v + eps)
def _scatter_add(tgt, idx, src, axis=0):
    return tgt.clone().index_add_(axis, idx, src)
def _segment_sum(src, seg, n):
    out = torch.zeros((n,) + src.shape[1:], dtype=src.dtype)
    return out.index_add_(0, seg, src)
def _pad(x, pw):
    flat = tuple(v for pair in reversed(pw) for v in pair)
    return torch.nn.functional.pad(x, flat)

kernel_name = 'interleave_layers__gqa_block_cached__gqa_block_cached__decode'

def setup_inputs():

    _w = (lambda a: (lambda t: t.to(torch.bfloat16) if t.is_floating_point() else t)(torch.as_tensor(a)))
    def _A_setup():
        B, Sq, D = 8, 1, 512
        Hq, Hkv, Sk, Dh = 32, 8, 4096, 128
        assert Hq % Hkv == 0, (Hq, Hkv)
        return {
            "x": _w((lambda *s: torch.randn(*s, dtype=torch.bfloat16) * 0.1)(B, Sq, D)),
            "k_cache": _w((lambda *s: torch.randn(*s, dtype=torch.bfloat16) * 0.8)(B, Hkv, Sk, Dh)),
            "v_cache": _w((lambda *s: torch.randn(*s, dtype=torch.bfloat16) * 3.2)(B, Hkv, Sk, Dh)),
            "wq": _w((lambda *s: torch.randn(*s, dtype=torch.bfloat16) * 0.8)(D, Hq * Dh) * (D ** -0.5)),
            "wo": _w((lambda *s: torch.randn(*s, dtype=torch.bfloat16) * 3.2)(Hq * Dh, D) * ((Hq * Dh) ** -0.5)),
        }
    _A_in = _A_setup()

    def _B_setup():
        B, Sq, D = 8, 1, 512
        Hq, Hkv, Sk, Dh = 32, 8, 4096, 128
        assert Hq % Hkv == 0, (Hq, Hkv)
        return {
            "x": _w((lambda *s: torch.randn(*s, dtype=torch.bfloat16) * 0.1)(B, Sq, D)),
            "k_cache": _w((lambda *s: torch.randn(*s, dtype=torch.bfloat16) * 1.6)(B, Hkv, Sk, Dh)),
            "v_cache": _w((lambda *s: torch.randn(*s, dtype=torch.bfloat16) * 1.6)(B, Hkv, Sk, Dh)),
            "wq": _w((lambda *s: torch.randn(*s, dtype=torch.bfloat16) * 1.6)(D, Hq * Dh) * (D ** -0.5)),
            "wo": _w((lambda *s: torch.randn(*s, dtype=torch.bfloat16) * 1.6)(Hq * Dh, D) * ((Hq * Dh) ** -0.5)),
        }
    _B_in = _B_setup()

    return {
        "A_x": _A_in["x"],
        "A_k_cache": _A_in["k_cache"],
        "A_v_cache": _A_in["v_cache"],
        "A_wq": _A_in["wq"],
        "A_wo": _A_in["wo"],
        "B_x": _B_in["x"],
        "B_k_cache": _B_in["k_cache"],
        "B_v_cache": _B_in["v_cache"],
        "B_wq": _B_in["wq"],
        "B_wo": _B_in["wo"],
    }

def reference(A_x, A_k_cache, A_v_cache, A_wq, A_wo, B_x, B_k_cache, B_v_cache, B_wq, B_wo):
    def _A_ref(x, k_cache, v_cache, wq, wo):
        B, Sq, D = x.shape
        Hq, Dh = 32, 128
        Hkv = k_cache.shape[1]
        rep = Hq // Hkv
        q = (lambda x, *d: x.permute(*d))((x @ wq).reshape(B, Sq, Hq, Dh), 0, 2, 1, 3)
        k = (lambda x, n, axis: torch.repeat_interleave(x, n, dim=axis))(k_cache, rep, axis=1)
        v = (lambda x, n, axis: torch.repeat_interleave(x, n, dim=axis))(v_cache, rep, axis=1)
        scores = torch.einsum("bhqd,bhkd->bhqk", q, k) * (Dh ** -0.5)
        p = _softmax(scores, axis=-1)
        o = torch.einsum("bhqk,bhkd->bhqd", p, v)
        return (lambda x, *d: x.permute(*d))(o, 0, 2, 1, 3).reshape(B, Sq, Hq * Dh) @ wo

    def _B_ref(x, k_cache, v_cache, wq, wo):
        B, Sq, D = x.shape
        Hq, Dh = 32, 128
        Hkv = k_cache.shape[1]
        rep = Hq // Hkv
        q = (lambda x, *d: x.permute(*d))((x @ wq).reshape(B, Sq, Hq, Dh), 0, 2, 1, 3)
        k = (lambda x, n, axis: torch.repeat_interleave(x, n, dim=axis))(k_cache, rep, axis=1)
        v = (lambda x, n, axis: torch.repeat_interleave(x, n, dim=axis))(v_cache, rep, axis=1)
        scores = torch.einsum("bhqd,bhkd->bhqk", q, k) * (Dh ** -0.5)
        p = _softmax(scores, axis=-1)
        o = torch.einsum("bhqk,bhkd->bhqd", p, v)
        return (lambda x, *d: x.permute(*d))(o, 0, 2, 1, 3).reshape(B, Sq, Hq * Dh) @ wo

    x = A_x
    x = x + _A_ref(_layernorm(x, axis=-1), A_k_cache, A_v_cache, A_wq, A_wo)
    x = x + _B_ref(_layernorm(x, axis=-1), B_k_cache, B_v_cache, B_wq, B_wo)
    x = x + _A_ref(_layernorm(x, axis=-1), A_k_cache, A_v_cache, A_wq, A_wo)
    x = x + _B_ref(_layernorm(x, axis=-1), B_k_cache, B_v_cache, B_wq, B_wo)
    return x
```

```asm
; @launch grid=(256,1,1) block=(256,1,1) lds=163840
.amdgcn_target "amdgcn-amd-amdhsa--gfx950"
.text
.globl interleave_layers__gqa_block_cached__gqa_block_cached__decode_kernel
.p2align 8
.type interleave_layers__gqa_block_cached__gqa_block_cached__decode_kernel,@function
interleave_layers__gqa_block_cached__gqa_block_cached__decode_kernel:
    s_cmp_ge_u32 s2, 256
    s_cbranch_scc1 L_end
    s_load_dwordx4 s[8:11], s[0:1], 8
    s_load_dwordx4 s[28:31], s[0:1], 24
    s_load_dwordx2 s[44:45], s[0:1], 0
    s_load_dwordx2 s[24:25], s[0:1], 96
    s_load_dwordx4 s[16:19], s[0:1], 48
    s_load_dwordx4 s[36:39], s[0:1], 64
    s_load_dwordx2 s[84:85], s[0:1], 88
    v_lshrrev_b32 v1, 6, v0
    v_and_b32 v0, 63, v0
    v_readfirstlane_b32 s3, v1
    s_getreg_b32 s4, hwreg(HW_REG_XCC_ID, 0, 4)
    s_and_b32 s4, s4, 7
    s_lshr_b32 s5, s2, 3
    s_mul_i32 s69, s4, s4
    s_lshl_b32 s70, s4, 6
    s_lshl_b32 s69, s69, 14
    s_add_u32 s61, s70, s69
    s_add_u32 s61, s61, 1
    s_mov_b32 s99, 0
    v_lshlrev_b32 v2, 4, v0
    v_bfe_u32 v1, v0, 2, 2
    v_lshlrev_b32 v1, 8, v1
    v_lshrrev_b32 v7, 4, v0
    v_lshl_add_u32 v1, v7, 6, v1
    v_and_b32 v7, 3, v0
    v_lshl_add_u32 v1, v7, 4, v1
    s_mul_i32 s77, s3, 37888
    s_add_u32 s77, s77, 12288
    v_add_u32 v3, s77, v2
    s_sub_u32 s77, s77, 4096
    s_getpc_b64 s[94:95]
L_pc:
L_role:
    s_lshr_b32 s6, s5, 2
    s_and_b32 s7, s5, 3
    s_lshl_b32 s73, s6, 23
    s_lshl_b32 s68, s4, 20
    s_add_u32 s73, s73, s68
    s_lshl_b32 s68, s7, 18
    s_add_u32 s73, s73, s68
    s_lshl_b32 s68, s3, 12
    s_add_u32 s73, s73, s68
    s_mov_b32 s86, 256
    s_mov_b32 s87, 0x20000
    s_waitcnt lgkmcnt(0)
    s_add_u32 s12, s10, s73
    s_addc_u32 s13, s11, 0
    s_add_u32 s8, s8, s73
    s_addc_u32 s9, s9, 0
    s_mov_b32 s10, 0x3d000
    s_mov_b32 s11, 0x20000
    s_mov_b32 s14, 0x3d000
    s_mov_b32 s15, 0x20000
    s_mov_b32 s48, 0
    s_add_u32 m0, s77, 4096
    s_nop 0
    buffer_load_dwordx4 v1, s[8:11], s48 offen offset:0 nt lds
    s_add_u32 m0, s77, 4096
    s_nop 0
    buffer_load_dwordx4 v1, s[8:11], s48 offen offset:1024 nt lds
    s_add_u32 m0, s77, 4096
    s_nop 0
    buffer_load_dwordx4 v1, s[8:11], s48 offen offset:2048 nt lds
    s_add_u32 m0, s77, 4096
    s_nop 0
    buffer_load_dwordx4 v1, s[8:11], s48 offen offset:3072 nt lds
    s_mov_b32 s48, 16384
    s_add_u32 m0, s77, 8192
    s_nop 0
    buffer_load_dwordx4 v1, s[8:11], s48 offen offset:0 nt lds
    s_add_u32 m0, s77, 8192
    s_nop 0
    buffer_load_dwordx4 v1, s[8:11], s48 offen offset:1024 nt lds
    s_add_u32 m0, s77, 8192
    s_nop 0
    buffer_load_dwordx4 v1, s[8:11], s48 offen offset:2048 nt lds
    s_add_u32 m0, s77, 8192
    s_nop 0
    buffer_load_dwordx4 v1, s[8:11], s48 offen offset:3072 nt lds
    v_mov_b32 v60, 0
    v_mov_b32 v61, 0
    s_or_b32 s68, s3, s99
    s_cbranch_scc1 L_cl_1
    s_lshl_b32 s68, 1, s5
    v_mov_b32 v60, s68
    s_lshl_b32 s68, s4, 5
    s_mov_b64 exec, 1
    buffer_atomic_or v60, v61, s[84:87], s68 offen offset:4 sc0
    s_mov_b64 exec, -1
L_cl_1:
    s_add_u32 s20, s18, s73
    s_addc_u32 s21, s19, 0
    s_add_u32 s16, s16, s73
    s_addc_u32 s17, s17, 0
    s_mov_b32 s18, 0x3d000
    s_mov_b32 s19, 0x20000
    s_mov_b32 s22, 0x3d000
    s_mov_b32 s23, 0x20000
    s_mov_b32 s32, s30
    s_mov_b32 s33, s31
    s_mov_b32 s30, 0x400000
    s_mov_b32 s31, 0x20000
    s_mov_b32 s34, 0x400000
    s_mov_b32 s35, 0x20000
    s_mov_b32 s40, s38
    s_mov_b32 s41, s39
    s_mov_b32 s38, 0x400000
    s_mov_b32 s39, 0x20000
    s_mov_b32 s42, 0x400000
    s_mov_b32 s43, 0x20000
    s_mov_b32 s26, 16777216
    s_mov_b32 s27, 0x20000
    s_mov_b32 s46, 8192
    s_mov_b32 s47, 0x20000
    s_mov_b32 s74, 0x05040100
    s_mov_b32 s75, 0x07060302
    s_mov_b32 s76, 0x3e0293ee
    s_lshl_b32 s78, s6, 19
    s_lshl_b32 s68, s4, 10
    s_add_u32 s78, s78, s68
    s_lshl_b32 s68, s7, 8
    s_add_u32 s78, s78, s68
    s_lshl_b32 s68, s3, 6
    s_add_u32 s78, s78, s68
    v_mov_b32 v7, 0
    s_mov_b64 exec, 1
    s_lshl_b32 s69, s4, 19
    buffer_load_dword v4, v7, s[12:15], 0 offen nt
    buffer_load_dword v4, v7, s[16:19], 0 offen nt
    buffer_load_dword v4, v7, s[20:23], 0 offen nt
    buffer_load_dword v4, v7, s[32:35], s69 offen nt
    buffer_load_dword v4, v7, s[40:43], s69 offen nt
    s_mov_b64 exec, -1
    v_bfe_u32 v53, v0, 2, 1
    v_lshlrev_b32 v53, 10, v53
    v_bfe_u32 v7, v0, 3, 2
    v_lshl_add_u32 v53, v7, 5, v53
    v_and_b32 v7, 3, v0
    v_lshl_add_u32 v53, v7, 3, v53
    s_lshl_b32 s69, s3, 11
    s_lshl_b32 s68, s6, 7
    s_add_u32 s69, s69, s68
    buffer_load_dwordx2 v[64:65], v53, s[44:47], s69 offen
    v_lshrrev_b32 v7, 4, v0
    v_lshlrev_b32 v7, 16, v7
    v_and_b32 v52, 15, v0
    v_lshl_add_u32 v7, v52, 2, v7
    s_add_u32 s68, s78, 0
    buffer_load_dword v28, v7, s[28:31], s68 offen
    s_add_u32 s68, s78, 8192
    buffer_load_dword v32, v7, s[28:31], s68 offen
    s_add_u32 s68, s78, 16384
    buffer_load_dword v29, v7, s[28:31], s68 offen
    s_add_u32 s68, s78, 24576
    buffer_load_dword v33, v7, s[28:31], s68 offen
    s_add_u32 s68, s78, 32768
    buffer_load_dword v30, v7, s[28:31], s68 offen
    s_add_u32 s68, s78, 40960
    buffer_load_dword v34, v7, s[28:31], s68 offen
    s_add_u32 s68, s78, 49152
    buffer_load_dword v31, v7, s[28:31], s68 offen
    s_add_u32 s68, s78, 57344
    buffer_load_dword v35, v7, s[28:31], s68 offen
    s_add_u32 s68, s78, 262144
    buffer_load_dword v36, v7, s[28:31], s68 offen
    s_add_u32 s68, s78, 270336
    buffer_load_dword v40, v7, s[28:31], s68 offen
    s_add_u32 s68, s78, 278528
    buffer_load_dword v37, v7, s[28:31], s68 offen
    s_add_u32 s68, s78, 286720
    buffer_load_dword v41, v7, s[28:31], s68 offen
    s_add_u32 s68, s78, 294912
    buffer_load_dword v38, v7, s[28:31], s68 offen
    s_add_u32 s68, s78, 303104
    buffer_load_dword v42, v7, s[28:31], s68 offen
    s_add_u32 s68, s78, 311296
    buffer_load_dword v39, v7, s[28:31], s68 offen
    s_add_u32 s68, s78, 319488
    buffer_load_dword v43, v7, s[28:31], s68 offen
    s_mov_b32 s48, 32768
    s_add_u32 m0, s77, 12288
    s_nop 0
    buffer_load_dwordx4 v1, s[8:11], s48 offen offset:0 nt lds
    s_add_u32 m0, s77, 12288
    s_nop 0
    buffer_load_dwordx4 v1, s[8:11], s48 offen offset:1024 nt lds
    s_add_u32 m0, s77, 12288
    s_nop 0
    buffer_load_dwordx4 v1, s[8:11], s48 offen offset:2048 nt lds
    s_add_u32 m0, s77, 12288
    s_nop 0
    buffer_load_dwordx4 v1, s[8:11], s48 offen offset:3072 nt lds
    s_waitcnt vmcnt(32)
    s_mov_b32 s48, 49152
    s_add_u32 m0, s77, 16384
    s_nop 0
    buffer_load_dwordx4 v1, s[8:11], s48 offen offset:0 nt lds
    s_add_u32 m0, s77, 16384
    s_nop 0
    buffer_load_dwordx4 v1, s[8:11], s48 offen offset:1024 nt lds
    v_lshrrev_b32 v7, 4, v0
    v_lshlrev_b32 v7, 16, v7
    v_and_b32 v52, 15, v0
    v_lshl_add_u32 v7, v52, 2, v7
    s_add_u32 s68, s78, 0
    buffer_load_dword v240, v7, s[36:39], s68 offen
    s_add_u32 s68, s78, 8192
    buffer_load_dword v244, v7, s[36:39], s68 offen
    s_add_u32 s68, s78, 16384
    buffer_load_dword v241, v7, s[36:39], s68 offen
    s_add_u32 s68, s78, 24576
    buffer_load_dword v245, v7, s[36:39], s68 offen
    s_add_u32 s68, s78, 32768
    buffer_load_dword v242, v7, s[36:39], s68 offen
    s_add_u32 s68, s78, 40960
    buffer_load_dword v246, v7, s[36:39], s68 offen
    s_add_u32 s68, s78, 49152
    buffer_load_dword v243, v7, s[36:39], s68 offen
    s_add_u32 s68, s78, 57344
    buffer_load_dword v247, v7, s[36:39], s68 offen
    s_add_u32 s68, s78, 262144
    buffer_load_dword v248, v7, s[36:39], s68 offen
    s_add_u32 s68, s78, 270336
    buffer_load_dword v252, v7, s[36:39], s68 offen
    s_add_u32 s68, s78, 278528
    buffer_load_dword v249, v7, s[36:39], s68 offen
    s_add_u32 s68, s78, 286720
    buffer_load_dword v253, v7, s[36:39], s68 offen
    s_add_u32 s68, s78, 294912
    buffer_load_dword v250, v7, s[36:39], s68 offen
    s_add_u32 s68, s78, 303104
    buffer_load_dword v254, v7, s[36:39], s68 offen
    s_add_u32 s68, s78, 311296
    buffer_load_dword v251, v7, s[36:39], s68 offen
    s_add_u32 s68, s78, 319488
    buffer_load_dword v255, v7, s[36:39], s68 offen
    s_waitcnt vmcnt(48)
    s_add_u32 m0, s77, 16384
    s_nop 0
    buffer_load_dwordx4 v1, s[8:11], s48 offen offset:2048 nt lds
    s_add_u32 m0, s77, 16384
    s_nop 0
    buffer_load_dwordx4 v1, s[8:11], s48 offen offset:3072 nt lds
    s_waitcnt vmcnt(48)
    s_mov_b32 s48, 65536
    s_add_u32 m0, s77, 20480
    s_nop 0
    buffer_load_dwordx4 v1, s[8:11], s48 offen offset:0 nt lds
    s_add_u32 m0, s77, 20480
    s_nop 0
    buffer_load_dwordx4 v1, s[8:11], s48 offen offset:1024 nt lds
    s_waitcnt vmcnt(48)
    s_add_u32 m0, s77, 20480
    s_nop 0
    buffer_load_dwordx4 v1, s[8:11], s48 offen offset:2048 nt lds
    s_add_u32 m0, s77, 20480
    s_nop 0
    buffer_load_dwordx4 v1, s[8:11], s48 offen offset:3072 nt lds
    s_lshl_b32 s68, s2, 2
    s_add_u32 s68, s68, s3
    s_mul_i32 s68, s68, 1408
    v_mov_b32 v12, -1
    v_mov_b32 v13, -1
    v_mov_b32 v14, -1
    v_mov_b32 v15, -1
    buffer_store_dwordx4 v[12:15], v2, s[24:27], s68 offen sc1
    s_mov_b64 exec, 0xffffff
    buffer_store_dwordx4 v[12:15], v2, s[24:27], s68 offen offset:1024 sc1
    s_mov_b64 exec, -1
    s_waitcnt vmcnt(28)
    s_mov_b32 s48, 81920
    s_add_u32 m0, s77, 24576
    s_nop 0
    buffer_load_dwordx4 v1, s[8:11], s48 offen offset:0 nt lds
    s_add_u32 m0, s77, 24576
    s_nop 0
    buffer_load_dwordx4 v1, s[8:11], s48 offen offset:1024 nt lds
    s_waitcnt vmcnt(28)
    s_add_u32 m0, s77, 24576
    s_nop 0
    buffer_load_dwordx4 v1, s[8:11], s48 offen offset:2048 nt lds
    s_add_u32 m0, s77, 24576
    s_nop 0
    buffer_load_dwordx4 v1, s[8:11], s48 offen offset:3072 nt lds
    s_waitcnt vmcnt(28)
    s_mov_b32 s48, 98304
    s_add_u32 m0, s77, 28672
    s_nop 0
    buffer_load_dwordx4 v1, s[8:11], s48 offen offset:0 nt lds
    s_add_u32 m0, s77, 28672
    s_nop 0
    buffer_load_dwordx4 v1, s[8:11], s48 offen offset:1024 nt lds
    s_lshl_b32 s79, s4, 19
    s_lshl_b32 s68, s3, 17
    s_add_u32 s79, s79, s68
    s_lshl_b32 s68, s5, 5
    s_add_u32 s79, s79, s68
    s_lshr_b32 s69, s7, 1
    s_xor_b32 s70, s69, 1
    s_and_b32 s71, s7, 1
    s_lshl_b32 s50, s4, 15
    s_lshl_b32 s68, s3, 13
    s_add_u32 s50, s50, s68
    s_lshl_b32 s68, s70, 12
    s_add_u32 s50, s50, s68
    s_lshl_b32 s51, s4, 15
    s_lshl_b32 s68, s3, 13
    s_add_u32 s51, s51, s68
    s_lshl_b32 s68, s69, 12
    s_add_u32 s51, s51, s68
    s_lshl_b32 s49, s71, 7
    s_lshl_b32 s68, s6, 4
    s_add_u32 s49, s49, s68
    s_add_u32 s49, s49, s51
    s_lshl_b32 s52, s4, 12
    s_lshl_b32 s68, s3, 3
    s_add_u32 s52, s52, s68
    s_lshl_b32 s53, s4, 12
    s_lshl_b32 s68, s7, 10
    s_add_u32 s53, s53, s68
    s_lshl_b32 s68, s6, 7
    s_add_u32 s53, s53, s68
    s_lshl_b32 s54, s6, 14
    s_lshl_b32 s68, s4, 11
    s_add_u32 s54, s54, s68
    s_lshl_b32 s68, s7, 9
    s_add_u32 s54, s54, s68
    s_lshl_b32 s55, s6, 14
    s_lshl_b32 s68, s3, 7
    s_add_u32 s55, s55, s68
    s_lshl_b32 s71, s4, 5
    s_lshl_b32 s68, s7, 3
    s_add_u32 s71, s71, s68
    s_lshl_b32 s68, s6, 0
    s_add_u32 s71, s71, s68
    s_mul_i32 s69, s71, 4608
    s_add_u32 s69, s69, 2097152
    s_lshl_b32 s56, s3, 7
    s_add_u32 s56, s56, s69
    s_add_u32 s57, s56, 4096
    s_lshl_b32 s73, s71, 9
    s_lshl_b32 s68, s3, 7
    s_add_u32 s73, s73, s68
    s_add_u32 s73, s73, 6553600
    s_lshl_b32 s69, s4, 2
    s_lshl_b32 s68, s3, 0
    s_add_u32 s69, s69, s68
    s_mul_i32 s69, s69, 36864
    s_add_u32 s69, s69, 2097152
    s_lshl_b32 s58, s6, 9
    s_add_u32 s58, s58, s69
    s_lshr_b32 s70, s6, 1
    s_and_b32 s71, s6, 1
    s_lshl_b32 s59, s70, 7
    s_lshl_b32 s68, s71, 6
    s_add_u32 s59, s59, s68
    s_add_u32 s59, s59, 4096
    s_add_u32 s59, s59, s69
    s_cmp_lg_u32 s3, 0
    s_cbranch_scc1 L_vd_2
    v_readfirstlane_b32 s68, v60
    s_mov_b32 s69, -1
    s_lshr_b32 s68, s68, s5
    s_bitcmp1_b32 s68, 0
    s_cbranch_scc1 L_ovf
L_ovf_done:
    v_mov_b32 v60, s69
    ds_write_b32 v61, v60 offset:10368
L_vd_2:
    s_waitcnt lgkmcnt(0)
    s_barrier
    ds_read_b32 v60, v61 offset:10368
    s_waitcnt lgkmcnt(0)
    v_readfirstlane_b32 s68, v60
    s_nop 0
    s_cmp_lg_u32 s68, -1
    s_cbranch_scc1 L_restart
    v_perm_b32 v7, v32, v28, s74
    v_perm_b32 v32, v32, v28, s75
    v_accvgpr_write_b32 a224, v7
    v_accvgpr_write_b32 a228, v32
    v_perm_b32 v7, v33, v29, s74
    v_perm_b32 v33, v33, v29, s75
    v_accvgpr_write_b32 a225, v7
    v_accvgpr_write_b32 a229, v33
    v_perm_b32 v7, v34, v30, s74
    v_perm_b32 v34, v34, v30, s75
    v_accvgpr_write_b32 a226, v7
    v_accvgpr_write_b32 a230, v34
    v_perm_b32 v7, v35, v31, s74
    v_perm_b32 v35, v35, v31, s75
    v_accvgpr_write_b32 a227, v7
    v_accvgpr_write_b32 a231, v35
    v_perm_b32 v7, v40, v36, s74
    v_perm_b32 v40, v40, v36, s75
    v_accvgpr_write_b32 a232, v7
    v_accvgpr_write_b32 a236, v40
    v_perm_b32 v7, v41, v37, s74
    v_perm_b32 v41, v41, v37, s75
    v_accvgpr_write_b32 a233, v7
    v_accvgpr_write_b32 a237, v41
    v_perm_b32 v7, v42, v38, s74
    v_perm_b32 v42, v42, v38, s75
    v_accvgpr_write_b32 a234, v7
    v_accvgpr_write_b32 a238, v42
    v_perm_b32 v7, v43, v39, s74
    v_perm_b32 v43, v43, v39, s75
    v_accvgpr_write_b32 a235, v7
    v_accvgpr_write_b32 a239, v43
    s_mov_b32 s78, 1
    s_mov_b32 s83, 2
    v_bfe_u32 v5, v0, 2, 1
    v_mul_u32_u24 v5, 144, v5
    v_bfe_u32 v7, v0, 3, 2
    v_lshl_add_u32 v5, v7, 5, v5
    v_and_b32 v7, 3, v0
    v_lshl_add_u32 v5, v7, 3, v5
    s_mul_i32 s72, s3, 288
    v_add_u32 v5, s72, v5
    v_and_b32 v54, 7, v0
    v_mul_u32_u24 v6, 144, v54
    v_and_b32 v7, 48, v0
    v_add_u32 v6, v7, v6
    v_lshl_add_u32 v54, v54, 9, v7
    v_and_b32 v7, 8, v0
    v_lshl_add_u32 v54, v7, 3, v54
    v_mov_b32 v8, 0x3f803f80
    v_mov_b32 v9, 0x3f803f80
    v_mov_b32 v10, 0x3f803f80
    v_mov_b32 v11, 0x3f803f80
    s_nop 1
    v_mfma_f32_16x16x32_bf16 v[20:23], a[224:227], v[8:11], 0
    v_mfma_f32_16x16x32_bf16 v[24:27], a[228:231], v[8:11], 0
    v_mfma_f32_16x16x32_bf16 v[20:23], a[232:235], v[8:11], v[20:23]
    v_mfma_f32_16x16x32_bf16 v[24:27], a[236:239], v[8:11], v[24:27]
    s_nop 7
    v_mov_b32_dpp v20, v24 row_shr:8 row_mask:0xf bank_mask:0xc
    v_mov_b32_dpp v21, v25 row_shr:8 row_mask:0xf bank_mask:0xc
    v_mov_b32_dpp v22, v26 row_shr:8 row_mask:0xf bank_mask:0xc
    v_mov_b32_dpp v23, v27 row_shr:8 row_mask:0xf bank_mask:0xc
    v_and_or_b32 v20, v20, -4, s83
    v_and_or_b32 v21, v21, -4, s83
    v_and_or_b32 v22, v22, -4, s83
    v_and_or_b32 v23, v23, -4, s83
    s_add_u32 s68, s73, 0
    s_mov_b32 exec_lo, 0x01010101
    s_mov_b32 exec_hi, 0x01010101
    buffer_store_dwordx4 v[20:23], v54, s[24:27], s68 offen sc1
    s_mov_b64 exec, -1
    s_waitcnt vmcnt(13)
    s_add_u32 m0, s77, 28672
    s_nop 0
    buffer_load_dwordx4 v1, s[8:11], s48 offen offset:2048 nt lds
    s_add_u32 m0, s77, 28672
    s_nop 0
    buffer_load_dwordx4 v1, s[8:11], s48 offen offset:3072 nt lds
    s_waitcnt vmcnt(13)
    s_mov_b32 s48, 114688
    s_add_u32 m0, s77, 32768
    s_nop 0
    buffer_load_dwordx4 v1, s[8:11], s48 offen offset:0 nt lds
    s_add_u32 m0, s77, 32768
    s_nop 0
    buffer_load_dwordx4 v1, s[8:11], s48 offen offset:1024 nt lds
    v_perm_b32 v7, v244, v240, s74
    v_perm_b32 v244, v244, v240, s75
    v_accvgpr_write_b32 a240, v7
    v_accvgpr_write_b32 a244, v244
    v_perm_b32 v7, v245, v241, s74
    v_perm_b32 v245, v245, v241, s75
    v_accvgpr_write_b32 a241, v7
    v_accvgpr_write_b32 a245, v245
    v_perm_b32 v7, v246, v242, s74
    v_perm_b32 v246, v246, v242, s75
    v_accvgpr_write_b32 a242, v7
    v_accvgpr_write_b32 a246, v246
    v_perm_b32 v7, v247, v243, s74
    v_perm_b32 v247, v247, v243, s75
    v_accvgpr_write_b32 a243, v7
    v_accvgpr_write_b32 a247, v247
    v_perm_b32 v7, v252, v248, s74
    v_perm_b32 v252, v252, v248, s75
    v_accvgpr_write_b32 a248, v7
    v_accvgpr_write_b32 a252, v252
    v_perm_b32 v7, v253, v249, s74
    v_perm_b32 v253, v253, v249, s75
    v_accvgpr_write_b32 a249, v7
    v_accvgpr_write_b32 a253, v253
    v_perm_b32 v7, v254, v250, s74
    v_perm_b32 v254, v254, v250, s75
    v_accvgpr_write_b32 a250, v7
    v_accvgpr_write_b32 a254, v254
    v_perm_b32 v7, v255, v251, s74
    v_perm_b32 v255, v255, v251, s75
    v_accvgpr_write_b32 a251, v7
    v_accvgpr_write_b32 a255, v255
    v_mfma_f32_16x16x32_bf16 v[20:23], a[240:243], v[8:11], 0
    v_mfma_f32_16x16x32_bf16 v[24:27], a[244:247], v[8:11], 0
    v_mfma_f32_16x16x32_bf16 v[20:23], a[248:251], v[8:11], v[20:23]
    v_mfma_f32_16x16x32_bf16 v[24:27], a[252:255], v[8:11], v[24:27]
    s_nop 7
    v_mov_b32_dpp v20, v24 row_shr:8 row_mask:0xf bank_mask:0xc
    v_mov_b32_dpp v21, v25 row_shr:8 row_mask:0xf bank_mask:0xc
    v_mov_b32_dpp v22, v26 row_shr:8 row_mask:0xf bank_mask:0xc
    v_mov_b32_dpp v23, v27 row_shr:8 row_mask:0xf bank_mask:0xc
    v_and_or_b32 v20, v20, -4, s83
    v_and_or_b32 v21, v21, -4, s83
    v_and_or_b32 v22, v22, -4, s83
    v_and_or_b32 v23, v23, -4, s83
    s_add_u32 s68, s73, 131072
    s_mov_b32 exec_lo, 0x01010101
    s_mov_b32 exec_hi, 0x01010101
    buffer_store_dwordx4 v[20:23], v54, s[24:27], s68 offen sc1
    s_mov_b64 exec, -1
    s_waitcnt vmcnt(14)
    s_add_u32 m0, s77, 32768
    s_nop 0
    buffer_load_dwordx4 v1, s[8:11], s48 offen offset:2048 nt lds
    s_add_u32 m0, s77, 32768
    s_nop 0
    buffer_load_dwordx4 v1, s[8:11], s48 offen offset:3072 nt lds
    s_waitcnt vmcnt(12)
    s_mov_b32 s48, 131072
    s_add_u32 m0, s77, 36864
    s_nop 0
    buffer_load_dwordx4 v1, s[8:11], s48 offen offset:0 nt lds
    s_add_u32 m0, s77, 36864
    s_nop 0
    buffer_load_dwordx4 v1, s[8:11], s48 offen offset:1024 nt lds
    s_mov_b32 s64, 8
    s_mov_b32 s99, 0
    s_call_b64 s[86:87], S_w2
    v_lshrrev_b32 v7, 1, v0
    v_lshlrev_b32 v7, 10, v7
    v_and_b32 v52, 1, v0
    v_lshl_add_u32 v7, v52, 4, v7
    s_add_u32 s68, s79, 0
    s_lshl_b32 m0, s3, 11
    s_nop 0
    buffer_load_dwordx4 v7, s[32:35], s68 offen  lds
    s_add_u32 s68, s79, 32768
    s_lshl_b32 m0, s3, 11
    s_add_u32 m0, m0, 1024
    s_nop 0
    buffer_load_dwordx4 v7, s[32:35], s68 offen  lds
    s_waitcnt vmcnt(16)
    s_mov_b32 s48, 131072
    s_add_u32 m0, s77, 36864
    s_nop 0
    buffer_load_dwordx4 v1, s[8:11], s48 offen offset:2048 nt lds
    s_add_u32 m0, s77, 36864
    s_nop 0
    buffer_load_dwordx4 v1, s[8:11], s48 offen offset:3072 nt lds
    s_waitcnt vmcnt(16)
    s_mov_b32 s48, 147456
    s_add_u32 m0, s77, 40960
    s_nop 0
    buffer_load_dwordx4 v1, s[8:11], s48 offen offset:0 nt lds
    buffer_load_dwordx4 a[0:3], v1, s[8:11], s48 offen offset:1024 nt
    s_waitcnt vmcnt(15)
    buffer_load_dwordx4 a[4:7], v1, s[8:11], s48 offen offset:2048 nt
    buffer_load_dwordx4 a[8:11], v1, s[8:11], s48 offen offset:3072 nt
    s_waitcnt vmcnt(15)
    s_mov_b32 s48, 163840
    buffer_load_dwordx4 a[12:15], v1, s[8:11], s48 offen offset:0 nt
    buffer_load_dwordx4 a[16:19], v1, s[8:11], s48 offen offset:1024 nt
    s_waitcnt vmcnt(14)
    buffer_load_dwordx4 a[20:23], v1, s[8:11], s48 offen offset:2048 nt
    buffer_load_dwordx4 a[24:27], v1, s[8:11], s48 offen offset:3072 nt
    s_waitcnt vmcnt(12)
    s_barrier
    s_load_dwordx2 s[44:45], s[0:1], 88
    s_waitcnt lgkmcnt(0)
    s_mov_b32 s46, 256
    s_cmp_lg_u32 s3, 0
    s_cbranch_scc1 L_skip_3
    s_lshl_b32 s68, s4, 5
    v_mov_b32 v52, s61
    v_mov_b32 v53, 0
    s_mov_b64 exec, 1
    buffer_atomic_add v52, v53, s[44:47], s68 offen
    s_mov_b64 exec, -1
L_skip_3:
    s_mov_b32 s48, 180224
    buffer_load_dwordx4 a[28:31], v1, s[8:11], s48 offen offset:0 nt
    buffer_load_dwordx4 a[32:35], v1, s[8:11], s48 offen offset:1024 nt
    s_waitcnt vmcnt(10)
    buffer_load_dwordx4 a[36:39], v1, s[8:11], s48 offen offset:2048 nt
    buffer_load_dwordx4 a[40:43], v1, s[8:11], s48 offen offset:3072 nt
    s_waitcnt vmcnt(10)
    s_mov_b32 s48, 196608
    buffer_load_dwordx4 a[44:47], v1, s[8:11], s48 offen offset:0 nt
    buffer_load_dwordx4 a[48:51], v1, s[8:11], s48 offen offset:1024 nt
    s_waitcnt vmcnt(10)
    buffer_load_dwordx4 a[52:55], v1, s[8:11], s48 offen offset:2048 nt
    buffer_load_dwordx4 a[56:59], v1, s[8:11], s48 offen offset:3072 nt
    s_waitcnt vmcnt(10)
    s_mov_b32 s48, 212992
    buffer_load_dwordx4 a[60:63], v1, s[8:11], s48 offen offset:0 nt
    buffer_load_dwordx4 a[64:67], v1, s[8:11], s48 offen offset:1024 nt
    v_lshrrev_b32 v7, 4, v0
    v_lshlrev_b32 v7, 8, v7
    v_and_b32 v52, 15, v0
    v_lshl_add_u32 v7, v52, 3, v7
    s_lshl_b32 s68, s3, 11
    v_add_u32 v7, s68, v7
    ds_read_b64_tr_b16 a[192:193], v7 offset:0
    ds_read_b64_tr_b16 a[194:195], v7 offset:128
    ds_read_b64_tr_b16 a[196:197], v7 offset:1024
    ds_read_b64_tr_b16 a[198:199], v7 offset:1152
    s_waitcnt lgkmcnt(0)
    v_lshrrev_b32 v7, 1, v0
    v_lshlrev_b32 v7, 10, v7
    v_and_b32 v52, 1, v0
    v_lshl_add_u32 v7, v52, 4, v7
    s_add_u32 s68, s79, 65536
    s_lshl_b32 m0, s3, 11
    s_nop 0
    buffer_load_dwordx4 v7, s[32:35], s68 offen  lds
    s_add_u32 s68, s79, 98304
    s_lshl_b32 m0, s3, 11
    s_add_u32 m0, m0, 1024
    s_nop 0
    buffer_load_dwordx4 v7, s[32:35], s68 offen  lds
    s_waitcnt vmcnt(12)
    buffer_load_dwordx4 a[68:71], v1, s[8:11], s48 offen offset:2048 nt
    buffer_load_dwordx4 a[72:75], v1, s[8:11], s48 offen offset:3072 nt
    s_waitcnt vmcnt(12)
    s_mov_b32 s48, 229376
    buffer_load_dwordx4 a[76:79], v1, s[8:11], s48 offen offset:0 nt
    buffer_load_dwordx4 a[80:83], v1, s[8:11], s48 offen offset:1024 nt
    s_waitcnt vmcnt(12)
    buffer_load_dwordx4 a[84:87], v1, s[8:11], s48 offen offset:2048 nt
    buffer_load_dwordx4 a[88:91], v1, s[8:11], s48 offen offset:3072 nt
    s_waitcnt vmcnt(12)
    s_mov_b32 s48, 245760
    buffer_load_dwordx4 a[92:95], v1, s[8:11], s48 offen offset:0 nt
    buffer_load_dwordx4 a[96:99], v1, s[8:11], s48 offen offset:1024 nt
    s_waitcnt vmcnt(12)
    buffer_load_dwordx4 a[100:103], v1, s[8:11], s48 offen offset:2048 nt
    buffer_load_dwordx4 a[104:107], v1, s[8:11], s48 offen offset:3072 nt
    v_lshrrev_b32 v7, 4, v0
    v_lshlrev_b32 v7, 8, v7
    v_and_b32 v52, 15, v0
    v_lshl_add_u32 v7, v52, 3, v7
    s_lshl_b32 s68, s3, 11
    v_add_u32 v7, s68, v7
    s_waitcnt vmcnt(10)
    ds_read_b64_tr_b16 a[200:201], v7 offset:0
    ds_read_b64_tr_b16 a[202:203], v7 offset:128
    ds_read_b64_tr_b16 a[204:205], v7 offset:1024
    ds_read_b64_tr_b16 a[206:207], v7 offset:1152
    s_waitcnt lgkmcnt(0)
    v_and_b32 v56, 7, v0
    v_lshlrev_b32 v56, 5, v56
    v_mov_b32 v55, 32
    s_mov_b64 exec, 0xff
    buffer_load_dword v55, v56, s[44:47], 0 offen sc1
    s_mov_b64 exec, -1
    s_mov_b32 s48, 0
    buffer_load_dwordx4 v[68:71], v2, s[12:15], s48 offen offset:0
    buffer_load_dwordx4 v[72:75], v2, s[12:15], s48 offen offset:1024
    s_waitcnt vmcnt(11)
    buffer_load_dwordx4 v[76:79], v2, s[12:15], s48 offen offset:2048
    buffer_load_dwordx4 v[80:83], v2, s[12:15], s48 offen offset:3072
    s_waitcnt vmcnt(11)
    s_mov_b32 s48, 16384
    buffer_load_dwordx4 v[84:87], v2, s[12:15], s48 offen offset:0
    buffer_load_dwordx4 v[88:91], v2, s[12:15], s48 offen offset:1024
    s_waitcnt vmcnt(11)
    buffer_load_dwordx4 v[92:95], v2, s[12:15], s48 offen offset:2048
    buffer_load_dwordx4 v[96:99], v2, s[12:15], s48 offen offset:3072
    s_waitcnt vmcnt(11)
    s_mov_b32 s48, 32768
    buffer_load_dwordx4 v[100:103], v2, s[12:15], s48 offen offset:0
    buffer_load_dwordx4 v[104:107], v2, s[12:15], s48 offen offset:1024
    s_waitcnt vmcnt(10)
    s_mov_b32 s98, 0
    s_mov_b32 s65, 0
    s_mov_b32 s81, 10
    s_mov_b32 s100, 8
    s_mov_b32 s101, -2
    s_mov_b32 s5, -2
    s_mov_b32 s80, -2
    s_add_u32 s88, s94, NB_bar_0-L_pc
    s_addc_u32 s89, s95, 0
L_retry_4:
    v_and_b32 v7, 63, v55
    v_cmp_gt_u32 vcc, 32, v7
    s_nop 0
    s_cbranch_vccz L_ok_5
    s_mov_b64 exec, 0xff
    buffer_load_dword v55, v56, s[44:47], 0 offen sc1
    s_mov_b64 exec, -1
    s_mov_b32 s96, 0
    s_cmp_ge_i32 s100, 0
    s_cbranch_scc1 L_w0_6
    s_waitcnt vmcnt(0)
    s_branch L_w2_8
L_w0_6:
    s_getreg_b32 s97, hwreg(HW_REG_IB_STS)
    s_bfe_u32 s66, s97, 0x20016
    s_and_b32 s97, s97, 15
    s_lshl_b32 s66, s66, 4
    s_or_b32 s97, s97, s66
    s_cmp_le_u32 s97, s96
    s_cbranch_scc1 L_w1_7
    s_sub_i32 s97, s97, 1
    s_max_i32 s97, s97, s96
    s_cmp_gt_i32 s97, s100
    s_cbranch_scc1 L_w0_6
    s_swappc_b64 s[90:91], s[88:89]
    s_branch L_w0_6
L_w1_7:
    s_lshl_b32 s66, s96, 3
    s_add_u32 s66, s66, WT-L_pc
    s_add_u32 s92, s94, s66
    s_addc_u32 s93, s95, 0
    s_swappc_b64 s[90:91], s[92:93]
L_w2_8:
    s_add_u32 s98, s98, 1
    s_cmp_lt_u32 s98, 1000000
    s_cbranch_scc1 L_retry_4
    s_branch L_abort
L_ok_5:
    v_readlane_b32 s68, v55, s4
    s_lshl_b32 s69, s61, 5
    s_nop 1
    s_cmp_eq_u32 s68, s69
    s_cselect_b32 s99, 1, 0
    v_lshrrev_b32 v9, 5, v0
    v_mul_u32_u24 v9, 512, v9
    v_and_b32 v7, 31, v0
    v_lshl_add_u32 v9, v7, 4, v9
    v_and_b32 v10, 7, v0
    v_mul_u32_u24 v10, 4608, v10
    s_lshl_b32 s69, s4, 14
    s_lshl_b32 s68, s3, 12
    s_add_u32 s69, s69, s68
    s_add_u32 s69, s69, 6553600
    s_add_u32 s72, s69, 0
    buffer_load_dwordx4 v[28:31], v9, s[24:27], s72 offen sc1
    s_add_u32 s72, s69, 1024
    buffer_load_dwordx4 v[32:35], v9, s[24:27], s72 offen sc1
    s_add_u32 s72, s69, 2048
    buffer_load_dwordx4 v[36:39], v9, s[24:27], s72 offen sc1
    s_add_u32 s72, s69, 3072
    buffer_load_dwordx4 v[40:43], v9, s[24:27], s72 offen sc1
    s_add_u32 s72, s69, 131072
    buffer_load_dwordx4 v[44:47], v9, s[24:27], s72 offen sc1
    s_add_u32 s72, s69, 132096
    buffer_load_dwordx4 v[48:51], v9, s[24:27], s72 offen sc1
    s_add_u32 s72, s69, 133120
    buffer_load_dwordx4 v[52:55], v9, s[24:27], s72 offen sc1
    s_add_u32 s72, s69, 134144
    buffer_load_dwordx4 v[56:59], v9, s[24:27], s72 offen sc1
    s_mov_b32 s96, 0
L_flush_9:
    s_cmp_ge_u32 s65, s81
    s_cbranch_scc1 L_flushed_10
    s_swappc_b64 s[90:91], s[88:89]
    s_branch L_flush_9
L_flushed_10:
    s_lshl_b32 s66, s96, 3
    s_add_u32 s66, s66, WT-L_pc
    s_add_u32 s92, s94, s66
    s_addc_u32 s93, s95, 0
    s_swappc_b64 s[90:91], s[92:93]
    v_pk_add_f32 v[28:29], v[28:29], v[32:33]
    v_pk_add_f32 v[30:31], v[30:31], v[34:35]
    v_pk_add_f32 v[36:37], v[36:37], v[40:41]
    v_pk_add_f32 v[38:39], v[38:39], v[42:43]
    v_pk_add_f32 v[28:29], v[28:29], v[36:37]
    v_pk_add_f32 v[30:31], v[30:31], v[38:39]
    v_mov_b32 v12, v28
    v_mov_b32 v13, v29
    v_mov_b32 v14, v30
    v_mov_b32 v15, v31
    v_permlane32_swap_b32 v28, v12
    v_permlane32_swap_b32 v29, v13
    v_permlane32_swap_b32 v30, v14
    v_permlane32_swap_b32 v31, v15
    v_pk_add_f32 v[28:29], v[28:29], v[12:13]
    v_pk_add_f32 v[30:31], v[30:31], v[14:15]
    v_mov_b32 v60, v28
    v_mov_b32 v61, v29
    v_mov_b32 v62, v30
    v_mov_b32 v63, v31
    s_mov_b64 exec, -1
    v_pk_add_f32 v[44:45], v[44:45], v[48:49]
    v_pk_add_f32 v[46:47], v[46:47], v[50:51]
    v_pk_add_f32 v[52:53], v[52:53], v[56:57]
    v_pk_add_f32 v[54:55], v[54:55], v[58:59]
    v_pk_add_f32 v[44:45], v[44:45], v[52:53]
    v_pk_add_f32 v[46:47], v[46:47], v[54:55]
    v_mov_b32 v12, v44
    v_mov_b32 v13, v45
    v_mov_b32 v14, v46
    v_mov_b32 v15, v47
    v_permlane32_swap_b32 v44, v12
    v_permlane32_swap_b32 v45, v13
    v_permlane32_swap_b32 v46, v14
    v_permlane32_swap_b32 v47, v15
    v_pk_add_f32 v[44:45], v[44:45], v[12:13]
    v_pk_add_f32 v[46:47], v[46:47], v[14:15]
    s_mov_b32 exec_lo, 0
    v_mov_b32 v60, v44
    v_mov_b32 v61, v45
    v_mov_b32 v62, v46
    v_mov_b32 v63, v47
    s_mov_b64 exec, -1
    v_lshrrev_b32 v9, 5, v0
    v_mul_u32_u24 v9, 4608, v9
    v_and_b32 v7, 31, v0
    v_lshl_add_u32 v9, v7, 4, v9
    v_and_b32 v10, 7, v0
    v_mul_u32_u24 v10, 4608, v10
    v_bfe_u32 v52, v0, 3, 2
    v_lshlrev_b32 v52, 6, v52
    v_and_b32 v7, 3, v0
    v_lshl_add_u32 v52, v7, 4, v52
    v_lshlrev_b32 v53, 8, v7
    v_bfe_u32 v7, v0, 2, 1
    v_lshl_add_u32 v52, v7, 1, v52
    s_lshl_b32 s72, s3, 8
    v_add_u32 v52, s72, v52
    v_lshrrev_b32 v7, 2, v0
    v_lshl_add_u32 v53, v7, 4, v53
    s_mov_b64 exec, 0xff
    buffer_load_dwordx2 v[12:13], v10, s[24:27], s59 offen sc1
    s_mov_b64 exec, -1
    s_add_u32 s72, s58, 0
    buffer_load_dwordx4 v[28:31], v9, s[24:27], s72 offen sc1
    s_add_u32 s72, s58, 9216
    buffer_load_dwordx4 v[32:35], v9, s[24:27], s72 offen sc1
    s_add_u32 s72, s58, 18432
    buffer_load_dwordx4 v[36:39], v9, s[24:27], s72 offen sc1
    s_add_u32 s72, s58, 27648
    buffer_load_dwordx4 v[40:43], v9, s[24:27], s72 offen sc1
    s_waitcnt vmcnt(15)
    s_mov_b32 s48, 114688
    buffer_load_dwordx4 v[188:191], v2, s[12:15], s48 offen offset:2048
    buffer_load_dwordx4 v[192:195], v2, s[12:15], s48 offen offset:3072
    s_waitcnt vmcnt(15)
    s_mov_b32 s48, 131072
    buffer_load_dwordx4 v[196:199], v2, s[12:15], s48 offen offset:0
    buffer_load_dwordx4 v[200:203], v2, s[12:15], s48 offen offset:1024
    s_waitcnt vmcnt(15)
    buffer_load_dwordx4 v[204:207], v2, s[12:15], s48 offen offset:2048
    buffer_load_dwordx4 v[208:211], v2, s[12:15], s48 offen offset:3072
    s_waitcnt vmcnt(15)
    s_mov_b32 s48, 147456
    buffer_load_dwordx4 v[212:215], v2, s[12:15], s48 offen offset:0
    buffer_load_dwordx4 v[216:219], v2, s[12:15], s48 offen offset:1024
    s_waitcnt vmcnt(15)
    buffer_load_dwordx4 v[220:223], v2, s[12:15], s48 offen offset:2048
    buffer_load_dwordx4 v[224:227], v2, s[12:15], s48 offen offset:3072
    s_waitcnt vmcnt(10)
    s_mov_b32 s65, 0
    s_mov_b32 s81, 0
    s_mov_b32 s100, 0
    s_mov_b32 s101, 0
    s_mov_b32 s5, 0
    s_mov_b32 s80, -2
    s_add_u32 s88, s94, NB_pre_0-L_pc
    s_addc_u32 s89, s95, 0
    s_mov_b32 s96, 10
    s_call_b64 s[86:87], S_q1
    ds_read_b128 v[44:47], v3 offset:0
    s_waitcnt lgkmcnt(0)
    v_mfma_f32_16x16x32_bf16 v[28:31], v[44:47], v[8:11], 0
    ds_read_b128 v[48:51], v3 offset:1024
    ds_read_b128 v[52:55], v3 offset:2048
    ds_read_b128 v[56:59], v3 offset:3072
    s_mov_b32 s48, 163840
    buffer_load_dwordx4 v[228:231], v2, s[12:15], s48 offen offset:0
    buffer_load_dwordx4 v[232:235], v2, s[12:15], s48 offen offset:1024
    s_waitcnt vmcnt(11)
    buffer_load_dwordx4 v[236:239], v2, s[12:15], s48 offen offset:2048
    s_waitcnt vmcnt(11)
    buffer_load_dwordx4 v[240:243], v2, s[12:15], s48 offen offset:3072
    s_waitcnt vmcnt(11)
    s_mov_b32 s48, 180224
    buffer_load_dwordx4 v[244:247], v2, s[12:15], s48 offen offset:0
    s_waitcnt vmcnt(11)
    buffer_load_dwordx4 v[248:251], v2, s[12:15], s48 offen offset:1024
    s_waitcnt lgkmcnt(2)
    v_mfma_f32_16x16x32_bf16 v[32:35], v[48:51], v[8:11], 0
    ds_read_b128 v[44:47], v3 offset:4096
    s_waitcnt lgkmcnt(2)
    v_mfma_f32_16x16x32_bf16 v[36:39], v[52:55], v[8:11], 0
    ds_read_b128 v[48:51], v3 offset:5120
    v_add_f32_dpp v40, v29, v28 row_ror:12 row_mask:0xf bank_mask:0xf
    v_add_f32_dpp v41, v31, v30 row_ror:12 row_mask:0xf bank_mask:0xf
    s_waitcnt lgkmcnt(2)
    v_mfma_f32_16x16x32_bf16 v[28:31], v[56:59], v[8:11], 0
    ds_read_b128 v[52:55], v3 offset:6144
    v_add_f32_dpp v12, v41, v40 row_ror:8 row_mask:0xf bank_mask:0x1
    v_add_f32_dpp v40, v33, v32 row_ror:12 row_mask:0xf bank_mask:0xf
    v_add_f32_dpp v41, v35, v34 row_ror:12 row_mask:0xf bank_mask:0xf
    s_waitcnt lgkmcnt(2)
    v_mfma_f32_16x16x32_bf16 v[32:35], v[44:47], v[8:11], 0
    ds_read_b128 v[56:59], v3 offset:7168
    v_add_f32_dpp v13, v41, v40 row_ror:8 row_mask:0xf bank_mask:0x1
    v_add_f32_dpp v40, v38, v37 row_ror:12 row_mask:0xf bank_mask:0xf
    v_add_f32_dpp v41, v36, v39 row_ror:12 row_mask:0xf bank_mask:0xf
    s_waitcnt lgkmcnt(2)
    v_mfma_f32_16x16x32_bf16 v[36:39], v[48:51], v[8:11], 0
    ds_read_b128 v[44:47], v3 offset:8192
    v_add_f32_dpp v12, v41, v40 row_ror:8 row_mask:0xf bank_mask:0x2
    v_add_f32_dpp v40, v30, v29 row_ror:12 row_mask:0xf bank_mask:0xf
    v_add_f32_dpp v41, v28, v31 row_ror:12 row_mask:0xf bank_mask:0xf
    s_waitcnt lgkmcnt(2)
    v_mfma_f32_16x16x32_bf16 v[28:31], v[52:55], v[8:11], 0
    ds_read_b128 v[48:51], v3 offset:9216
    v_add_f32_dpp v13, v41, v40 row_ror:8 row_mask:0xf bank_mask:0x2
    v_add_f32_dpp v40, v35, v34 row_ror:12 row_mask:0xf bank_mask:0xf
    v_add_f32_dpp v41, v33, v32 row_ror:12 row_mask:0xf bank_mask:0xf
    s_waitcnt lgkmcnt(2)
    v_mfma_f32_16x16x32_bf16 v[32:35], v[56:59], v[8:11], 0
    ds_read_b128 v[52:55], v3 offset:10240
    s_waitcnt vmcnt(11)
    buffer_load_dwordx4 v[252:255], v2, s[12:15], s48 offen offset:2048
    v_add_f32_dpp v12, v41, v40 row_ror:8 row_mask:0xf bank_mask:0x4
    v_add_f32_dpp v40, v39, v38 row_ror:12 row_mask:0xf bank_mask:0xf
    v_add_f32_dpp v41, v37, v36 row_ror:12 row_mask:0xf bank_mask:0xf
    s_waitcnt lgkmcnt(2)
    v_mfma_f32_16x16x32_bf16 v[36:39], v[44:47], v[8:11], 0
    ds_read_b128 v[56:59], v3 offset:11264
    v_add_f32_dpp v13, v41, v40 row_ror:8 row_mask:0xf bank_mask:0x4
    v_add_f32_dpp v40, v28, v31 row_ror:12 row_mask:0xf bank_mask:0xf
    v_add_f32_dpp v41, v30, v29 row_ror:12 row_mask:0xf bank_mask:0xf
    s_waitcnt lgkmcnt(2)
    v_mfma_f32_16x16x32_bf16 v[28:31], v[48:51], v[8:11], 0
    ds_read_b128 v[44:47], v3 offset:12288
    v_add_f32_dpp v12, v41, v40 row_ror:8 row_mask:0xf bank_mask:0x8
    v_add_f32_dpp v40, v32, v35 row_ror:12 row_mask:0xf bank_mask:0xf
    v_add_f32_dpp v41, v34, v33 row_ror:12 row_mask:0xf bank_mask:0xf
    s_waitcnt lgkmcnt(2)
    v_mfma_f32_16x16x32_bf16 v[32:35], v[52:55], v[8:11], 0
    ds_read_b128 v[48:51], v3 offset:13312
    v_add_f32_dpp v13, v41, v40 row_ror:8 row_mask:0xf bank_mask:0x8
    v_add_f32_dpp v40, v37, v36 row_ror:12 row_mask:0xf bank_mask:0xf
    v_add_f32_dpp v41, v39, v38 row_ror:12 row_mask:0xf bank_mask:0xf
    s_waitcnt lgkmcnt(2)
    v_mfma_f32_16x16x32_bf16 v[36:39], v[56:59], v[8:11], 0
    ds_read_b128 v[52:55], v3 offset:14336
    v_add_f32_dpp v14, v41, v40 row_ror:8 row_mask:0xf bank_mask:0x1
    v_add_f32_dpp v40, v29, v28 row_ror:12 row_mask:0xf bank_mask:0xf
    v_add_f32_dpp v41, v31, v30 row_ror:12 row_mask:0xf bank_mask:0xf
    s_waitcnt lgkmcnt(2)
    v_mfma_f32_16x16x32_bf16 v[28:31], v[44:47], v[8:11], 0
    ds_read_b128 v[56:59], v3 offset:15360
    v_add_f32_dpp v15, v41, v40 row_ror:8 row_mask:0xf bank_mask:0x1
    v_add_f32_dpp v40, v34, v33 row_ror:12 row_mask:0xf bank_mask:0xf
    v_add_f32_dpp v41, v32, v35 row_ror:12 row_mask:0xf bank_mask:0xf
    s_waitcnt lgkmcnt(2)
    v_mfma_f32_16x16x32_bf16 v[32:35], v[48:51], v[8:11], 0
    ds_read_b128 v[44:47], v3 offset:16384
    v_add_f32_dpp v14, v41, v40 row_ror:8 row_mask:0xf bank_mask:0x2
    v_add_f32_dpp v40, v38, v37 row_ror:12 row_mask:0xf bank_mask:0xf
    v_add_f32_dpp v41, v36, v39 row_ror:12 row_mask:0xf bank_mask:0xf
    s_waitcnt lgkmcnt(2)
    v_mfma_f32_16x16x32_bf16 v[36:39], v[52:55], v[8:11], 0
    ds_read_b128 v[48:51], v3 offset:17408
    s_waitcnt vmcnt(11)
    buffer_load_dwordx4 a[108:111], v2, s[12:15], s48 offen offset:3072
    v_add_f32_dpp v15, v41, v40 row_ror:8 row_mask:0xf bank_mask:0x2
    v_add_f32_dpp v40, v31, v30 row_ror:12 row_mask:0xf bank_mask:0xf
    v_add_f32_dpp v41, v29, v28 row_ror:12 row_mask:0xf bank_mask:0xf
    s_waitcnt lgkmcnt(2)
    v_mfma_f32_16x16x32_bf16 v[28:31], v[56:59], v[8:11], 0
    ds_read_b128 v[52:55], v3 offset:18432
    v_add_f32_dpp v14, v41, v40 row_ror:8 row_mask:0xf bank_mask:0x4
    v_add_f32_dpp v40, v35, v34 row_ror:12 row_mask:0xf bank_mask:0xf
    v_add_f32_dpp v41, v33, v32 row_ror:12 row_mask:0xf bank_mask:0xf
    s_waitcnt lgkmcnt(2)
    v_mfma_f32_16x16x32_bf16 v[32:35], v[44:47], v[8:11], 0
    ds_read_b128 v[56:59], v3 offset:19456
    v_add_f32_dpp v15, v41, v40 row_ror:8 row_mask:0xf bank_mask:0x4
    v_add_f32_dpp v40, v36, v39 row_ror:12 row_mask:0xf bank_mask:0xf
    v_add_f32_dpp v41, v38, v37 row_ror:12 row_mask:0xf bank_mask:0xf
    s_waitcnt lgkmcnt(2)
    v_mfma_f32_16x16x32_bf16 v[36:39], v[48:51], v[8:11], 0
    ds_read_b128 v[44:47], v3 offset:20480
    v_add_f32_dpp v14, v41, v40 row_ror:8 row_mask:0xf bank_mask:0x8
    v_add_f32_dpp v40, v28, v31 row_ror:12 row_mask:0xf bank_mask:0xf
    v_add_f32_dpp v41, v30, v29 row_ror:12 row_mask:0xf bank_mask:0xf
    s_waitcnt lgkmcnt(2)
    v_mfma_f32_16x16x32_bf16 v[28:31], v[52:55], v[8:11], 0
    ds_read_b128 v[48:51], v3 offset:21504
    v_add_f32_dpp v15, v41, v40 row_ror:8 row_mask:0xf bank_mask:0x8
    v_add_f32_dpp v40, v33, v32 row_ror:12 row_mask:0xf bank_mask:0xf
    v_add_f32_dpp v41, v35, v34 row_ror:12 row_mask:0xf bank_mask:0xf
    s_waitcnt lgkmcnt(2)
    v_mfma_f32_16x16x32_bf16 v[32:35], v[56:59], v[8:11], 0
    ds_read_b128 v[52:55], v3 offset:22528
    v_add_f32_dpp v16, v41, v40 row_ror:8 row_mask:0xf bank_mask:0x1
    v_add_f32_dpp v40, v37, v36 row_ror:12 row_mask:0xf bank_mask:0xf
    v_add_f32_dpp v41, v39, v38 row_ror:12 row_mask:0xf bank_mask:0xf
    s_waitcnt lgkmcnt(2)
    v_mfma_f32_16x16x32_bf16 v[36:39], v[44:47], v[8:11], 0
    ds_read_b128 v[56:59], v3 offset:23552
    v_add_f32_dpp v17, v41, v40 row_ror:8 row_mask:0xf bank_mask:0x1
    v_add_f32_dpp v40, v30, v29 row_ror:12 row_mask:0xf bank_mask:0xf
    v_add_f32_dpp v41, v28, v31 row_ror:12 row_mask:0xf bank_mask:0xf
    s_waitcnt lgkmcnt(2)
    v_mfma_f32_16x16x32_bf16 v[28:31], v[48:51], v[8:11], 0
    ds_read_b128 v[44:47], v3 offset:24576
    v_add_f32_dpp v16, v41, v40 row_ror:8 row_mask:0xf bank_mask:0x2
    v_add_f32_dpp v40, v34, v33 row_ror:12 row_mask:0xf bank_mask:0xf
    v_add_f32_dpp v41, v32, v35 row_ror:12 row_mask:0xf bank_mask:0xf
    s_waitcnt lgkmcnt(2)
    v_mfma_f32_16x16x32_bf16 v[32:35], v[52:55], v[8:11], 0
    ds_read_b128 v[48:51], v3 offset:25600
    s_waitcnt vmcnt(11)
    s_mov_b32 s48, 196608
    buffer_load_dwordx4 a[112:115], v2, s[12:15], s48 offen offset:0
    v_add_f32_dpp v17, v41, v40 row_ror:8 row_mask:0xf bank_mask:0x2
    v_add_f32_dpp v40, v39, v38 row_ror:12 row_mask:0xf bank_mask:0xf
    v_add_f32_dpp v41, v37, v36 row_ror:12 row_mask:0xf bank_mask:0xf
    s_waitcnt lgkmcnt(2)
    v_mfma_f32_16x16x32_bf16 v[36:39], v[56:59], v[8:11], 0
    ds_read_b128 v[52:55], v3 offset:26624
    v_add_f32_dpp v16, v41, v40 row_ror:8 row_mask:0xf bank_mask:0x4
    v_add_f32_dpp v40, v31, v30 row_ror:12 row_mask:0xf bank_mask:0xf
    v_add_f32_dpp v41, v29, v28 row_ror:12 row_mask:0xf bank_mask:0xf
    s_waitcnt lgkmcnt(2)
    v_mfma_f32_16x16x32_bf16 v[28:31], v[44:47], v[8:11], 0
    ds_read_b128 v[56:59], v3 offset:27648
    v_add_f32_dpp v17, v41, v40 row_ror:8 row_mask:0xf bank_mask:0x4
    v_add_f32_dpp v40, v32, v35 row_ror:12 row_mask:0xf bank_mask:0xf
    v_add_f32_dpp v41, v34, v33 row_ror:12 row_mask:0xf bank_mask:0xf
    s_waitcnt lgkmcnt(2)
    v_mfma_f32_16x16x32_bf16 v[32:35], v[48:51], v[8:11], 0
    ds_read_b128 v[44:47], v3 offset:28672
    v_add_f32_dpp v16, v41, v40 row_ror:8 row_mask:0xf bank_mask:0x8
    v_add_f32_dpp v40, v36, v39 row_ror:12 row_mask:0xf bank_mask:0xf
    v_add_f32_dpp v41, v38, v37 row_ror:12 row_mask:0xf bank_mask:0xf
    s_waitcnt lgkmcnt(2)
    v_mfma_f32_16x16x32_bf16 v[36:39], v[52:55], v[8:11], 0
    ds_read_b128 v[48:51], v3 offset:29696
    v_add_f32_dpp v17, v41, v40 row_ror:8 row_mask:0xf bank_mask:0x8
    v_add_f32_dpp v40, v29, v28 row_ror:12 row_mask:0xf bank_mask:0xf
    v_add_f32_dpp v41, v31, v30 row_ror:12 row_mask:0xf bank_mask:0xf
    s_waitcnt lgkmcnt(2)
    v_mfma_f32_16x16x32_bf16 v[28:31], v[56:59], v[8:11], 0
    ds_read_b128 v[52:55], v3 offset:30720
    v_add_f32_dpp v18, v41, v40 row_ror:8 row_mask:0xf bank_mask:0x1
    v_add_f32_dpp v40, v33, v32 row_ror:12 row_mask:0xf bank_mask:0xf
    v_add_f32_dpp v41, v35, v34 row_ror:12 row_mask:0xf bank_mask:0xf
    s_waitcnt lgkmcnt(2)
    v_mfma_f32_16x16x32_bf16 v[32:35], v[44:47], v[8:11], 0
    ds_read_b128 v[56:59], v3 offset:31744
    v_add_f32_dpp v19, v41, v40 row_ror:8 row_mask:0xf bank_mask:0x1
    v_add_f32_dpp v40, v38, v37 row_ror:12 row_mask:0xf bank_mask:0xf
    v_add_f32_dpp v41, v36, v39 row_ror:12 row_mask:0xf bank_mask:0xf
    s_waitcnt lgkmcnt(2)
    v_mfma_f32_16x16x32_bf16 v[36:39], v[48:51], v[8:11], 0
    ds_read_b128 v[44:47], v3 offset:32768
    s_waitcnt vmcnt(11)
    buffer_load_dwordx4 a[116:119], v2, s[12:15], s48 offen offset:1024
    v_add_f32_dpp v18, v41, v40 row_ror:8 row_mask:0xf bank_mask:0x2
    v_add_f32_dpp v40, v30, v29 row_ror:12 row_mask:0xf bank_mask:0xf
    v_add_f32_dpp v41, v28, v31 row_ror:12 row_mask:0xf bank_mask:0xf
    s_waitcnt lgkmcnt(2)
    v_mfma_f32_16x16x32_bf16 v[28:31], v[52:55], v[8:11], 0
    ds_read_b128 v[48:51], v3 offset:33792
    v_add_f32_dpp v19, v41, v40 row_ror:8 row_mask:0xf bank_mask:0x2
    v_add_f32_dpp v40, v35, v34 row_ror:12 row_mask:0xf bank_mask:0xf
    v_add_f32_dpp v41, v33, v32 row_ror:12 row_mask:0xf bank_mask:0xf
    s_waitcnt lgkmcnt(2)
    v_mfma_f32_16x16x32_bf16 v[32:35], v[56:59], v[8:11], 0
    ds_read_b128 v[52:55], v3 offset:34816
    v_add_f32_dpp v18, v41, v40 row_ror:8 row_mask:0xf bank_mask:0x4
    v_add_f32_dpp v40, v39, v38 row_ror:12 row_mask:0xf bank_mask:0xf
    v_add_f32_dpp v41, v37, v36 row_ror:12 row_mask:0xf bank_mask:0xf
    s_waitcnt lgkmcnt(2)
    v_mfma_f32_16x16x32_bf16 v[36:39], v[44:47], v[8:11], 0
    ds_read_b128 v[56:59], v3 offset:35840
    v_add_f32_dpp v19, v41, v40 row_ror:8 row_mask:0xf bank_mask:0x4
    v_add_f32_dpp v40, v28, v31 row_ror:12 row_mask:0xf bank_mask:0xf
    v_add_f32_dpp v41, v30, v29 row_ror:12 row_mask:0xf bank_mask:0xf
    s_waitcnt lgkmcnt(2)
    v_mfma_f32_16x16x32_bf16 v[28:31], v[48:51], v[8:11], 0
    ds_read_b128 v[44:47], v3 offset:36864
    v_add_f32_dpp v18, v41, v40 row_ror:8 row_mask:0xf bank_mask:0x8
    v_add_f32_dpp v40, v32, v35 row_ror:12 row_mask:0xf bank_mask:0xf
    v_add_f32_dpp v41, v34, v33 row_ror:12 row_mask:0xf bank_mask:0xf
    s_waitcnt lgkmcnt(2)
    v_mfma_f32_16x16x32_bf16 v[32:35], v[52:55], v[8:11], 0
    v_add_f32_dpp v19, v41, v40 row_ror:8 row_mask:0xf bank_mask:0x8
    v_add_f32_dpp v40, v37, v36 row_ror:12 row_mask:0xf bank_mask:0xf
    v_add_f32_dpp v41, v39, v38 row_ror:12 row_mask:0xf bank_mask:0xf
    s_waitcnt lgkmcnt(1)
    v_mfma_f32_16x16x32_bf16 v[36:39], v[56:59], v[8:11], 0
    v_add_f32_dpp v20, v41, v40 row_ror:8 row_mask:0xf bank_mask:0x1
    v_add_f32_dpp v40, v29, v28 row_ror:12 row_mask:0xf bank_mask:0xf
    v_add_f32_dpp v41, v31, v30 row_ror:12 row_mask:0xf bank_mask:0xf
    s_waitcnt lgkmcnt(0)
    v_mfma_f32_16x16x32_bf16 v[28:31], v[44:47], v[8:11], 0
    v_add_f32_dpp v21, v41, v40 row_ror:8 row_mask:0xf bank_mask:0x1
    v_add_f32_dpp v40, v34, v33 row_ror:12 row_mask:0xf bank_mask:0xf
    v_add_f32_dpp v41, v32, v35 row_ror:12 row_mask:0xf bank_mask:0xf
    v_mfma_f32_16x16x32_bf16 v[32:35], a[0:3], v[8:11], 0
    s_nop 0
    v_add_f32_dpp v20, v41, v40 row_ror:8 row_mask:0xf bank_mask:0x2
    v_add_f32_dpp v40, v38, v37 row_ror:12 row_mask:0xf bank_mask:0xf
    v_add_f32_dpp v41, v36, v39 row_ror:12 row_mask:0xf bank_mask:0xf
    v_mfma_f32_16x16x32_bf16 v[36:39], a[4:7], v[8:11], 0
    s_waitcnt vmcnt(11)
    buffer_load_dwordx4 a[120:123], v2, s[12:15], s48 offen offset:2048
    v_add_f32_dpp v21, v41, v40 row_ror:8 row_mask:0xf bank_mask:0x2
    v_add_f32_dpp v40, v31, v30 row_ror:12 row_mask:0xf bank_mask:0xf
    v_add_f32_dpp v41, v29, v28 row_ror:12 row_mask:0xf bank_mask:0xf
    v_mfma_f32_16x16x32_bf16 v[28:31], a[8:11], v[8:11], 0
    s_nop 0
    v_add_f32_dpp v20, v41, v40 row_ror:8 row_mask:0xf bank_mask:0x4
    v_add_f32_dpp v40, v35, v34 row_ror:12 row_mask:0xf bank_mask:0xf
    v_add_f32_dpp v41, v33, v32 row_ror:12 row_mask:0xf bank_mask:0xf
    v_mfma_f32_16x16x32_bf16 v[32:35], a[12:15], v[8:11], 0
    s_nop 0
    v_add_f32_dpp v21, v41, v40 row_ror:8 row_mask:0xf bank_mask:0x4
    v_add_f32_dpp v40, v36, v39 row_ror:12 row_mask:0xf bank_mask:0xf
    v_add_f32_dpp v41, v38, v37 row_ror:12 row_mask:0xf bank_mask:0xf
    v_mfma_f32_16x16x32_bf16 v[36:39], a[16:19], v[8:11], 0
    s_nop 0
    v_add_f32_dpp v20, v41, v40 row_ror:8 row_mask:0xf bank_mask:0x8
    v_add_f32_dpp v40, v28, v31 row_ror:12 row_mask:0xf bank_mask:0xf
    v_add_f32_dpp v41, v30, v29 row_ror:12 row_mask:0xf bank_mask:0xf
    v_mfma_f32_16x16x32_bf16 v[28:31], a[20:23], v[8:11], 0
    s_nop 0
    v_add_f32_dpp v21, v41, v40 row_ror:8 row_mask:0xf bank_mask:0x8
    v_add_f32_dpp v40, v33, v32 row_ror:12 row_mask:0xf bank_mask:0xf
    v_add_f32_dpp v41, v35, v34 row_ror:12 row_mask:0xf bank_mask:0xf
    v_mfma_f32_16x16x32_bf16 v[32:35], a[24:27], v[8:11], 0
    s_nop 0
    v_add_f32_dpp v22, v41, v40 row_ror:8 row_mask:0xf bank_mask:0x1
    v_add_f32_dpp v40, v37, v36 row_ror:12 row_mask:0xf bank_mask:0xf
    v_add_f32_dpp v41, v39, v38 row_ror:12 row_mask:0xf bank_mask:0xf
    v_mfma_f32_16x16x32_bf16 v[36:39], a[28:31], v[8:11], 0
    s_nop 0
    v_add_f32_dpp v23, v41, v40 row_ror:8 row_mask:0xf bank_mask:0x1
    v_add_f32_dpp v40, v30, v29 row_ror:12 row_mask:0xf bank_mask:0xf
    v_add_f32_dpp v41, v28, v31 row_ror:12 row_mask:0xf bank_mask:0xf
    v_mfma_f32_16x16x32_bf16 v[28:31], a[32:35], v[8:11], 0
    s_nop 0
    v_add_f32_dpp v22, v41, v40 row_ror:8 row_mask:0xf bank_mask:0x2
    v_add_f32_dpp v40, v34, v33 row_ror:12 row_mask:0xf bank_mask:0xf
    v_add_f32_dpp v41, v32, v35 row_ror:12 row_mask:0xf bank_mask:0xf
    v_mfma_f32_16x16x32_bf16 v[32:35], a[36:39], v[8:11], 0
    s_nop 0
    v_add_f32_dpp v23, v41, v40 row_ror:8 row_mask:0xf bank_mask:0x2
    v_add_f32_dpp v40, v39, v38 row_ror:12 row_mask:0xf bank_mask:0xf
    v_add_f32_dpp v41, v37, v36 row_ror:12 row_mask:0xf bank_mask:0xf
    v_mfma_f32_16x16x32_bf16 v[36:39], a[40:43], v[8:11], 0
    s_nop 0
    v_add_f32_dpp v22, v41, v40 row_ror:8 row_mask:0xf bank_mask:0x4
    v_add_f32_dpp v40, v31, v30 row_ror:12 row_mask:0xf bank_mask:0xf
    v_add_f32_dpp v41, v29, v28 row_ror:12 row_mask:0xf bank_mask:0xf
    v_mfma_f32_16x16x32_bf16 v[28:31], a[44:47], v[8:11], 0
    s_nop 0
    v_add_f32_dpp v23, v41, v40 row_ror:8 row_mask:0xf bank_mask:0x4
    v_add_f32_dpp v40, v32, v35 row_ror:12 row_mask:0xf bank_mask:0xf
    v_add_f32_dpp v41, v34, v33 row_ror:12 row_mask:0xf bank_mask:0xf
    v_mfma_f32_16x16x32_bf16 v[32:35], a[48:51], v[8:11], 0
    s_nop 0
    v_add_f32_dpp v22, v41, v40 row_ror:8 row_mask:0xf bank_mask:0x8
    v_add_f32_dpp v40, v36, v39 row_ror:12 row_mask:0xf bank_mask:0xf
    v_add_f32_dpp v41, v38, v37 row_ror:12 row_mask:0xf bank_mask:0xf
    v_mfma_f32_16x16x32_bf16 v[36:39], a[52:55], v[8:11], 0
    s_waitcnt vmcnt(11)
    buffer_load_dwordx4 a[124:127], v2, s[12:15], s48 offen offset:3072
    v_add_f32_dpp v23, v41, v40 row_ror:8 row_mask:0xf bank_mask:0x8
    v_add_f32_dpp v40, v29, v28 row_ror:12 row_mask:0xf bank_mask:0xf
    v_add_f32_dpp v41, v31, v30 row_ror:12 row_mask:0xf bank_mask:0xf
    v_mfma_f32_16x16x32_bf16 v[28:31], a[56:59], v[8:11], 0
    s_nop 0
    v_add_f32_dpp v24, v41, v40 row_ror:8 row_mask:0xf bank_mask:0x1
    v_add_f32_dpp v40, v33, v32 row_ror:12 row_mask:0xf bank_mask:0xf
    v_add_f32_dpp v41, v35, v34 row_ror:12 row_mask:0xf bank_mask:0xf
    v_mfma_f32_16x16x32_bf16 v[32:35], a[60:63], v[8:11], 0
    s_nop 0
    v_add_f32_dpp v25, v41, v40 row_ror:8 row_mask:0xf bank_mask:0x1
    v_add_f32_dpp v40, v38, v37 row_ror:12 row_mask:0xf bank_mask:0xf
    v_add_f32_dpp v41, v36, v39 row_ror:12 row_mask:0xf bank_mask:0xf
    v_mfma_f32_16x16x32_bf16 v[36:39], a[64:67], v[8:11], 0
    s_nop 0
    v_add_f32_dpp v24, v41, v40 row_ror:8 row_mask:0xf bank_mask:0x2
    v_add_f32_dpp v40, v30, v29 row_ror:12 row_mask:0xf bank_mask:0xf
    v_add_f32_dpp v41, v28, v31 row_ror:12 row_mask:0xf bank_mask:0xf
    v_mfma_f32_16x16x32_bf16 v[28:31], a[68:71], v[8:11], 0
    s_nop 0
    v_add_f32_dpp v25, v41, v40 row_ror:8 row_mask:0xf bank_mask:0x2
    v_add_f32_dpp v40, v35, v34 row_ror:12 row_mask:0xf bank_mask:0xf
    v_add_f32_dpp v41, v33, v32 row_ror:12 row_mask:0xf bank_mask:0xf
    v_mfma_f32_16x16x32_bf16 v[32:35], a[72:75], v[8:11], 0
    s_nop 0
    v_add_f32_dpp v24, v41, v40 row_ror:8 row_mask:0xf bank_mask:0x4
    v_add_f32_dpp v40, v39, v38 row_ror:12 row_mask:0xf bank_mask:0xf
    v_add_f32_dpp v41, v37, v36 row_ror:12 row_mask:0xf bank_mask:0xf
    v_mfma_f32_16x16x32_bf16 v[36:39], a[76:79], v[8:11], 0
    s_nop 0
    v_add_f32_dpp v25, v41, v40 row_ror:8 row_mask:0xf bank_mask:0x4
    v_add_f32_dpp v40, v28, v31 row_ror:12 row_mask:0xf bank_mask:0xf
    v_add_f32_dpp v41, v30, v29 row_ror:12 row_mask:0xf bank_mask:0xf
    v_mfma_f32_16x16x32_bf16 v[28:31], a[80:83], v[8:11], 0
    s_nop 0
    v_add_f32_dpp v24, v41, v40 row_ror:8 row_mask:0xf bank_mask:0x8
    v_add_f32_dpp v40, v32, v35 row_ror:12 row_mask:0xf bank_mask:0xf
    v_add_f32_dpp v41, v34, v33 row_ror:12 row_mask:0xf bank_mask:0xf
    v_mfma_f32_16x16x32_bf16 v[32:35], a[84:87], v[8:11], 0
    s_nop 0
    v_add_f32_dpp v25, v41, v40 row_ror:8 row_mask:0xf bank_mask:0x8
    v_add_f32_dpp v40, v37, v36 row_ror:12 row_mask:0xf bank_mask:0xf
    v_add_f32_dpp v41, v39, v38 row_ror:12 row_mask:0xf bank_mask:0xf
    v_mfma_f32_16x16x32_bf16 v[36:39], a[88:91], v[8:11], 0
    s_nop 0
    v_add_f32_dpp v26, v41, v40 row_ror:8 row_mask:0xf bank_mask:0x1
    v_add_f32_dpp v40, v29, v28 row_ror:12 row_mask:0xf bank_mask:0xf
    v_add_f32_dpp v41, v31, v30 row_ror:12 row_mask:0xf bank_mask:0xf
    v_mfma_f32_16x16x32_bf16 v[28:31], a[92:95], v[8:11], 0
    s_nop 0
    v_add_f32_dpp v27, v41, v40 row_ror:8 row_mask:0xf bank_mask:0x1
    v_add_f32_dpp v40, v34, v33 row_ror:12 row_mask:0xf bank_mask:0xf
    v_add_f32_dpp v41, v32, v35 row_ror:12 row_mask:0xf bank_mask:0xf
    v_mfma_f32_16x16x32_bf16 v[32:35], a[96:99], v[8:11], 0
    s_waitcnt vmcnt(11)
    s_mov_b32 s48, 212992
    buffer_load_dwordx4 a[128:131], v2, s[12:15], s48 offen offset:0
    v_add_f32_dpp v26, v41, v40 row_ror:8 row_mask:0xf bank_mask:0x2
    v_add_f32_dpp v40, v38, v37 row_ror:12 row_mask:0xf bank_mask:0xf
    v_add_f32_dpp v41, v36, v39 row_ror:12 row_mask:0xf bank_mask:0xf
    v_mfma_f32_16x16x32_bf16 v[36:39], a[100:103], v[8:11], 0
    s_nop 0
    v_add_f32_dpp v27, v41, v40 row_ror:8 row_mask:0xf bank_mask:0x2
    v_add_f32_dpp v40, v31, v30 row_ror:12 row_mask:0xf bank_mask:0xf
    v_add_f32_dpp v41, v29, v28 row_ror:12 row_mask:0xf bank_mask:0xf
    v_mfma_f32_16x16x32_bf16 v[28:31], a[104:107], v[8:11], 0
    s_nop 0
    v_add_f32_dpp v26, v41, v40 row_ror:8 row_mask:0xf bank_mask:0x4
    v_add_f32_dpp v40, v35, v34 row_ror:12 row_mask:0xf bank_mask:0xf
    v_add_f32_dpp v41, v33, v32 row_ror:12 row_mask:0xf bank_mask:0xf
    s_nop 1
    v_add_f32_dpp v27, v41, v40 row_ror:8 row_mask:0xf bank_mask:0x4
    v_add_f32_dpp v40, v36, v39 row_ror:12 row_mask:0xf bank_mask:0xf
    v_add_f32_dpp v41, v38, v37 row_ror:12 row_mask:0xf bank_mask:0xf
    s_nop 1
    v_add_f32_dpp v26, v41, v40 row_ror:8 row_mask:0xf bank_mask:0x8
    v_add_f32_dpp v40, v28, v31 row_ror:12 row_mask:0xf bank_mask:0xf
    v_add_f32_dpp v41, v30, v29 row_ror:12 row_mask:0xf bank_mask:0xf
    s_nop 1
    v_add_f32_dpp v27, v41, v40 row_ror:8 row_mask:0xf bank_mask:0x8
    s_mov_b32 s61, 1048576
    s_waitcnt lgkmcnt(0)
    s_call_b64 s[86:87], S_sm
    v_mov_b32 v28, 0
    v_mov_b32 v29, 0
    v_mov_b32 v30, 0
    v_mov_b32 v31, 0
    v_mov_b32 v32, 0
    v_mov_b32 v33, 0
    v_mov_b32 v34, 0
    v_mov_b32 v35, 0
    v_mov_b32 v36, 0
    v_mov_b32 v37, 0
    v_mov_b32 v38, 0
    v_mov_b32 v39, 0
    v_mov_b32 v40, 0
    v_mov_b32 v41, 0
    v_mov_b32 v42, 0
    v_mov_b32 v43, 0
    v_mov_b32_dpp v28, v12 quad_perm:[0,1,2,3] row_mask:0xf bank_mask:0x1
    v_mov_b32_dpp v29, v12 row_shl:4 row_mask:0xf bank_mask:0x1
    v_mov_b32_dpp v30, v12 row_shl:8 row_mask:0xf bank_mask:0x1
    v_mov_b32_dpp v31, v12 row_shl:12 row_mask:0xf bank_mask:0x1
    v_mov_b32_dpp v32, v12 row_shr:4 row_mask:0xf bank_mask:0x2
    v_mov_b32_dpp v33, v12 quad_perm:[0,1,2,3] row_mask:0xf bank_mask:0x2
    v_mov_b32_dpp v34, v12 row_shl:4 row_mask:0xf bank_mask:0x2
    v_mov_b32_dpp v35, v12 row_shl:8 row_mask:0xf bank_mask:0x2
    v_mov_b32_dpp v36, v12 row_shr:8 row_mask:0xf bank_mask:0x4
    v_mov_b32_dpp v37, v12 row_shr:4 row_mask:0xf bank_mask:0x4
    v_mov_b32_dpp v38, v12 quad_perm:[0,1,2,3] row_mask:0xf bank_mask:0x4
    v_mov_b32_dpp v39, v12 row_shl:4 row_mask:0xf bank_mask:0x4
    v_mov_b32_dpp v40, v12 row_shr:12 row_mask:0xf bank_mask:0x8
    v_mov_b32_dpp v41, v12 row_shr:8 row_mask:0xf bank_mask:0x8
    v_mov_b32_dpp v42, v12 row_shr:4 row_mask:0xf bank_mask:0x8
    v_mov_b32_dpp v43, v12 quad_perm:[0,1,2,3] row_mask:0xf bank_mask:0x8
    v_perm_b32 v20, v72, v68, s74
    v_perm_b32 v21, v80, v76, s74
    v_perm_b32 v22, v88, v84, s74
    v_perm_b32 v23, v96, v92, s74
    s_waitcnt vmcnt(11)
    s_mov_b32 s48, 212992
    buffer_load_dwordx4 a[132:135], v2, s[12:15], s48 offen offset:1024
    s_waitcnt vmcnt(11)
    buffer_load_dwordx4 a[136:139], v2, s[12:15], s48 offen offset:2048
    s_waitcnt vmcnt(11)
    buffer_load_dwordx4 a[140:143], v2, s[12:15], s48 offen offset:3072
    v_perm_b32 v24, v72, v68, s75
    v_perm_b32 v25, v80, v76, s75
    v_perm_b32 v26, v88, v84, s75
    v_perm_b32 v27, v96, v92, s75
    v_mfma_f32_16x16x32_bf16 v[44:47], v[28:31], v[20:23], 0
    v_perm_b32 v20, v73, v69, s74
    v_perm_b32 v21, v81, v77, s74
    v_perm_b32 v22, v89, v85, s74
    v_perm_b32 v23, v97, v93, s74
    v_mfma_f32_16x16x32_bf16 v[44:47], v[32:35], v[24:27], v[44:47]
    v_perm_b32 v24, v73, v69, s75
    v_perm_b32 v25, v81, v77, s75
    v_perm_b32 v26, v89, v85, s75
    v_perm_b32 v27, v97, v93, s75
    v_mfma_f32_16x16x32_bf16 v[44:47], v[36:39], v[20:23], v[44:47]
    v_perm_b32 v20, v74, v70, s74
    v_perm_b32 v21, v82, v78, s74
    v_perm_b32 v22, v90, v86, s74
    v_perm_b32 v23, v98, v94, s74
    v_mfma_f32_16x16x32_bf16 v[44:47], v[40:43], v[24:27], v[44:47]
    v_perm_b32 v24, v74, v70, s75
    v_perm_b32 v25, v82, v78, s75
    v_perm_b32 v26, v90, v86, s75
    v_perm_b32 v27, v98, v94, s75
    v_mfma_f32_16x16x32_bf16 v[48:51], v[28:31], v[20:23], 0
    v_perm_b32 v20, v75, v71, s74
    v_perm_b32 v21, v83, v79, s74
    v_perm_b32 v22, v91, v87, s74
    v_perm_b32 v23, v99, v95, s74
    v_mfma_f32_16x16x32_bf16 v[48:51], v[32:35], v[24:27], v[48:51]
    v_perm_b32 v24, v75, v71, s75
    v_perm_b32 v25, v83, v79, s75
    v_perm_b32 v26, v91, v87, s75
    v_perm_b32 v27, v99, v95, s75
    v_mfma_f32_16x16x32_bf16 v[48:51], v[36:39], v[20:23], v[48:51]
    s_waitcnt vmcnt(11)
    s_mov_b32 s48, 229376
    buffer_load_dwordx4 a[144:147], v2, s[12:15], s48 offen offset:0 nt
    v_mfma_f32_16x16x32_bf16 v[48:51], v[40:43], v[24:27], v[48:51]
    s_nop 6
    s_call_b64 s[86:87], S_sm2
    v_mov_b32_dpp v28, v13 quad_perm:[0,1,2,3] row_mask:0xf bank_mask:0x1
    v_mov_b32_dpp v29, v13 row_shl:4 row_mask:0xf bank_mask:0x1
    v_mov_b32_dpp v30, v13 row_shl:8 row_mask:0xf bank_mask:0x1
    v_mov_b32_dpp v31, v13 row_shl:12 row_mask:0xf bank_mask:0x1
    v_mov_b32_dpp v32, v13 row_shr:4 row_mask:0xf bank_mask:0x2
    v_mov_b32_dpp v33, v13 quad_perm:[0,1,2,3] row_mask:0xf bank_mask:0x2
    v_mov_b32_dpp v34, v13 row_shl:4 row_mask:0xf bank_mask:0x2
    v_mov_b32_dpp v35, v13 row_shl:8 row_mask:0xf bank_mask:0x2
    v_mov_b32_dpp v36, v13 row_shr:8 row_mask:0xf bank_mask:0x4
    v_mov_b32_dpp v37, v13 row_shr:4 row_mask:0xf bank_mask:0x4
    v_mov_b32_dpp v38, v13 quad_perm:[0,1,2,3] row_mask:0xf bank_mask:0x4
    v_mov_b32_dpp v39, v13 row_shl:4 row_mask:0xf bank_mask:0x4
    v_mov_b32_dpp v40, v13 row_shr:12 row_mask:0xf bank_mask:0x8
    v_mov_b32_dpp v41, v13 row_shr:8 row_mask:0xf bank_mask:0x8
    v_mov_b32_dpp v42, v13 row_shr:4 row_mask:0xf bank_mask:0x8
    v_mov_b32_dpp v43, v13 quad_perm:[0,1,2,3] row_mask:0xf bank_mask:0x8
    v_perm_b32 v20, v104, v100, s74
    v_perm_b32 v21, v112, v108, s74
    v_perm_b32 v22, v120, v116, s74
    v_perm_b32 v23, v128, v124, s74
    v_perm_b32 v24, v104, v100, s75
    v_perm_b32 v25, v112, v108, s75
    v_perm_b32 v26, v120, v116, s75
    v_perm_b32 v27, v128, v124, s75
    v_mfma_f32_16x16x32_bf16 v[44:47], v[28:31], v[20:23], v[44:47]
    v_perm_b32 v20, v105, v101, s74
    v_perm_b32 v21, v113, v109, s74
    v_perm_b32 v22, v121, v117, s74
    v_perm_b32 v23, v129, v125, s74
    v_mfma_f32_16x16x32_bf16 v[44:47], v[32:35], v[24:27], v[44:47]
    v_perm_b32 v24, v105, v101, s75
    v_perm_b32 v25, v113, v109, s75
    v_perm_b32 v26, v121, v117, s75
    v_perm_b32 v27, v129, v125, s75
    v_mfma_f32_16x16x32_bf16 v[44:47], v[36:39], v[20:23], v[44:47]
    v_perm_b32 v20, v106, v102, s74
    v_perm_b32 v21, v114, v110, s74
    v_perm_b32 v22, v122, v118, s74
    v_perm_b32 v23, v130, v126, s74
    v_mfma_f32_16x16x32_bf16 v[44:47], v[40:43], v[24:27], v[44:47]
    v_perm_b32 v24, v106, v102, s75
    v_perm_b32 v25, v114, v110, s75
    v_perm_b32 v26, v122, v118, s75
    v_perm_b32 v27, v130, v126, s75
    v_mfma_f32_16x16x32_bf16 v[48:51], v[28:31], v[20:23], v[48:51]
    s_waitcnt vmcnt(11)
    s_mov_b32 s48, 229376
    buffer_load_dwordx4 v[68:71], v2, s[12:15], s48 offen offset:1024 nt
    v_perm_b32 v20, v107, v103, s74
    v_perm_b32 v21, v115, v111, s74
    v_perm_b32 v22, v123, v119, s74
    v_perm_b32 v23, v131, v127, s74
    v_mfma_f32_16x16x32_bf16 v[48:51], v[32:35], v[24:27], v[48:51]
    v_perm_b32 v24, v107, v103, s75
    v_perm_b32 v25, v115, v111, s75
    v_perm_b32 v26, v123, v119, s75
    v_perm_b32 v27, v131, v127, s75
    v_mfma_f32_16x16x32_bf16 v[48:51], v[36:39], v[20:23], v[48:51]
    s_nop 0
    v_mfma_f32_16x16x32_bf16 v[48:51], v[40:43], v[24:27], v[48:51]
    v_mov_b32_dpp v28, v14 quad_perm:[0,1,2,3] row_mask:0xf bank_mask:0x1
    v_mov_b32_dpp v29, v14 row_shl:4 row_mask:0xf bank_mask:0x1
    v_mov_b32_dpp v30, v14 row_shl:8 row_mask:0xf bank_mask:0x1
    v_mov_b32_dpp v31, v14 row_shl:12 row_mask:0xf bank_mask:0x1
    v_mov_b32_dpp v32, v14 row_shr:4 row_mask:0xf bank_mask:0x2
    v_mov_b32_dpp v33, v14 quad_perm:[0,1,2,3] row_mask:0xf bank_mask:0x2
    v_mov_b32_dpp v34, v14 row_shl:4 row_mask:0xf bank_mask:0x2
    v_mov_b32_dpp v35, v14 row_shl:8 row_mask:0xf bank_mask:0x2
    v_mov_b32_dpp v36, v14 row_shr:8 row_mask:0xf bank_mask:0x4
    v_mov_b32_dpp v37, v14 row_shr:4 row_mask:0xf bank_mask:0x4
    v_mov_b32_dpp v38, v14 quad_perm:[0,1,2,3] row_mask:0xf bank_mask:0x4
    v_mov_b32_dpp v39, v14 row_shl:4 row_mask:0xf bank_mask:0x4
    v_mov_b32_dpp v40, v14 row_shr:12 row_mask:0xf bank_mask:0x8
    v_mov_b32_dpp v41, v14 row_shr:8 row_mask:0xf bank_mask:0x8
    v_mov_b32_dpp v42, v14 row_shr:4 row_mask:0xf bank_mask:0x8
    v_mov_b32_dpp v43, v14 quad_perm:[0,1,2,3] row_mask:0xf bank_mask:0x8
    v_perm_b32 v20, v136, v132, s74
    v_perm_b32 v21, v144, v140, s74
    v_perm_b32 v22, v152, v148, s74
    v_perm_b32 v23, v160, v156, s74
    v_perm_b32 v24, v136, v132, s75
    v_perm_b32 v25, v144, v140, s75
    v_perm_b32 v26, v152, v148, s75
    v_perm_b32 v27, v160, v156, s75
    v_mfma_f32_16x16x32_bf16 v[44:47], v[28:31], v[20:23], v[44:47]
    v_perm_b32 v20, v137, v133, s74
    v_perm_b32 v21, v145, v141, s74
    v_perm_b32 v22, v153, v149, s74
    v_perm_b32 v23, v161, v157, s74
    v_mfma_f32_16x16x32_bf16 v[44:47], v[32:35], v[24:27], v[44:47]
    v_perm_b32 v24, v137, v133, s75
    v_perm_b32 v25, v145, v141, s75
    v_perm_b32 v26, v153, v149, s75
    v_perm_b32 v27, v161, v157, s75
    v_mfma_f32_16x16x32_bf16 v[44:47], v[36:39], v[20:23], v[44:47]
    s_waitcnt vmcnt(11)
    buffer_load_dwordx4 v[72:75], v2, s[12:15], s48 offen offset:2048 nt
    v_perm_b32 v20, v138, v134, s74
    v_perm_b32 v21, v146, v142, s74
    v_perm_b32 v22, v154, v150, s74
    v_perm_b32 v23, v162, v158, s74
    v_mfma_f32_16x16x32_bf16 v[44:47], v[40:43], v[24:27], v[44:47]
    v_perm_b32 v24, v138, v134, s75
    v_perm_b32 v25, v146, v142, s75
    v_perm_b32 v26, v154, v150, s75
    v_perm_b32 v27, v162, v158, s75
    v_mfma_f32_16x16x32_bf16 v[48:51], v[28:31], v[20:23], v[48:51]
    v_perm_b32 v20, v139, v135, s74
    v_perm_b32 v21, v147, v143, s74
    v_perm_b32 v22, v155, v151, s74
    v_perm_b32 v23, v163, v159, s74
    v_mfma_f32_16x16x32_bf16 v[48:51], v[32:35], v[24:27], v[48:51]
    v_perm_b32 v24, v139, v135, s75
    v_perm_b32 v25, v147, v143, s75
    v_perm_b32 v26, v155, v151, s75
    v_perm_b32 v27, v163, v159, s75
    v_mfma_f32_16x16x32_bf16 v[48:51], v[36:39], v[20:23], v[48:51]
    s_nop 0
    v_mfma_f32_16x16x32_bf16 v[48:51], v[40:43], v[24:27], v[48:51]
    v_mov_b32_dpp v28, v15 quad_perm:[0,1,2,3] row_mask:0xf bank_mask:0x1
    v_mov_b32_dpp v29, v15 row_shl:4 row_mask:0xf bank_mask:0x1
    v_mov_b32_dpp v30, v15 row_shl:8 row_mask:0xf bank_mask:0x1
    v_mov_b32_dpp v31, v15 row_shl:12 row_mask:0xf bank_mask:0x1
    v_mov_b32_dpp v32, v15 row_shr:4 row_mask:0xf bank_mask:0x2
    v_mov_b32_dpp v33, v15 quad_perm:[0,1,2,3] row_mask:0xf bank_mask:0x2
    v_mov_b32_dpp v34, v15 row_shl:4 row_mask:0xf bank_mask:0x2
    v_mov_b32_dpp v35, v15 row_shl:8 row_mask:0xf bank_mask:0x2
    v_mov_b32_dpp v36, v15 row_shr:8 row_mask:0xf bank_mask:0x4
    v_mov_b32_dpp v37, v15 row_shr:4 row_mask:0xf bank_mask:0x4
    v_mov_b32_dpp v38, v15 quad_perm:[0,1,2,3] row_mask:0xf bank_mask:0x4
    v_mov_b32_dpp v39, v15 row_shl:4 row_mask:0xf bank_mask:0x4
    v_mov_b32_dpp v40, v15 row_shr:12 row_mask:0xf bank_mask:0x8
    v_mov_b32_dpp v41, v15 row_shr:8 row_mask:0xf bank_mask:0x8
    v_mov_b32_dpp v42, v15 row_shr:4 row_mask:0xf bank_mask:0x8
    v_mov_b32_dpp v43, v15 quad_perm:[0,1,2,3] row_mask:0xf bank_mask:0x8
    v_perm_b32 v20, v168, v164, s74
    v_perm_b32 v21, v176, v172, s74
    v_perm_b32 v22, v184, v180, s74
    v_perm_b32 v23, v192, v188, s74
    v_perm_b32 v24, v168, v164, s75
    v_perm_b32 v25, v176, v172, s75
    v_perm_b32 v26, v184, v180, s75
    v_perm_b32 v27, v192, v188, s75
    v_mfma_f32_16x16x32_bf16 v[44:47], v[28:31], v[20:23], v[44:47]
    s_waitcnt vmcnt(11)
    buffer_load_dwordx4 v[76:79], v2, s[12:15], s48 offen offset:3072 nt
    v_perm_b32 v20, v169, v165, s74
    v_perm_b32 v21, v177, v173, s74
    v_perm_b32 v22, v185, v181, s74
    v_perm_b32 v23, v193, v189, s74
    v_mfma_f32_16x16x32_bf16 v[44:47], v[32:35], v[24:27], v[44:47]
    v_perm_b32 v24, v169, v165, s75
    v_perm_b32 v25, v177, v173, s75
    v_perm_b32 v26, v185, v181, s75
    v_perm_b32 v27, v193, v189, s75
    v_mfma_f32_16x16x32_bf16 v[44:47], v[36:39], v[20:23], v[44:47]
    v_perm_b32 v20, v170, v166, s74
    v_perm_b32 v21, v178, v174, s74
    v_perm_b32 v22, v186, v182, s74
    v_perm_b32 v23, v194, v190, s74
    v_mfma_f32_16x16x32_bf16 v[44:47], v[40:43], v[24:27], v[44:47]
    v_perm_b32 v24, v170, v166, s75
    v_perm_b32 v25, v178, v174, s75
    v_perm_b32 v26, v186, v182, s75
    v_perm_b32 v27, v194, v190, s75
    v_mfma_f32_16x16x32_bf16 v[48:51], v[28:31], v[20:23], v[48:51]
    v_perm_b32 v20, v171, v167, s74
    v_perm_b32 v21, v179, v175, s74
    v_perm_b32 v22, v187, v183, s74
    v_perm_b32 v23, v195, v191, s74
    v_mfma_f32_16x16x32_bf16 v[48:51], v[32:35], v[24:27], v[48:51]
    v_perm_b32 v24, v171, v167, s75
    v_perm_b32 v25, v179, v175, s75
    v_perm_b32 v26, v187, v183, s75
    v_perm_b32 v27, v195, v191, s75
    v_mfma_f32_16x16x32_bf16 v[48:51], v[36:39], v[20:23], v[48:51]
    s_nop 0
    v_mfma_f32_16x16x32_bf16 v[48:51], v[40:43], v[24:27], v[48:51]
    v_mov_b32_dpp v28, v16 quad_perm:[0,1,2,3] row_mask:0xf bank_mask:0x1
    v_mov_b32_dpp v29, v16 row_shl:4 row_mask:0xf bank_mask:0x1
    v_mov_b32_dpp v30, v16 row_shl:8 row_mask:0xf bank_mask:0x1
    v_mov_b32_dpp v31, v16 row_shl:12 row_mask:0xf bank_mask:0x1
    v_mov_b32_dpp v32, v16 row_shr:4 row_mask:0xf bank_mask:0x2
    v_mov_b32_dpp v33, v16 quad_perm:[0,1,2,3] row_mask:0xf bank_mask:0x2
    v_mov_b32_dpp v34, v16 row_shl:4 row_mask:0xf bank_mask:0x2
    v_mov_b32_dpp v35, v16 row_shl:8 row_mask:0xf bank_mask:0x2
    v_mov_b32_dpp v36, v16 row_shr:8 row_mask:0xf bank_mask:0x4
    v_mov_b32_dpp v37, v16 row_shr:4 row_mask:0xf bank_mask:0x4
    v_mov_b32_dpp v38, v16 quad_perm:[0,1,2,3] row_mask:0xf bank_mask:0x4
    v_mov_b32_dpp v39, v16 row_shl:4 row_mask:0xf bank_mask:0x4
    v_mov_b32_dpp v40, v16 row_shr:12 row_mask:0xf bank_mask:0x8
    v_mov_b32_dpp v41, v16 row_shr:8 row_mask:0xf bank_mask:0x8
    v_mov_b32_dpp v42, v16 row_shr:4 row_mask:0xf bank_mask:0x8
    v_mov_b32_dpp v43, v16 quad_perm:[0,1,2,3] row_mask:0xf bank_mask:0x8
    v_perm_b32 v20, v200, v196, s74
    v_perm_b32 v21, v208, v204, s74
    v_perm_b32 v22, v216, v212, s74
    v_perm_b32 v23, v224, v220, s74
    s_waitcnt vmcnt(11)
    s_mov_b32 s48, 245760
    buffer_load_dwordx4 v[80:83], v2, s[12:15], s48 offen offset:0 nt
    v_perm_b32 v24, v200, v196, s75
    v_perm_b32 v25, v208, v204, s75
    v_perm_b32 v26, v216, v212, s75
    v_perm_b32 v27, v224, v220, s75
    v_mfma_f32_16x16x32_bf16 v[44:47], v[28:31], v[20:23], v[44:47]
    v_perm_b32 v20, v201, v197, s74
    v_perm_b32 v21, v209, v205, s74
    v_perm_b32 v22, v217, v213, s74
    v_perm_b32 v23, v225, v221, s74
    v_mfma_f32_16x16x32_bf16 v[44:47], v[32:35], v[24:27], v[44:47]
    v_perm_b32 v24, v201, v197, s75
    v_perm_b32 v25, v209, v205, s75
    v_perm_b32 v26, v217, v213, s75
    v_perm_b32 v27, v225, v221, s75
    v_mfma_f32_16x16x32_bf16 v[44:47], v[36:39], v[20:23], v[44:47]
    v_perm_b32 v20, v202, v198, s74
    v_perm_b32 v21, v210, v206, s74
    v_perm_b32 v22, v218, v214, s74
    v_perm_b32 v23, v226, v222, s74
    v_mfma_f32_16x16x32_bf16 v[44:47], v[40:43], v[24:27], v[44:47]
    v_perm_b32 v24, v202, v198, s75
    v_perm_b32 v25, v210, v206, s75
    v_perm_b32 v26, v218, v214, s75
    v_perm_b32 v27, v226, v222, s75
    v_mfma_f32_16x16x32_bf16 v[48:51], v[28:31], v[20:23], v[48:51]
    v_perm_b32 v20, v203, v199, s74
    v_perm_b32 v21, v211, v207, s74
    v_perm_b32 v22, v219, v215, s74
    v_perm_b32 v23, v227, v223, s74
    v_mfma_f32_16x16x32_bf16 v[48:51], v[32:35], v[24:27], v[48:51]
    v_perm_b32 v24, v203, v199, s75
    v_perm_b32 v25, v211, v207, s75
    v_perm_b32 v26, v219, v215, s75
    v_perm_b32 v27, v227, v223, s75
    v_mfma_f32_16x16x32_bf16 v[48:51], v[36:39], v[20:23], v[48:51]
    s_nop 0
    v_mfma_f32_16x16x32_bf16 v[48:51], v[40:43], v[24:27], v[48:51]
    v_mov_b32_dpp v28, v17 quad_perm:[0,1,2,3] row_mask:0xf bank_mask:0x1
    v_mov_b32_dpp v29, v17 row_shl:4 row_mask:0xf bank_mask:0x1
    v_mov_b32_dpp v30, v17 row_shl:8 row_mask:0xf bank_mask:0x1
    v_mov_b32_dpp v31, v17 row_shl:12 row_mask:0xf bank_mask:0x1
    v_mov_b32_dpp v32, v17 row_shr:4 row_mask:0xf bank_mask:0x2
    v_mov_b32_dpp v33, v17 quad_perm:[0,1,2,3] row_mask:0xf bank_mask:0x2
    v_mov_b32_dpp v34, v17 row_shl:4 row_mask:0xf bank_mask:0x2
    v_mov_b32_dpp v35, v17 row_shl:8 row_mask:0xf bank_mask:0x2
    v_mov_b32_dpp v36, v17 row_shr:8 row_mask:0xf bank_mask:0x4
    v_mov_b32_dpp v37, v17 row_shr:4 row_mask:0xf bank_mask:0x4
    v_mov_b32_dpp v38, v17 quad_perm:[0,1,2,3] row_mask:0xf bank_mask:0x4
    v_mov_b32_dpp v39, v17 row_shl:4 row_mask:0xf bank_mask:0x4
    v_mov_b32_dpp v40, v17 row_shr:12 row_mask:0xf bank_mask:0x8
    v_mov_b32_dpp v41, v17 row_shr:8 row_mask:0xf bank_mask:0x8
    v_mov_b32_dpp v42, v17 row_shr:4 row_mask:0xf bank_mask:0x8
    v_mov_b32_dpp v43, v17 quad_perm:[0,1,2,3] row_mask:0xf bank_mask:0x8
    v_accvgpr_read_b32 v59, a108
    v_perm_b32 v20, v232, v228, s74
    v_perm_b32 v21, v240, v236, s74
    v_perm_b32 v22, v248, v244, s74
    v_perm_b32 v23, v59, v252, s74
    s_waitcnt vmcnt(11)
    buffer_load_dwordx4 v[84:87], v2, s[12:15], s48 offen offset:1024 nt
    v_perm_b32 v24, v232, v228, s75
    v_perm_b32 v25, v240, v236, s75
    v_perm_b32 v26, v248, v244, s75
    v_perm_b32 v27, v59, v252, s75
    v_mfma_f32_16x16x32_bf16 v[44:47], v[28:31], v[20:23], v[44:47]
    v_accvgpr_read_b32 v59, a109
    v_perm_b32 v20, v233, v229, s74
    v_perm_b32 v21, v241, v237, s74
    v_perm_b32 v22, v249, v245, s74
    v_perm_b32 v23, v59, v253, s74
    v_mfma_f32_16x16x32_bf16 v[44:47], v[32:35], v[24:27], v[44:47]
    v_perm_b32 v24, v233, v229, s75
    v_perm_b32 v25, v241, v237, s75
    v_perm_b32 v26, v249, v245, s75
    v_perm_b32 v27, v59, v253, s75
    v_mfma_f32_16x16x32_bf16 v[44:47], v[36:39], v[20:23], v[44:47]
    v_accvgpr_read_b32 v59, a110
    v_perm_b32 v20, v234, v230, s74
    v_perm_b32 v21, v242, v238, s74
    v_perm_b32 v22, v250, v246, s74
    v_perm_b32 v23, v59, v254, s74
    v_mfma_f32_16x16x32_bf16 v[44:47], v[40:43], v[24:27], v[44:47]
    v_perm_b32 v24, v234, v230, s75
    v_perm_b32 v25, v242, v238, s75
    v_perm_b32 v26, v250, v246, s75
    v_perm_b32 v27, v59, v254, s75
    v_mfma_f32_16x16x32_bf16 v[48:51], v[28:31], v[20:23], v[48:51]
    s_waitcnt vmcnt(11)
    buffer_load_dwordx4 v[88:91], v2, s[12:15], s48 offen offset:2048 nt
    v_accvgpr_read_b32 v59, a111
    v_perm_b32 v20, v235, v231, s74
    v_perm_b32 v21, v243, v239, s74
    v_perm_b32 v22, v251, v247, s74
    v_perm_b32 v23, v59, v255, s74
    v_mfma_f32_16x16x32_bf16 v[48:51], v[32:35], v[24:27], v[48:51]
    v_perm_b32 v24, v235, v231, s75
    v_perm_b32 v25, v243, v239, s75
    v_perm_b32 v26, v251, v247, s75
    v_perm_b32 v27, v59, v255, s75
    v_mfma_f32_16x16x32_bf16 v[48:51], v[36:39], v[20:23], v[48:51]
    s_nop 0
    v_mfma_f32_16x16x32_bf16 v[48:51], v[40:43], v[24:27], v[48:51]
    v_mov_b32_dpp v28, v18 quad_perm:[0,1,2,3] row_mask:0xf bank_mask:0x1
    v_mov_b32_dpp v29, v18 row_shl:4 row_mask:0xf bank_mask:0x1
    v_mov_b32_dpp v30, v18 row_shl:8 row_mask:0xf bank_mask:0x1
    v_mov_b32_dpp v31, v18 row_shl:12 row_mask:0xf bank_mask:0x1
    v_mov_b32_dpp v32, v18 row_shr:4 row_mask:0xf bank_mask:0x2
    v_mov_b32_dpp v33, v18 quad_perm:[0,1,2,3] row_mask:0xf bank_mask:0x2
    v_mov_b32_dpp v34, v18 row_shl:4 row_mask:0xf bank_mask:0x2
    v_mov_b32_dpp v35, v18 row_shl:8 row_mask:0xf bank_mask:0x2
    v_mov_b32_dpp v36, v18 row_shr:8 row_mask:0xf bank_mask:0x4
    v_mov_b32_dpp v37, v18 row_shr:4 row_mask:0xf bank_mask:0x4
    v_mov_b32_dpp v38, v18 quad_perm:[0,1,2,3] row_mask:0xf bank_mask:0x4
    v_mov_b32_dpp v39, v18 row_shl:4 row_mask:0xf bank_mask:0x4
    v_mov_b32_dpp v40, v18 row_shr:12 row_mask:0xf bank_mask:0x8
    v_mov_b32_dpp v41, v18 row_shr:8 row_mask:0xf bank_mask:0x8
    v_mov_b32_dpp v42, v18 row_shr:4 row_mask:0xf bank_mask:0x8
    v_mov_b32_dpp v43, v18 quad_perm:[0,1,2,3] row_mask:0xf bank_mask:0x8
    s_waitcnt vmcnt(11)
    buffer_load_dwordx4 v[92:95], v2, s[12:15], s48 offen offset:3072 nt
    s_waitcnt vmcnt(11)
    s_mov_b32 s48, 0
    buffer_load_dwordx4 a[148:151], v1, s[16:19], s48 offen offset:0
    s_waitcnt vmcnt(11)
    buffer_load_dwordx4 a[152:155], v1, s[16:19], s48 offen offset:1024
    s_waitcnt vmcnt(11)
    buffer_load_dwordx4 a[156:159], v1, s[16:19], s48 offen offset:2048
    s_waitcnt vmcnt(11)
    buffer_load_dwordx4 a[160:163], v1, s[16:19], s48 offen offset:3072
    v_accvgpr_read_b32 v52, a112
    v_accvgpr_read_b32 v53, a116
    v_accvgpr_read_b32 v54, a120
    v_accvgpr_read_b32 v55, a124
    v_accvgpr_read_b32 v56, a128
    v_accvgpr_read_b32 v57, a132
    v_accvgpr_read_b32 v58, a136
    v_accvgpr_read_b32 v59, a140
    v_perm_b32 v20, v53, v52, s74
    v_perm_b32 v21, v55, v54, s74
    v_perm_b32 v22, v57, v56, s74
    v_perm_b32 v23, v59, v58, s74
    s_waitcnt vmcnt(11)
    s_mov_b32 s48, 16384
    buffer_load_dwordx4 a[164:167], v1, s[16:19], s48 offen offset:0
    v_perm_b32 v24, v53, v52, s75
    v_perm_b32 v25, v55, v54, s75
    v_perm_b32 v26, v57, v56, s75
    v_perm_b32 v27, v59, v58, s75
    v_mfma_f32_16x16x32_bf16 v[44:47], v[28:31], v[20:23], v[44:47]
    v_accvgpr_read_b32 v52, a113
    v_accvgpr_read_b32 v53, a117
    v_accvgpr_read_b32 v54, a121
    v_accvgpr_read_b32 v55, a125
    v_accvgpr_read_b32 v56, a129
    v_accvgpr_read_b32 v57, a133
    v_accvgpr_read_b32 v58, a137
    v_accvgpr_read_b32 v59, a141
    v_perm_b32 v20, v53, v52, s74
    v_perm_b32 v21, v55, v54, s74
    v_perm_b32 v22, v57, v56, s74
    v_perm_b32 v23, v59, v58, s74
    v_mfma_f32_16x16x32_bf16 v[44:47], v[32:35], v[24:27], v[44:47]
    v_perm_b32 v24, v53, v52, s75
    v_perm_b32 v25, v55, v54, s75
    v_perm_b32 v26, v57, v56, s75
    v_perm_b32 v27, v59, v58, s75
    v_mfma_f32_16x16x32_bf16 v[44:47], v[36:39], v[20:23], v[44:47]
    v_accvgpr_read_b32 v52, a114
    v_accvgpr_read_b32 v53, a118
    v_accvgpr_read_b32 v54, a122
    v_accvgpr_read_b32 v55, a126
    v_accvgpr_read_b32 v56, a130
    v_accvgpr_read_b32 v57, a134
    v_accvgpr_read_b32 v58, a138
    v_accvgpr_read_b32 v59, a142
    v_perm_b32 v20, v53, v52, s74
    v_perm_b32 v21, v55, v54, s74
    v_perm_b32 v22, v57, v56, s74
    v_perm_b32 v23, v59, v58, s74
    v_mfma_f32_16x16x32_bf16 v[44:47], v[40:43], v[24:27], v[44:47]
    v_perm_b32 v24, v53, v52, s75
    v_perm_b32 v25, v55, v54, s75
    v_perm_b32 v26, v57, v56, s75
    v_perm_b32 v27, v59, v58, s75
    v_mfma_f32_16x16x32_bf16 v[48:51], v[28:31], v[20:23], v[48:51]
    s_waitcnt vmcnt(11)
    buffer_load_dwordx4 a[168:171], v1, s[16:19], s48 offen offset:1024
    v_accvgpr_read_b32 v52, a115
    v_accvgpr_read_b32 v53, a119
    v_accvgpr_read_b32 v54, a123
    v_accvgpr_read_b32 v55, a127
    v_accvgpr_read_b32 v56, a131
    v_accvgpr_read_b32 v57, a135
    v_accvgpr_read_b32 v58, a139
    v_accvgpr_read_b32 v59, a143
    v_perm_b32 v20, v53, v52, s74
    v_perm_b32 v21, v55, v54, s74
    v_perm_b32 v22, v57, v56, s74
    v_perm_b32 v23, v59, v58, s74
    v_mfma_f32_16x16x32_bf16 v[48:51], v[32:35], v[24:27], v[48:51]
    v_perm_b32 v24, v53, v52, s75
    v_perm_b32 v25, v55, v54, s75
    v_perm_b32 v26, v57, v56, s75
    v_perm_b32 v27, v59, v58, s75
    v_mfma_f32_16x16x32_bf16 v[48:51], v[36:39], v[20:23], v[48:51]
    s_nop 0
    v_mfma_f32_16x16x32_bf16 v[48:51], v[40:43], v[24:27], v[48:51]
    v_mov_b32_dpp v28, v19 quad_perm:[0,1,2,3] row_mask:0xf bank_mask:0x1
    v_mov_b32_dpp v29, v19 row_shl:4 row_mask:0xf bank_mask:0x1
    v_mov_b32_dpp v30, v19 row_shl:8 row_mask:0xf bank_mask:0x1
    v_mov_b32_dpp v31, v19 row_shl:12 row_mask:0xf bank_mask:0x1
    v_mov_b32_dpp v32, v19 row_shr:4 row_mask:0xf bank_mask:0x2
    v_mov_b32_dpp v33, v19 quad_perm:[0,1,2,3] row_mask:0xf bank_mask:0x2
    v_mov_b32_dpp v34, v19 row_shl:4 row_mask:0xf bank_mask:0x2
    v_mov_b32_dpp v35, v19 row_shl:8 row_mask:0xf bank_mask:0x2
    v_mov_b32_dpp v36, v19 row_shr:8 row_mask:0xf bank_mask:0x4
    v_mov_b32_dpp v37, v19 row_shr:4 row_mask:0xf bank_mask:0x4
    v_mov_b32_dpp v38, v19 quad_perm:[0,1,2,3] row_mask:0xf bank_mask:0x4
    v_mov_b32_dpp v39, v19 row_shl:4 row_mask:0xf bank_mask:0x4
    v_mov_b32_dpp v40, v19 row_shr:12 row_mask:0xf bank_mask:0x8
    v_mov_b32_dpp v41, v19 row_shr:8 row_mask:0xf bank_mask:0x8
    v_mov_b32_dpp v42, v19 row_shr:4 row_mask:0xf bank_mask:0x8
    v_mov_b32_dpp v43, v19 quad_perm:[0,1,2,3] row_mask:0xf bank_mask:0x8
    s_waitcnt vmcnt(11)
    buffer_load_dwordx4 a[172:175], v1, s[16:19], s48 offen offset:2048
    s_waitcnt vmcnt(11)
    buffer_load_dwordx4 a[176:179], v1, s[16:19], s48 offen offset:3072
    s_waitcnt vmcnt(11)
    s_mov_b32 s48, 32768
    buffer_load_dwordx4 a[180:183], v1, s[16:19], s48 offen offset:0
    s_waitcnt vmcnt(11)
    buffer_load_dwordx4 a[184:187], v1, s[16:19], s48 offen offset:1024
    s_waitcnt vmcnt(11)
    buffer_load_dwordx4 a[188:191], v1, s[16:19], s48 offen offset:2048
    s_waitcnt vmcnt(11)
    buffer_load_dwordx4 a[108:111], v1, s[16:19], s48 offen offset:3072
    s_mov_b32 s60, 0
    s_mov_b32 s62, 1179648
    s_mov_b32 s63, 1
    s_mov_b32 s82, 2
    s_mov_b32 s78, 2
    s_mov_b32 s83, 1
    s_mov_b32 s64, 64
    v_accvgpr_read_b32 v52, a144
    v_perm_b32 v20, v68, v52, s74
    v_perm_b32 v21, v76, v72, s74
    v_perm_b32 v22, v84, v80, s74
    v_perm_b32 v23, v92, v88, s74
    s_waitcnt vmcnt(11)
    s_mov_b32 s48, 49152
    buffer_load_dwordx4 a[112:115], v1, s[16:19], s48 offen offset:0
    v_perm_b32 v24, v68, v52, s75
    v_perm_b32 v25, v76, v72, s75
    v_perm_b32 v26, v84, v80, s75
    v_perm_b32 v27, v92, v88, s75
    v_mfma_f32_16x16x32_bf16 v[44:47], v[28:31], v[20:23], v[44:47]
    v_accvgpr_read_b32 v52, a145
    v_perm_b32 v20, v69, v52, s74
    v_perm_b32 v21, v77, v73, s74
    v_perm_b32 v22, v85, v81, s74
    v_perm_b32 v23, v93, v89, s74
    v_mfma_f32_16x16x32_bf16 v[44:47], v[32:35], v[24:27], v[44:47]
    v_perm_b32 v24, v69, v52, s75
    v_perm_b32 v25, v77, v73, s75
    v_perm_b32 v26, v85, v81, s75
    v_perm_b32 v27, v93, v89, s75
    v_mfma_f32_16x16x32_bf16 v[44:47], v[36:39], v[20:23], v[44:47]
    v_accvgpr_read_b32 v52, a146
    v_perm_b32 v20, v70, v52, s74
    v_perm_b32 v21, v78, v74, s74
    v_perm_b32 v22, v86, v82, s74
    v_perm_b32 v23, v94, v90, s74
    v_mfma_f32_16x16x32_bf16 v[44:47], v[40:43], v[24:27], v[44:47]
    v_perm_b32 v24, v70, v52, s75
    v_perm_b32 v25, v78, v74, s75
    v_perm_b32 v26, v86, v82, s75
    v_perm_b32 v27, v94, v90, s75
    v_mfma_f32_16x16x32_bf16 v[48:51], v[28:31], v[20:23], v[48:51]
    v_accvgpr_read_b32 v52, a147
    v_perm_b32 v20, v71, v52, s74
    v_perm_b32 v21, v79, v75, s74
    v_perm_b32 v22, v87, v83, s74
    v_perm_b32 v23, v95, v91, s74
    v_mfma_f32_16x16x32_bf16 v[48:51], v[32:35], v[24:27], v[48:51]
    s_waitcnt vmcnt(11)
    buffer_load_dwordx4 a[116:119], v1, s[16:19], s48 offen offset:1024
    v_perm_b32 v24, v71, v52, s75
    v_perm_b32 v25, v79, v75, s75
    v_perm_b32 v26, v87, v83, s75
    v_perm_b32 v27, v95, v91, s75
    v_mfma_f32_16x16x32_bf16 v[48:51], v[36:39], v[20:23], v[48:51]
    s_nop 0
    v_mfma_f32_16x16x32_bf16 v[48:51], v[40:43], v[24:27], v[48:51]
    s_mov_b32 s65, 0
    s_mov_b32 s81, 23
    s_mov_b32 s100, 10
    s_mov_b32 s101, 4
    s_mov_b32 s5, 10
    s_mov_b32 s80, 6
    s_add_u32 s88, s94, NB_g0_0-L_pc
    s_addc_u32 s89, s95, 0
    s_call_b64 s[86:87], S_epi
    v_mfma_f32_16x16x32_bf16 v[28:31], a[148:151], v[8:11], 0
    v_mfma_f32_16x16x32_bf16 v[32:35], a[152:155], v[8:11], 0
    v_mfma_f32_16x16x32_bf16 v[36:39], a[156:159], v[8:11], 0
    s_nop 5
    v_add_f32_dpp v40, v29, v28 row_ror:12 row_mask:0xf bank_mask:0xf
    v_add_f32_dpp v41, v31, v30 row_ror:12 row_mask:0xf bank_mask:0xf
    v_mfma_f32_16x16x32_bf16 v[28:31], a[160:163], v[8:11], 0
    s_nop 0
    v_add_f32_dpp v12, v41, v40 row_ror:8 row_mask:0xf bank_mask:0x1
    v_add_f32_dpp v40, v33, v32 row_ror:12 row_mask:0xf bank_mask:0xf
    v_add_f32_dpp v41, v35, v34 row_ror:12 row_mask:0xf bank_mask:0xf
    v_mfma_f32_16x16x32_bf16 v[32:35], a[164:167], v[8:11], 0
    s_nop 0
    v_add_f32_dpp v13, v41, v40 row_ror:8 row_mask:0xf bank_mask:0x1
    v_add_f32_dpp v40, v38, v37 row_ror:12 row_mask:0xf bank_mask:0xf
    v_add_f32_dpp v41, v36, v39 row_ror:12 row_mask:0xf bank_mask:0xf
    v_mfma_f32_16x16x32_bf16 v[36:39], a[168:171], v[8:11], 0
    s_nop 0
    v_add_f32_dpp v12, v41, v40 row_ror:8 row_mask:0xf bank_mask:0x2
    v_add_f32_dpp v40, v30, v29 row_ror:12 row_mask:0xf bank_mask:0xf
    v_add_f32_dpp v41, v28, v31 row_ror:12 row_mask:0xf bank_mask:0xf
    v_mfma_f32_16x16x32_bf16 v[28:31], a[172:175], v[8:11], 0
    s_nop 0
    v_add_f32_dpp v13, v41, v40 row_ror:8 row_mask:0xf bank_mask:0x2
    v_add_f32_dpp v40, v35, v34 row_ror:12 row_mask:0xf bank_mask:0xf
    v_add_f32_dpp v41, v33, v32 row_ror:12 row_mask:0xf bank_mask:0xf
    v_mfma_f32_16x16x32_bf16 v[32:35], a[176:179], v[8:11], 0
    s_nop 0
    v_add_f32_dpp v12, v41, v40 row_ror:8 row_mask:0xf bank_mask:0x4
    v_add_f32_dpp v40, v39, v38 row_ror:12 row_mask:0xf bank_mask:0xf
    v_add_f32_dpp v41, v37, v36 row_ror:12 row_mask:0xf bank_mask:0xf
    v_mfma_f32_16x16x32_bf16 v[36:39], a[180:183], v[8:11], 0
    s_nop 0
    v_add_f32_dpp v13, v41, v40 row_ror:8 row_mask:0xf bank_mask:0x4
    v_add_f32_dpp v40, v28, v31 row_ror:12 row_mask:0xf bank_mask:0xf
    v_add_f32_dpp v41, v30, v29 row_ror:12 row_mask:0xf bank_mask:0xf
    v_mfma_f32_16x16x32_bf16 v[28:31], a[184:187], v[8:11], 0
    s_nop 0
    v_add_f32_dpp v12, v41, v40 row_ror:8 row_mask:0xf bank_mask:0x8
    v_add_f32_dpp v40, v32, v35 row_ror:12 row_mask:0xf bank_mask:0xf
    v_add_f32_dpp v41, v34, v33 row_ror:12 row_mask:0xf bank_mask:0xf
    v_mfma_f32_16x16x32_bf16 v[32:35], a[188:191], v[8:11], 0
    s_nop 0
    v_add_f32_dpp v13, v41, v40 row_ror:8 row_mask:0xf bank_mask:0x8
    v_add_f32_dpp v40, v37, v36 row_ror:12 row_mask:0xf bank_mask:0xf
    v_add_f32_dpp v41, v39, v38 row_ror:12 row_mask:0xf bank_mask:0xf
    v_mfma_f32_16x16x32_bf16 v[36:39], a[108:111], v[8:11], 0
    s_nop 0
    v_add_f32_dpp v14, v41, v40 row_ror:8 row_mask:0xf bank_mask:0x1
    v_add_f32_dpp v40, v29, v28 row_ror:12 row_mask:0xf bank_mask:0xf
    v_add_f32_dpp v41, v31, v30 row_ror:12 row_mask:0xf bank_mask:0xf
    v_mfma_f32_16x16x32_bf16 v[28:31], a[112:115], v[8:11], 0
    s_nop 0
    v_add_f32_dpp v15, v41, v40 row_ror:8 row_mask:0xf bank_mask:0x1
    v_add_f32_dpp v40, v34, v33 row_ror:12 row_mask:0xf bank_mask:0xf
    v_add_f32_dpp v41, v32, v35 row_ror:12 row_mask:0xf bank_mask:0xf
    v_mfma_f32_16x16x32_bf16 v[32:35], a[116:119], v[8:11], 0
    s_nop 0
    v_add_f32_dpp v14, v41, v40 row_ror:8 row_mask:0xf bank_mask:0x2
    v_add_f32_dpp v40, v38, v37 row_ror:12 row_mask:0xf bank_mask:0xf
    v_add_f32_dpp v41, v36, v39 row_ror:12 row_mask:0xf bank_mask:0xf
    s_waitcnt vmcnt(45)
    v_mfma_f32_16x16x32_bf16 v[36:39], a[120:123], v[8:11], 0
    s_waitcnt vmcnt(44)
    v_add_f32_dpp v15, v41, v40 row_ror:8 row_mask:0xf bank_mask:0x2
    v_add_f32_dpp v40, v31, v30 row_ror:12 row_mask:0xf bank_mask:0xf
    v_add_f32_dpp v41, v29, v28 row_ror:12 row_mask:0xf bank_mask:0xf
    v_mfma_f32_16x16x32_bf16 v[28:31], a[124:127], v[8:11], 0
    s_nop 0
    v_add_f32_dpp v14, v41, v40 row_ror:8 row_mask:0xf bank_mask:0x4
    v_add_f32_dpp v40, v35, v34 row_ror:12 row_mask:0xf bank_mask:0xf
    v_add_f32_dpp v41, v33, v32 row_ror:12 row_mask:0xf bank_mask:0xf
    s_waitcnt vmcnt(43)
    v_mfma_f32_16x16x32_bf16 v[32:35], a[128:131], v[8:11], 0
    v_add_f32_dpp v15, v41, v40 row_ror:8 row_mask:0xf bank_mask:0x4
    v_add_f32_dpp v40, v36, v39 row_ror:12 row_mask:0xf bank_mask:0xf
    v_add_f32_dpp v41, v38, v37 row_ror:12 row_mask:0xf bank_mask:0xf
    s_waitcnt vmcnt(42)
    v_mfma_f32_16x16x32_bf16 v[36:39], a[132:135], v[8:11], 0
    v_add_f32_dpp v14, v41, v40 row_ror:8 row_mask:0xf bank_mask:0x8
    v_add_f32_dpp v40, v28, v31 row_ror:12 row_mask:0xf bank_mask:0xf
    v_add_f32_dpp v41, v30, v29 row_ror:12 row_mask:0xf bank_mask:0xf
    s_waitcnt vmcnt(41)
    v_mfma_f32_16x16x32_bf16 v[28:31], a[136:139], v[8:11], 0
    v_add_f32_dpp v15, v41, v40 row_ror:8 row_mask:0xf bank_mask:0x8
    v_add_f32_dpp v40, v33, v32 row_ror:12 row_mask:0xf bank_mask:0xf
    v_add_f32_dpp v41, v35, v34 row_ror:12 row_mask:0xf bank_mask:0xf
    s_waitcnt vmcnt(40)
    v_mfma_f32_16x16x32_bf16 v[32:35], a[140:143], v[8:11], 0
    v_add_f32_dpp v16, v41, v40 row_ror:8 row_mask:0xf bank_mask:0x1
    v_add_f32_dpp v40, v37, v36 row_ror:12 row_mask:0xf bank_mask:0xf
    v_add_f32_dpp v41, v39, v38 row_ror:12 row_mask:0xf bank_mask:0xf
    s_waitcnt vmcnt(39)
    v_mfma_f32_16x16x32_bf16 v[36:39], v[96:99], v[8:11], 0
    v_add_f32_dpp v17, v41, v40 row_ror:8 row_mask:0xf bank_mask:0x1
    v_add_f32_dpp v40, v30, v29 row_ror:12 row_mask:0xf bank_mask:0xf
    v_add_f32_dpp v41, v28, v31 row_ror:12 row_mask:0xf bank_mask:0xf
    s_waitcnt vmcnt(38)
    v_mfma_f32_16x16x32_bf16 v[28:31], v[100:103], v[8:11], 0
    v_add_f32_dpp v16, v41, v40 row_ror:8 row_mask:0xf bank_mask:0x2
    v_add_f32_dpp v40, v34, v33 row_ror:12 row_mask:0xf bank_mask:0xf
    v_add_f32_dpp v41, v32, v35 row_ror:12 row_mask:0xf bank_mask:0xf
    s_waitcnt vmcnt(37)
    v_mfma_f32_16x16x32_bf16 v[32:35], v[104:107], v[8:11], 0
    v_add_f32_dpp v17, v41, v40 row_ror:8 row_mask:0xf bank_mask:0x2
    v_add_f32_dpp v40, v39, v38 row_ror:12 row_mask:0xf bank_mask:0xf
    v_add_f32_dpp v41, v37, v36 row_ror:12 row_mask:0xf bank_mask:0xf
    s_waitcnt vmcnt(36)
    v_mfma_f32_16x16x32_bf16 v[36:39], v[108:111], v[8:11], 0
    s_waitcnt vmcnt(35)
    v_add_f32_dpp v16, v41, v40 row_ror:8 row_mask:0xf bank_mask:0x4
    v_add_f32_dpp v40, v31, v30 row_ror:12 row_mask:0xf bank_mask:0xf
    v_add_f32_dpp v41, v29, v28 row_ror:12 row_mask:0xf bank_mask:0xf
    v_mfma_f32_16x16x32_bf16 v[28:31], v[112:115], v[8:11], 0
    s_nop 0
    v_add_f32_dpp v17, v41, v40 row_ror:8 row_mask:0xf bank_mask:0x4
    v_add_f32_dpp v40, v32, v35 row_ror:12 row_mask:0xf bank_mask:0xf
    v_add_f32_dpp v41, v34, v33 row_ror:12 row_mask:0xf bank_mask:0xf
    s_waitcnt vmcnt(34)
    v_mfma_f32_16x16x32_bf16 v[32:35], v[116:119], v[8:11], 0
    v_add_f32_dpp v16, v41, v40 row_ror:8 row_mask:0xf bank_mask:0x8
    v_add_f32_dpp v40, v36, v39 row_ror:12 row_mask:0xf bank_mask:0xf
    v_add_f32_dpp v41, v38, v37 row_ror:12 row_mask:0xf bank_mask:0xf
    s_waitcnt vmcnt(33)
    v_mfma_f32_16x16x32_bf16 v[36:39], v[120:123], v[8:11], 0
    v_add_f32_dpp v17, v41, v40 row_ror:8 row_mask:0xf bank_mask:0x8
    v_add_f32_dpp v40, v29, v28 row_ror:12 row_mask:0xf bank_mask:0xf
    v_add_f32_dpp v41, v31, v30 row_ror:12 row_mask:0xf bank_mask:0xf
    s_waitcnt vmcnt(32)
    v_mfma_f32_16x16x32_bf16 v[28:31], v[124:127], v[8:11], 0
    v_add_f32_dpp v18, v41, v40 row_ror:8 row_mask:0xf bank_mask:0x1
    v_add_f32_dpp v40, v33, v32 row_ror:12 row_mask:0xf bank_mask:0xf
    v_add_f32_dpp v41, v35, v34 row_ror:12 row_mask:0xf bank_mask:0xf
    s_waitcnt vmcnt(31)
    v_mfma_f32_16x16x32_bf16 v[32:35], v[128:131], v[8:11], 0
    v_add_f32_dpp v19, v41, v40 row_ror:8 row_mask:0xf bank_mask:0x1
    v_add_f32_dpp v40, v38, v37 row_ror:12 row_mask:0xf bank_mask:0xf
    v_add_f32_dpp v41, v36, v39 row_ror:12 row_mask:0xf bank_mask:0xf
    s_waitcnt vmcnt(30)
    v_mfma_f32_16x16x32_bf16 v[36:39], v[132:135], v[8:11], 0
    v_add_f32_dpp v18, v41, v40 row_ror:8 row_mask:0xf bank_mask:0x2
    v_add_f32_dpp v40, v30, v29 row_ror:12 row_mask:0xf bank_mask:0xf
    v_add_f32_dpp v41, v28, v31 row_ror:12 row_mask:0xf bank_mask:0xf
    s_waitcnt vmcnt(29)
    v_mfma_f32_16x16x32_bf16 v[28:31], v[136:139], v[8:11], 0
    v_add_f32_dpp v19, v41, v40 row_ror:8 row_mask:0xf bank_mask:0x2
    v_add_f32_dpp v40, v35, v34 row_ror:12 row_mask:0xf bank_mask:0xf
    v_add_f32_dpp v41, v33, v32 row_ror:12 row_mask:0xf bank_mask:0xf
    s_waitcnt vmcnt(28)
    v_mfma_f32_16x16x32_bf16 v[32:35], v[140:143], v[8:11], 0
    v_add_f32_dpp v18, v41, v40 row_ror:8 row_mask:0xf bank_mask:0x4
    v_add_f32_dpp v40, v39, v38 row_ror:12 row_mask:0xf bank_mask:0xf
    v_add_f32_dpp v41, v37, v36 row_ror:12 row_mask:0xf bank_mask:0xf
    s_waitcnt vmcnt(27)
    v_mfma_f32_16x16x32_bf16 v[36:39], v[144:147], v[8:11], 0
    v_add_f32_dpp v19, v41, v40 row_ror:8 row_mask:0xf bank_mask:0x4
    v_add_f32_dpp v40, v28, v31 row_ror:12 row_mask:0xf bank_mask:0xf
    v_add_f32_dpp v41, v30, v29 row_ror:12 row_mask:0xf bank_mask:0xf
    s_waitcnt vmcnt(26)
    v_mfma_f32_16x16x32_bf16 v[28:31], v[148:151], v[8:11], 0
    s_waitcnt vmcnt(25)
    v_add_f32_dpp v18, v41, v40 row_ror:8 row_mask:0xf bank_mask:0x8
    v_add_f32_dpp v40, v32, v35 row_ror:12 row_mask:0xf bank_mask:0xf
    v_add_f32_dpp v41, v34, v33 row_ror:12 row_mask:0xf bank_mask:0xf
    v_mfma_f32_16x16x32_bf16 v[32:35], v[152:155], v[8:11], 0
    s_nop 0
    v_add_f32_dpp v19, v41, v40 row_ror:8 row_mask:0xf bank_mask:0x8
    v_add_f32_dpp v40, v37, v36 row_ror:12 row_mask:0xf bank_mask:0xf
    v_add_f32_dpp v41, v39, v38 row_ror:12 row_mask:0xf bank_mask:0xf
    s_waitcnt vmcnt(24)
    v_mfma_f32_16x16x32_bf16 v[36:39], v[156:159], v[8:11], 0
    v_add_f32_dpp v20, v41, v40 row_ror:8 row_mask:0xf bank_mask:0x1
    v_add_f32_dpp v40, v29, v28 row_ror:12 row_mask:0xf bank_mask:0xf
    v_add_f32_dpp v41, v31, v30 row_ror:12 row_mask:0xf bank_mask:0xf
    s_waitcnt vmcnt(23)
    v_mfma_f32_16x16x32_bf16 v[28:31], v[160:163], v[8:11], 0
    v_add_f32_dpp v21, v41, v40 row_ror:8 row_mask:0xf bank_mask:0x1
    v_add_f32_dpp v40, v34, v33 row_ror:12 row_mask:0xf bank_mask:0xf
    v_add_f32_dpp v41, v32, v35 row_ror:12 row_mask:0xf bank_mask:0xf
    s_waitcnt vmcnt(22)
    v_mfma_f32_16x16x32_bf16 v[32:35], v[164:167], v[8:11], 0
    v_add_f32_dpp v20, v41, v40 row_ror:8 row_mask:0xf bank_mask:0x2
    v_add_f32_dpp v40, v38, v37 row_ror:12 row_mask:0xf bank_mask:0xf
    v_add_f32_dpp v41, v36, v39 row_ror:12 row_mask:0xf bank_mask:0xf
    s_waitcnt vmcnt(21)
    v_mfma_f32_16x16x32_bf16 v[36:39], v[168:171], v[8:11], 0
    v_add_f32_dpp v21, v41, v40 row_ror:8 row_mask:0xf bank_mask:0x2
    v_add_f32_dpp v40, v31, v30 row_ror:12 row_mask:0xf bank_mask:0xf
    v_add_f32_dpp v41, v29, v28 row_ror:12 row_mask:0xf bank_mask:0xf
    s_waitcnt vmcnt(20)
    v_mfma_f32_16x16x32_bf16 v[28:31], v[172:175], v[8:11], 0
    v_add_f32_dpp v20, v41, v40 row_ror:8 row_mask:0xf bank_mask:0x4
    v_add_f32_dpp v40, v35, v34 row_ror:12 row_mask:0xf bank_mask:0xf
    v_add_f32_dpp v41, v33, v32 row_ror:12 row_mask:0xf bank_mask:0xf
    s_waitcnt vmcnt(19)
    v_mfma_f32_16x16x32_bf16 v[32:35], v[176:179], v[8:11], 0
    v_add_f32_dpp v21, v41, v40 row_ror:8 row_mask:0xf bank_mask:0x4
    v_add_f32_dpp v40, v36, v39 row_ror:12 row_mask:0xf bank_mask:0xf
    v_add_f32_dpp v41, v38, v37 row_ror:12 row_mask:0xf bank_mask:0xf
    s_waitcnt vmcnt(18)
    v_mfma_f32_16x16x32_bf16 v[36:39], v[180:183], v[8:11], 0
    v_add_f32_dpp v20, v41, v40 row_ror:8 row_mask:0xf bank_mask:0x8
    v_add_f32_dpp v40, v28, v31 row_ror:12 row_mask:0xf bank_mask:0xf
    v_add_f32_dpp v41, v30, v29 row_ror:12 row_mask:0xf bank_mask:0xf
    s_waitcnt vmcnt(17)
    v_mfma_f32_16x16x32_bf16 v[28:31], v[184:187], v[8:11], 0
    v_add_f32_dpp v21, v41, v40 row_ror:8 row_mask:0xf bank_mask:0x8
    v_add_f32_dpp v40, v33, v32 row_ror:12 row_mask:0xf bank_mask:0xf
    v_add_f32_dpp v41, v35, v34 row_ror:12 row_mask:0xf bank_mask:0xf
    s_waitcnt vmcnt(16)
    v_mfma_f32_16x16x32_bf16 v[32:35], v[188:191], v[8:11], 0
    s_waitcnt vmcnt(15)
    v_add_f32_dpp v22, v41, v40 row_ror:8 row_mask:0xf bank_mask:0x1
    v_add_f32_dpp v40, v37, v36 row_ror:12 row_mask:0xf bank_mask:0xf
    v_add_f32_dpp v41, v39, v38 row_ror:12 row_mask:0xf bank_mask:0xf
    v_mfma_f32_16x16x32_bf16 v[36:39], v[192:195], v[8:11], 0
    s_nop 0
    v_add_f32_dpp v23, v41, v40 row_ror:8 row_mask:0xf bank_mask:0x1
    v_add_f32_dpp v40, v30, v29 row_ror:12 row_mask:0xf bank_mask:0xf
    v_add_f32_dpp v41, v28, v31 row_ror:12 row_mask:0xf bank_mask:0xf
    s_waitcnt vmcnt(14)
    v_mfma_f32_16x16x32_bf16 v[28:31], v[196:199], v[8:11], 0
    v_add_f32_dpp v22, v41, v40 row_ror:8 row_mask:0xf bank_mask:0x2
    v_add_f32_dpp v40, v34, v33 row_ror:12 row_mask:0xf bank_mask:0xf
    v_add_f32_dpp v41, v32, v35 row_ror:12 row_mask:0xf bank_mask:0xf
    s_waitcnt vmcnt(13)
    v_mfma_f32_16x16x32_bf16 v[32:35], v[200:203], v[8:11], 0
    v_add_f32_dpp v23, v41, v40 row_ror:8 row_mask:0xf bank_mask:0x2
    v_add_f32_dpp v40, v39, v38 row_ror:12 row_mask:0xf bank_mask:0xf
    v_add_f32_dpp v41, v37, v36 row_ror:12 row_mask:0xf bank_mask:0xf
    s_waitcnt vmcnt(12)
    v_mfma_f32_16x16x32_bf16 v[36:39], v[204:207], v[8:11], 0
    v_add_f32_dpp v22, v41, v40 row_ror:8 row_mask:0xf bank_mask:0x4
    v_add_f32_dpp v40, v31, v30 row_ror:12 row_mask:0xf bank_mask:0xf
    v_add_f32_dpp v41, v29, v28 row_ror:12 row_mask:0xf bank_mask:0xf
    s_waitcnt vmcnt(11)
    v_mfma_f32_16x16x32_bf16 v[28:31], v[208:211], v[8:11], 0
    s_mov_b32 s48, 245760
    buffer_load_dwordx4 a[148:151], v1, s[16:19], s48 offen offset:0 nt
    v_add_f32_dpp v23, v41, v40 row_ror:8 row_mask:0xf bank_mask:0x4
    v_add_f32_dpp v40, v32, v35 row_ror:12 row_mask:0xf bank_mask:0xf
    v_add_f32_dpp v41, v34, v33 row_ror:12 row_mask:0xf bank_mask:0xf
    s_waitcnt vmcnt(11)
    v_mfma_f32_16x16x32_bf16 v[32:35], v[212:215], v[8:11], 0
    buffer_load_dwordx4 a[152:155], v1, s[16:19], s48 offen offset:1024 nt
    v_add_f32_dpp v22, v41, v40 row_ror:8 row_mask:0xf bank_mask:0x8
    v_add_f32_dpp v40, v36, v39 row_ror:12 row_mask:0xf bank_mask:0xf
    v_add_f32_dpp v41, v38, v37 row_ror:12 row_mask:0xf bank_mask:0xf
    s_waitcnt vmcnt(11)
    v_mfma_f32_16x16x32_bf16 v[36:39], v[216:219], v[8:11], 0
    buffer_load_dwordx4 a[156:159], v1, s[16:19], s48 offen offset:2048 nt
    v_add_f32_dpp v23, v41, v40 row_ror:8 row_mask:0xf bank_mask:0x8
    v_add_f32_dpp v40, v29, v28 row_ror:12 row_mask:0xf bank_mask:0xf
    v_add_f32_dpp v41, v31, v30 row_ror:12 row_mask:0xf bank_mask:0xf
    s_waitcnt vmcnt(11)
    v_mfma_f32_16x16x32_bf16 v[28:31], v[220:223], v[8:11], 0
    buffer_load_dwordx4 a[160:163], v1, s[16:19], s48 offen offset:3072 nt
    s_waitcnt vmcnt(11)
    s_mov_b32 s48, 0
    buffer_load_dwordx4 v[96:99], v2, s[20:23], s48 offen offset:0
    v_add_f32_dpp v24, v41, v40 row_ror:8 row_mask:0xf bank_mask:0x1
    v_add_f32_dpp v40, v33, v32 row_ror:12 row_mask:0xf bank_mask:0xf
    v_add_f32_dpp v41, v35, v34 row_ror:12 row_mask:0xf bank_mask:0xf
    v_mfma_f32_16x16x32_bf16 v[32:35], v[224:227], v[8:11], 0
    s_nop 0
    v_add_f32_dpp v25, v41, v40 row_ror:8 row_mask:0xf bank_mask:0x1
    v_add_f32_dpp v40, v38, v37 row_ror:12 row_mask:0xf bank_mask:0xf
    v_add_f32_dpp v41, v36, v39 row_ror:12 row_mask:0xf bank_mask:0xf
    s_waitcnt vmcnt(11)
    v_mfma_f32_16x16x32_bf16 v[36:39], v[228:231], v[8:11], 0
    buffer_load_dwordx4 v[100:103], v2, s[20:23], s48 offen offset:1024
    v_add_f32_dpp v24, v41, v40 row_ror:8 row_mask:0xf bank_mask:0x2
    v_add_f32_dpp v40, v30, v29 row_ror:12 row_mask:0xf bank_mask:0xf
    v_add_f32_dpp v41, v28, v31 row_ror:12 row_mask:0xf bank_mask:0xf
    s_waitcnt vmcnt(11)
    v_mfma_f32_16x16x32_bf16 v[28:31], v[232:235], v[8:11], 0
    buffer_load_dwordx4 v[104:107], v2, s[20:23], s48 offen offset:2048
    v_add_f32_dpp v25, v41, v40 row_ror:8 row_mask:0xf bank_mask:0x2
    v_add_f32_dpp v40, v35, v34 row_ror:12 row_mask:0xf bank_mask:0xf
    v_add_f32_dpp v41, v33, v32 row_ror:12 row_mask:0xf bank_mask:0xf
    s_waitcnt vmcnt(11)
    v_mfma_f32_16x16x32_bf16 v[32:35], v[236:239], v[8:11], 0
    buffer_load_dwordx4 v[108:111], v2, s[20:23], s48 offen offset:3072
    v_add_f32_dpp v24, v41, v40 row_ror:8 row_mask:0xf bank_mask:0x4
    v_add_f32_dpp v40, v39, v38 row_ror:12 row_mask:0xf bank_mask:0xf
    v_add_f32_dpp v41, v37, v36 row_ror:12 row_mask:0xf bank_mask:0xf
    s_waitcnt vmcnt(11)
    v_mfma_f32_16x16x32_bf16 v[36:39], v[240:243], v[8:11], 0
    s_mov_b32 s48, 16384
    buffer_load_dwordx4 v[112:115], v2, s[20:23], s48 offen offset:0
    v_add_f32_dpp v25, v41, v40 row_ror:8 row_mask:0xf bank_mask:0x4
    v_add_f32_dpp v40, v28, v31 row_ror:12 row_mask:0xf bank_mask:0xf
    v_add_f32_dpp v41, v30, v29 row_ror:12 row_mask:0xf bank_mask:0xf
    s_waitcnt vmcnt(11)
    v_mfma_f32_16x16x32_bf16 v[28:31], v[244:247], v[8:11], 0
    buffer_load_dwordx4 v[116:119], v2, s[20:23], s48 offen offset:1024
    v_add_f32_dpp v24, v41, v40 row_ror:8 row_mask:0xf bank_mask:0x8
    v_add_f32_dpp v40, v32, v35 row_ror:12 row_mask:0xf bank_mask:0xf
    v_add_f32_dpp v41, v34, v33 row_ror:12 row_mask:0xf bank_mask:0xf
    s_waitcnt vmcnt(11)
    v_mfma_f32_16x16x32_bf16 v[32:35], v[248:251], v[8:11], 0
    buffer_load_dwordx4 v[120:123], v2, s[20:23], s48 offen offset:2048
    v_add_f32_dpp v25, v41, v40 row_ror:8 row_mask:0xf bank_mask:0x8
    v_add_f32_dpp v40, v37, v36 row_ror:12 row_mask:0xf bank_mask:0xf
    v_add_f32_dpp v41, v39, v38 row_ror:12 row_mask:0xf bank_mask:0xf
    s_waitcnt vmcnt(11)
    v_mfma_f32_16x16x32_bf16 v[36:39], v[252:255], v[8:11], 0
    buffer_load_dwordx4 v[124:127], v2, s[20:23], s48 offen offset:3072
    s_waitcnt vmcnt(11)
    s_mov_b32 s48, 32768
    buffer_load_dwordx4 v[128:131], v2, s[20:23], s48 offen offset:0
    v_add_f32_dpp v26, v41, v40 row_ror:8 row_mask:0xf bank_mask:0x1
    v_add_f32_dpp v40, v29, v28 row_ror:12 row_mask:0xf bank_mask:0xf
    v_add_f32_dpp v41, v31, v30 row_ror:12 row_mask:0xf bank_mask:0xf
    v_mfma_f32_16x16x32_bf16 v[28:31], a[148:151], v[8:11], 0
    s_nop 0
    v_add_f32_dpp v27, v41, v40 row_ror:8 row_mask:0xf bank_mask:0x1
    v_add_f32_dpp v40, v34, v33 row_ror:12 row_mask:0xf bank_mask:0xf
    v_add_f32_dpp v41, v32, v35 row_ror:12 row_mask:0xf bank_mask:0xf
    s_waitcnt vmcnt(11)
    v_mfma_f32_16x16x32_bf16 v[32:35], a[152:155], v[8:11], 0
    buffer_load_dwordx4 v[132:135], v2, s[20:23], s48 offen offset:1024
    v_add_f32_dpp v26, v41, v40 row_ror:8 row_mask:0xf bank_mask:0x2
    v_add_f32_dpp v40, v38, v37 row_ror:12 row_mask:0xf bank_mask:0xf
    v_add_f32_dpp v41, v36, v39 row_ror:12 row_mask:0xf bank_mask:0xf
    s_waitcnt vmcnt(11)
    v_mfma_f32_16x16x32_bf16 v[36:39], a[156:159], v[8:11], 0
    buffer_load_dwordx4 v[136:139], v2, s[20:23], s48 offen offset:2048
    v_add_f32_dpp v27, v41, v40 row_ror:8 row_mask:0xf bank_mask:0x2
    v_add_f32_dpp v40, v31, v30 row_ror:12 row_mask:0xf bank_mask:0xf
    v_add_f32_dpp v41, v29, v28 row_ror:12 row_mask:0xf bank_mask:0xf
    s_waitcnt vmcnt(11)
    v_mfma_f32_16x16x32_bf16 v[28:31], a[160:163], v[8:11], 0
    buffer_load_dwordx4 v[140:143], v2, s[20:23], s48 offen offset:3072
    v_add_f32_dpp v26, v41, v40 row_ror:8 row_mask:0xf bank_mask:0x4
    v_add_f32_dpp v40, v35, v34 row_ror:12 row_mask:0xf bank_mask:0xf
    v_add_f32_dpp v41, v33, v32 row_ror:12 row_mask:0xf bank_mask:0xf
    s_nop 1
    v_add_f32_dpp v27, v41, v40 row_ror:8 row_mask:0xf bank_mask:0x4
    v_add_f32_dpp v40, v36, v39 row_ror:12 row_mask:0xf bank_mask:0xf
    v_add_f32_dpp v41, v38, v37 row_ror:12 row_mask:0xf bank_mask:0xf
    s_nop 1
    v_add_f32_dpp v26, v41, v40 row_ror:8 row_mask:0xf bank_mask:0x8
    v_add_f32_dpp v40, v28, v31 row_ror:12 row_mask:0xf bank_mask:0xf
    v_add_f32_dpp v41, v30, v29 row_ror:12 row_mask:0xf bank_mask:0xf
    s_nop 1
    v_add_f32_dpp v27, v41, v40 row_ror:8 row_mask:0xf bank_mask:0x8
    s_mov_b32 s61, 1081344
    s_waitcnt lgkmcnt(0)
    s_call_b64 s[86:87], S_sm
    v_lshrrev_b32 v7, 1, v0
    v_lshlrev_b32 v7, 10, v7
    v_and_b32 v52, 1, v0
    v_lshl_add_u32 v7, v52, 4, v7
    s_add_u32 s68, s79, 0
    s_lshl_b32 m0, s3, 11
    s_nop 0
    buffer_load_dwordx4 v7, s[40:43], s68 offen  lds
    s_add_u32 s68, s79, 32768
    s_lshl_b32 m0, s3, 11
    s_add_u32 m0, m0, 1024
    s_nop 0
    buffer_load_dwordx4 v7, s[40:43], s68 offen  lds
    v_mov_b32 v28, 0
    v_mov_b32 v29, 0
    v_mov_b32 v30, 0
    v_mov_b32 v31, 0
    v_mov_b32 v32, 0
    v_mov_b32 v33, 0
    v_mov_b32 v34, 0
    v_mov_b32 v35, 0
    v_mov_b32 v36, 0
    v_mov_b32 v37, 0
    v_mov_b32 v38, 0
    v_mov_b32 v39, 0
    v_mov_b32 v40, 0
    v_mov_b32 v41, 0
    v_mov_b32 v42, 0
    v_mov_b32 v43, 0
    v_mov_b32_dpp v28, v12 quad_perm:[0,1,2,3] row_mask:0xf bank_mask:0x1
    v_mov_b32_dpp v29, v12 row_shl:4 row_mask:0xf bank_mask:0x1
    v_mov_b32_dpp v30, v12 row_shl:8 row_mask:0xf bank_mask:0x1
    v_mov_b32_dpp v31, v12 row_shl:12 row_mask:0xf bank_mask:0x1
    v_mov_b32_dpp v32, v12 row_shr:4 row_mask:0xf bank_mask:0x2
    v_mov_b32_dpp v33, v12 quad_perm:[0,1,2,3] row_mask:0xf bank_mask:0x2
    v_mov_b32_dpp v34, v12 row_shl:4 row_mask:0xf bank_mask:0x2
    v_mov_b32_dpp v35, v12 row_shl:8 row_mask:0xf bank_mask:0x2
    v_mov_b32_dpp v36, v12 row_shr:8 row_mask:0xf bank_mask:0x4
    v_mov_b32_dpp v37, v12 row_shr:4 row_mask:0xf bank_mask:0x4
    v_mov_b32_dpp v38, v12 quad_perm:[0,1,2,3] row_mask:0xf bank_mask:0x4
    v_mov_b32_dpp v39, v12 row_shl:4 row_mask:0xf bank_mask:0x4
    v_mov_b32_dpp v40, v12 row_shr:12 row_mask:0xf bank_mask:0x8
    v_mov_b32_dpp v41, v12 row_shr:8 row_mask:0xf bank_mask:0x8
    v_mov_b32_dpp v42, v12 row_shr:4 row_mask:0xf bank_mask:0x8
    v_mov_b32_dpp v43, v12 quad_perm:[0,1,2,3] row_mask:0xf bank_mask:0x8
    s_waitcnt vmcnt(13)
    s_mov_b32 s48, 49152
    buffer_load_dwordx4 v[144:147], v2, s[20:23], s48 offen offset:0
    s_waitcnt vmcnt(13)
    buffer_load_dwordx4 v[148:151], v2, s[20:23], s48 offen offset:1024
    s_waitcnt vmcnt(13)
    buffer_load_dwordx4 v[152:155], v2, s[20:23], s48 offen offset:2048
    s_waitcnt vmcnt(13)
    buffer_load_dwordx4 v[156:159], v2, s[20:23], s48 offen offset:3072
    s_waitcnt vmcnt(13)
    s_mov_b32 s48, 65536
    buffer_load_dwordx4 v[160:163], v2, s[20:23], s48 offen offset:0
    s_waitcnt vmcnt(13)
    buffer_load_dwordx4 a[164:167], v2, s[20:23], s48 offen offset:1024
    s_waitcnt vmcnt(13)
    buffer_load_dwordx4 a[168:171], v2, s[20:23], s48 offen offset:2048
    s_waitcnt vmcnt(13)
    buffer_load_dwordx4 a[172:175], v2, s[20:23], s48 offen offset:3072
    v_perm_b32 v20, v100, v96, s74
    v_perm_b32 v21, v108, v104, s74
    v_perm_b32 v22, v116, v112, s74
    v_perm_b32 v23, v124, v120, s74
    s_waitcnt vmcnt(13)
    s_mov_b32 s48, 81920
    buffer_load_dwordx4 a[176:179], v2, s[20:23], s48 offen offset:0
    s_waitcnt vmcnt(13)
    buffer_load_dwordx4 a[180:183], v2, s[20:23], s48 offen offset:1024
    s_waitcnt vmcnt(13)
    buffer_load_dwordx4 a[184:187], v2, s[20:23], s48 offen offset:2048
    s_waitcnt vmcnt(13)
    buffer_load_dwordx4 a[188:191], v2, s[20:23], s48 offen offset:3072
    v_perm_b32 v24, v100, v96, s75
    v_perm_b32 v25, v108, v104, s75
    v_perm_b32 v26, v116, v112, s75
    v_perm_b32 v27, v124, v120, s75
    v_mfma_f32_16x16x32_bf16 v[44:47], v[28:31], v[20:23], 0
    v_perm_b32 v20, v101, v97, s74
    v_perm_b32 v21, v109, v105, s74
    v_perm_b32 v22, v117, v113, s74
    v_perm_b32 v23, v125, v121, s74
    v_mfma_f32_16x16x32_bf16 v[44:47], v[32:35], v[24:27], v[44:47]
    v_perm_b32 v24, v101, v97, s75
    v_perm_b32 v25, v109, v105, s75
    v_perm_b32 v26, v117, v113, s75
    v_perm_b32 v27, v125, v121, s75
    v_mfma_f32_16x16x32_bf16 v[44:47], v[36:39], v[20:23], v[44:47]
    v_perm_b32 v20, v102, v98, s74
    v_perm_b32 v21, v110, v106, s74
    v_perm_b32 v22, v118, v114, s74
    v_perm_b32 v23, v126, v122, s74
    v_mfma_f32_16x16x32_bf16 v[44:47], v[40:43], v[24:27], v[44:47]
    v_perm_b32 v24, v102, v98, s75
    v_perm_b32 v25, v110, v106, s75
    v_perm_b32 v26, v118, v114, s75
    v_perm_b32 v27, v126, v122, s75
    v_mfma_f32_16x16x32_bf16 v[48:51], v[28:31], v[20:23], 0
    v_perm_b32 v20, v103, v99, s74
    v_perm_b32 v21, v111, v107, s74
    v_perm_b32 v22, v119, v115, s74
    v_perm_b32 v23, v127, v123, s74
    v_mfma_f32_16x16x32_bf16 v[48:51], v[32:35], v[24:27], v[48:51]
    v_perm_b32 v24, v103, v99, s75
    v_perm_b32 v25, v111, v107, s75
    v_perm_b32 v26, v119, v115, s75
    v_perm_b32 v27, v127, v123, s75
    v_mfma_f32_16x16x32_bf16 v[48:51], v[36:39], v[20:23], v[48:51]
    s_waitcnt vmcnt(11)
    s_mov_b32 s48, 98304
    buffer_load_dwordx4 a[108:111], v2, s[20:23], s48 offen offset:0
    v_mfma_f32_16x16x32_bf16 v[48:51], v[40:43], v[24:27], v[48:51]
    s_nop 6
    s_call_b64 s[86:87], S_sm2
    v_mov_b32_dpp v28, v13 quad_perm:[0,1,2,3] row_mask:0xf bank_mask:0x1
    v_mov_b32_dpp v29, v13 row_shl:4 row_mask:0xf bank_mask:0x1
    v_mov_b32_dpp v30, v13 row_shl:8 row_mask:0xf bank_mask:0x1
    v_mov_b32_dpp v31, v13 row_shl:12 row_mask:0xf bank_mask:0x1
    v_mov_b32_dpp v32, v13 row_shr:4 row_mask:0xf bank_mask:0x2
    v_mov_b32_dpp v33, v13 quad_perm:[0,1,2,3] row_mask:0xf bank_mask:0x2
    v_mov_b32_dpp v34, v13 row_shl:4 row_mask:0xf bank_mask:0x2
    v_mov_b32_dpp v35, v13 row_shl:8 row_mask:0xf bank_mask:0x2
    v_mov_b32_dpp v36, v13 row_shr:8 row_mask:0xf bank_mask:0x4
    v_mov_b32_dpp v37, v13 row_shr:4 row_mask:0xf bank_mask:0x4
    v_mov_b32_dpp v38, v13 quad_perm:[0,1,2,3] row_mask:0xf bank_mask:0x4
    v_mov_b32_dpp v39, v13 row_shl:4 row_mask:0xf bank_mask:0x4
    v_mov_b32_dpp v40, v13 row_shr:12 row_mask:0xf bank_mask:0x8
    v_mov_b32_dpp v41, v13 row_shr:8 row_mask:0xf bank_mask:0x8
    v_mov_b32_dpp v42, v13 row_shr:4 row_mask:0xf bank_mask:0x8
    v_mov_b32_dpp v43, v13 quad_perm:[0,1,2,3] row_mask:0xf bank_mask:0x8
    s_waitcnt vmcnt(11)
    s_mov_b32 s48, 98304
    buffer_load_dwordx4 v[96:99], v2, s[20:23], s48 offen offset:1024
    s_waitcnt vmcnt(11)
    buffer_load_dwordx4 v[100:103], v2, s[20:23], s48 offen offset:2048
    s_waitcnt vmcnt(11)
    buffer_load_dwordx4 v[104:107], v2, s[20:23], s48 offen offset:3072
    v_perm_b32 v20, v132, v128, s74
    v_perm_b32 v21, v140, v136, s74
    v_perm_b32 v22, v148, v144, s74
    v_perm_b32 v23, v156, v152, s74
    v_perm_b32 v24, v132, v128, s75
    v_perm_b32 v25, v140, v136, s75
    v_perm_b32 v26, v148, v144, s75
    v_perm_b32 v27, v156, v152, s75
    v_mfma_f32_16x16x32_bf16 v[44:47], v[28:31], v[20:23], v[44:47]
    v_perm_b32 v20, v133, v129, s74
    v_perm_b32 v21, v141, v137, s74
    v_perm_b32 v22, v149, v145, s74
    v_perm_b32 v23, v157, v153, s74
    v_mfma_f32_16x16x32_bf16 v[44:47], v[32:35], v[24:27], v[44:47]
    v_perm_b32 v24, v133, v129, s75
    v_perm_b32 v25, v141, v137, s75
    v_perm_b32 v26, v149, v145, s75
    v_perm_b32 v27, v157, v153, s75
    v_mfma_f32_16x16x32_bf16 v[44:47], v[36:39], v[20:23], v[44:47]
    v_perm_b32 v20, v134, v130, s74
    v_perm_b32 v21, v142, v138, s74
    v_perm_b32 v22, v150, v146, s74
    v_perm_b32 v23, v158, v154, s74
    v_mfma_f32_16x16x32_bf16 v[44:47], v[40:43], v[24:27], v[44:47]
    s_waitcnt vmcnt(11)
    s_mov_b32 s48, 114688
    buffer_load_dwordx4 v[108:111], v2, s[20:23], s48 offen offset:0
    v_perm_b32 v24, v134, v130, s75
    v_perm_b32 v25, v142, v138, s75
    v_perm_b32 v26, v150, v146, s75
    v_perm_b32 v27, v158, v154, s75
    v_mfma_f32_16x16x32_bf16 v[48:51], v[28:31], v[20:23], v[48:51]
    v_perm_b32 v20, v135, v131, s74
    v_perm_b32 v21, v143, v139, s74
    v_perm_b32 v22, v151, v147, s74
    v_perm_b32 v23, v159, v155, s74
    v_mfma_f32_16x16x32_bf16 v[48:51], v[32:35], v[24:27], v[48:51]
    v_perm_b32 v24, v135, v131, s75
    v_perm_b32 v25, v143, v139, s75
    v_perm_b32 v26, v151, v147, s75
    v_perm_b32 v27, v159, v155, s75
    v_mfma_f32_16x16x32_bf16 v[48:51], v[36:39], v[20:23], v[48:51]
    s_nop 0
    v_mfma_f32_16x16x32_bf16 v[48:51], v[40:43], v[24:27], v[48:51]
    v_lshrrev_b32 v7, 4, v0
    v_lshlrev_b32 v7, 8, v7
    v_and_b32 v52, 15, v0
    v_lshl_add_u32 v7, v52, 3, v7
    s_lshl_b32 s68, s3, 11
    v_add_u32 v7, s68, v7
    ds_read_b64_tr_b16 a[208:209], v7 offset:0
    ds_read_b64_tr_b16 a[210:211], v7 offset:128
    ds_read_b64_tr_b16 a[212:213], v7 offset:1024
    ds_read_b64_tr_b16 a[214:215], v7 offset:1152
    s_waitcnt lgkmcnt(0)
    v_lshrrev_b32 v7, 1, v0
    v_lshlrev_b32 v7, 10, v7
    v_and_b32 v52, 1, v0
    v_lshl_add_u32 v7, v52, 4, v7
    s_add_u32 s68, s79, 65536
    s_lshl_b32 m0, s3, 11
    s_nop 0
    buffer_load_dwordx4 v7, s[40:43], s68 offen  lds
    s_add_u32 s68, s79, 98304
    s_lshl_b32 m0, s3, 11
    s_add_u32 m0, m0, 1024
    s_nop 0
    buffer_load_dwordx4 v7, s[40:43], s68 offen  lds
    v_mov_b32_dpp v28, v14 quad_perm:[0,1,2,3] row_mask:0xf bank_mask:0x1
    v_mov_b32_dpp v29, v14 row_shl:4 row_mask:0xf bank_mask:0x1
    v_mov_b32_dpp v30, v14 row_shl:8 row_mask:0xf bank_mask:0x1
    v_mov_b32_dpp v31, v14 row_shl:12 row_mask:0xf bank_mask:0x1
    v_mov_b32_dpp v32, v14 row_shr:4 row_mask:0xf bank_mask:0x2
    v_mov_b32_dpp v33, v14 quad_perm:[0,1,2,3] row_mask:0xf bank_mask:0x2
    v_mov_b32_dpp v34, v14 row_shl:4 row_mask:0xf bank_mask:0x2
    v_mov_b32_dpp v35, v14 row_shl:8 row_mask:0xf bank_mask:0x2
    v_mov_b32_dpp v36, v14 row_shr:8 row_mask:0xf bank_mask:0x4
    v_mov_b32_dpp v37, v14 row_shr:4 row_mask:0xf bank_mask:0x4
    v_mov_b32_dpp v38, v14 quad_perm:[0,1,2,3] row_mask:0xf bank_mask:0x4
    v_mov_b32_dpp v39, v14 row_shl:4 row_mask:0xf bank_mask:0x4
    v_mov_b32_dpp v40, v14 row_shr:12 row_mask:0xf bank_mask:0x8
    v_mov_b32_dpp v41, v14 row_shr:8 row_mask:0xf bank_mask:0x8
    v_mov_b32_dpp v42, v14 row_shr:4 row_mask:0xf bank_mask:0x8
    v_mov_b32_dpp v43, v14 quad_perm:[0,1,2,3] row_mask:0xf bank_mask:0x8
    s_waitcnt vmcnt(13)
    buffer_load_dwordx4 v[112:115], v2, s[20:23], s48 offen offset:1024
    s_waitcnt vmcnt(13)
    buffer_load_dwordx4 v[116:119], v2, s[20:23], s48 offen offset:2048
    s_waitcnt vmcnt(13)
    buffer_load_dwordx4 v[120:123], v2, s[20:23], s48 offen offset:3072
    s_waitcnt vmcnt(13)
    s_mov_b32 s48, 131072
    buffer_load_dwordx4 v[124:127], v2, s[20:23], s48 offen offset:0
    s_waitcnt vmcnt(13)
    buffer_load_dwordx4 v[128:131], v2, s[20:23], s48 offen offset:1024
    s_waitcnt vmcnt(13)
    buffer_load_dwordx4 v[132:135], v2, s[20:23], s48 offen offset:2048
    s_waitcnt vmcnt(13)
    buffer_load_dwordx4 v[136:139], v2, s[20:23], s48 offen offset:3072
    v_accvgpr_read_b32 v53, a164
    v_accvgpr_read_b32 v54, a168
    v_accvgpr_read_b32 v55, a172
    v_accvgpr_read_b32 v56, a176
    v_accvgpr_read_b32 v57, a180
    v_accvgpr_read_b32 v58, a184
    v_accvgpr_read_b32 v59, a188
    v_perm_b32 v20, v53, v160, s74
    v_perm_b32 v21, v55, v54, s74
    v_perm_b32 v22, v57, v56, s74
    v_perm_b32 v23, v59, v58, s74
    s_waitcnt vmcnt(13)
    s_mov_b32 s48, 147456
    buffer_load_dwordx4 v[140:143], v2, s[20:23], s48 offen offset:0
    v_perm_b32 v24, v53, v160, s75
    v_perm_b32 v25, v55, v54, s75
    v_perm_b32 v26, v57, v56, s75
    v_perm_b32 v27, v59, v58, s75
    v_mfma_f32_16x16x32_bf16 v[44:47], v[28:31], v[20:23], v[44:47]
    v_accvgpr_read_b32 v53, a165
    v_accvgpr_read_b32 v54, a169
    v_accvgpr_read_b32 v55, a173
    v_accvgpr_read_b32 v56, a177
    v_accvgpr_read_b32 v57, a181
    v_accvgpr_read_b32 v58, a185
    v_accvgpr_read_b32 v59, a189
    v_perm_b32 v20, v53, v161, s74
    v_perm_b32 v21, v55, v54, s74
    v_perm_b32 v22, v57, v56, s74
    v_perm_b32 v23, v59, v58, s74
    v_mfma_f32_16x16x32_bf16 v[44:47], v[32:35], v[24:27], v[44:47]
    s_waitcnt vmcnt(13)
    buffer_load_dwordx4 v[144:147], v2, s[20:23], s48 offen offset:1024
    v_perm_b32 v24, v53, v161, s75
    v_perm_b32 v25, v55, v54, s75
    v_perm_b32 v26, v57, v56, s75
    v_perm_b32 v27, v59, v58, s75
    v_mfma_f32_16x16x32_bf16 v[44:47], v[36:39], v[20:23], v[44:47]
    v_accvgpr_read_b32 v53, a166
    v_accvgpr_read_b32 v54, a170
    v_accvgpr_read_b32 v55, a174
    v_accvgpr_read_b32 v56, a178
    v_accvgpr_read_b32 v57, a182
    v_accvgpr_read_b32 v58, a186
    v_accvgpr_read_b32 v59, a190
    v_perm_b32 v20, v53, v162, s74
    v_perm_b32 v21, v55, v54, s74
    v_perm_b32 v22, v57, v56, s74
    v_perm_b32 v23, v59, v58, s74
    v_mfma_f32_16x16x32_bf16 v[44:47], v[40:43], v[24:27], v[44:47]
    v_perm_b32 v24, v53, v162, s75
    v_perm_b32 v25, v55, v54, s75
    v_perm_b32 v26, v57, v56, s75
    v_perm_b32 v27, v59, v58, s75
    v_mfma_f32_16x16x32_bf16 v[48:51], v[28:31], v[20:23], v[48:51]
    v_accvgpr_read_b32 v53, a167
    v_accvgpr_read_b32 v54, a171
    v_accvgpr_read_b32 v55, a175
    v_accvgpr_read_b32 v56, a179
    v_accvgpr_read_b32 v57, a183
    v_accvgpr_read_b32 v58, a187
    v_accvgpr_read_b32 v59, a191
    v_perm_b32 v20, v53, v163, s74
    v_perm_b32 v21, v55, v54, s74
    v_perm_b32 v22, v57, v56, s74
    v_perm_b32 v23, v59, v58, s74
    v_mfma_f32_16x16x32_bf16 v[48:51], v[32:35], v[24:27], v[48:51]
    v_perm_b32 v24, v53, v163, s75
    v_perm_b32 v25, v55, v54, s75
    v_perm_b32 v26, v57, v56, s75
    v_perm_b32 v27, v59, v58, s75
    v_mfma_f32_16x16x32_bf16 v[48:51], v[36:39], v[20:23], v[48:51]
    s_waitcnt vmcnt(13)
    buffer_load_dwordx4 v[148:151], v2, s[20:23], s48 offen offset:2048
    v_mfma_f32_16x16x32_bf16 v[48:51], v[40:43], v[24:27], v[48:51]
    v_mov_b32_dpp v28, v15 quad_perm:[0,1,2,3] row_mask:0xf bank_mask:0x1
    v_mov_b32_dpp v29, v15 row_shl:4 row_mask:0xf bank_mask:0x1
    v_mov_b32_dpp v30, v15 row_shl:8 row_mask:0xf bank_mask:0x1
    v_mov_b32_dpp v31, v15 row_shl:12 row_mask:0xf bank_mask:0x1
    v_mov_b32_dpp v32, v15 row_shr:4 row_mask:0xf bank_mask:0x2
    v_mov_b32_dpp v33, v15 quad_perm:[0,1,2,3] row_mask:0xf bank_mask:0x2
    v_mov_b32_dpp v34, v15 row_shl:4 row_mask:0xf bank_mask:0x2
    v_mov_b32_dpp v35, v15 row_shl:8 row_mask:0xf bank_mask:0x2
    v_mov_b32_dpp v36, v15 row_shr:8 row_mask:0xf bank_mask:0x4
    v_mov_b32_dpp v37, v15 row_shr:4 row_mask:0xf bank_mask:0x4
    v_mov_b32_dpp v38, v15 quad_perm:[0,1,2,3] row_mask:0xf bank_mask:0x4
    v_mov_b32_dpp v39, v15 row_shl:4 row_mask:0xf bank_mask:0x4
    v_mov_b32_dpp v40, v15 row_shr:12 row_mask:0xf bank_mask:0x8
    v_mov_b32_dpp v41, v15 row_shr:8 row_mask:0xf bank_mask:0x8
    v_mov_b32_dpp v42, v15 row_shr:4 row_mask:0xf bank_mask:0x8
    v_mov_b32_dpp v43, v15 quad_perm:[0,1,2,3] row_mask:0xf bank_mask:0x8
    s_waitcnt vmcnt(13)
    buffer_load_dwordx4 v[152:155], v2, s[20:23], s48 offen offset:3072
    s_waitcnt vmcnt(13)
    s_mov_b32 s48, 163840
    buffer_load_dwordx4 v[156:159], v2, s[20:23], s48 offen offset:0 nt
    s_waitcnt vmcnt(11)
    buffer_load_dwordx4 v[160:163], v2, s[20:23], s48 offen offset:1024 nt
    s_waitcnt vmcnt(11)
    buffer_load_dwordx4 a[112:115], v2, s[20:23], s48 offen offset:2048 nt
    s_waitcnt vmcnt(11)
    buffer_load_dwordx4 a[116:119], v2, s[20:23], s48 offen offset:3072 nt
    v_accvgpr_read_b32 v52, a108
    v_perm_b32 v20, v96, v52, s74
    v_perm_b32 v21, v104, v100, s74
    v_perm_b32 v22, v112, v108, s74
    v_perm_b32 v23, v120, v116, s74
    v_perm_b32 v24, v96, v52, s75
    v_perm_b32 v25, v104, v100, s75
    v_perm_b32 v26, v112, v108, s75
    v_perm_b32 v27, v120, v116, s75
    v_mfma_f32_16x16x32_bf16 v[44:47], v[28:31], v[20:23], v[44:47]
    v_accvgpr_read_b32 v52, a109
    v_perm_b32 v20, v97, v52, s74
    v_perm_b32 v21, v105, v101, s74
    v_perm_b32 v22, v113, v109, s74
    v_perm_b32 v23, v121, v117, s74
    v_mfma_f32_16x16x32_bf16 v[44:47], v[32:35], v[24:27], v[44:47]
    s_waitcnt vmcnt(11)
    s_mov_b32 s48, 180224
    buffer_load_dwordx4 a[120:123], v2, s[20:23], s48 offen offset:0 nt
    v_perm_b32 v24, v97, v52, s75
    v_perm_b32 v25, v105, v101, s75
    v_perm_b32 v26, v113, v109, s75
    v_perm_b32 v27, v121, v117, s75
    v_mfma_f32_16x16x32_bf16 v[44:47], v[36:39], v[20:23], v[44:47]
    v_accvgpr_read_b32 v52, a110
    v_perm_b32 v20, v98, v52, s74
    v_perm_b32 v21, v106, v102, s74
    v_perm_b32 v22, v114, v110, s74
    v_perm_b32 v23, v122, v118, s74
    v_mfma_f32_16x16x32_bf16 v[44:47], v[40:43], v[24:27], v[44:47]
    v_perm_b32 v24, v98, v52, s75
    v_perm_b32 v25, v106, v102, s75
    v_perm_b32 v26, v114, v110, s75
    v_perm_b32 v27, v122, v118, s75
    v_mfma_f32_16x16x32_bf16 v[48:51], v[28:31], v[20:23], v[48:51]
    v_accvgpr_read_b32 v52, a111
    v_perm_b32 v20, v99, v52, s74
    v_perm_b32 v21, v107, v103, s74
    v_perm_b32 v22, v115, v111, s74
    v_perm_b32 v23, v123, v119, s74
    v_mfma_f32_16x16x32_bf16 v[48:51], v[32:35], v[24:27], v[48:51]
    v_perm_b32 v24, v99, v52, s75
    v_perm_b32 v25, v107, v103, s75
    v_perm_b32 v26, v115, v111, s75
    v_perm_b32 v27, v123, v119, s75
    v_mfma_f32_16x16x32_bf16 v[48:51], v[36:39], v[20:23], v[48:51]
    s_nop 0
    v_mfma_f32_16x16x32_bf16 v[48:51], v[40:43], v[24:27], v[48:51]
    v_lshrrev_b32 v7, 4, v0
    v_lshlrev_b32 v7, 8, v7
    v_and_b32 v52, 15, v0
    v_lshl_add_u32 v7, v52, 3, v7
    s_lshl_b32 s68, s3, 11
    v_add_u32 v7, s68, v7
    ds_read_b64_tr_b16 a[216:217], v7 offset:0
    ds_read_b64_tr_b16 a[218:219], v7 offset:128
    ds_read_b64_tr_b16 a[220:221], v7 offset:1024
    ds_read_b64_tr_b16 a[222:223], v7 offset:1152
    s_waitcnt lgkmcnt(0)
    v_mov_b32_dpp v28, v16 quad_perm:[0,1,2,3] row_mask:0xf bank_mask:0x1
    v_mov_b32_dpp v29, v16 row_shl:4 row_mask:0xf bank_mask:0x1
    v_mov_b32_dpp v30, v16 row_shl:8 row_mask:0xf bank_mask:0x1
    v_mov_b32_dpp v31, v16 row_shl:12 row_mask:0xf bank_mask:0x1
    v_mov_b32_dpp v32, v16 row_shr:4 row_mask:0xf bank_mask:0x2
    v_mov_b32_dpp v33, v16 quad_perm:[0,1,2,3] row_mask:0xf bank_mask:0x2
    v_mov_b32_dpp v34, v16 row_shl:4 row_mask:0xf bank_mask:0x2
    v_mov_b32_dpp v35, v16 row_shl:8 row_mask:0xf bank_mask:0x2
    v_mov_b32_dpp v36, v16 row_shr:8 row_mask:0xf bank_mask:0x4
    v_mov_b32_dpp v37, v16 row_shr:4 row_mask:0xf bank_mask:0x4
    v_mov_b32_dpp v38, v16 quad_perm:[0,1,2,3] row_mask:0xf bank_mask:0x4
    v_mov_b32_dpp v39, v16 row_shl:4 row_mask:0xf bank_mask:0x4
    v_mov_b32_dpp v40, v16 row_shr:12 row_mask:0xf bank_mask:0x8
    v_mov_b32_dpp v41, v16 row_shr:8 row_mask:0xf bank_mask:0x8
    v_mov_b32_dpp v42, v16 row_shr:4 row_mask:0xf bank_mask:0x8
    v_mov_b32_dpp v43, v16 quad_perm:[0,1,2,3] row_mask:0xf bank_mask:0x8
    s_waitcnt vmcnt(11)
    buffer_load_dwordx4 v[96:99], v2, s[20:23], s48 offen offset:1024 nt
    s_waitcnt vmcnt(11)
    buffer_load_dwordx4 v[100:103], v2, s[20:23], s48 offen offset:2048 nt
    s_waitcnt vmcnt(11)
    buffer_load_dwordx4 v[104:107], v2, s[20:23], s48 offen offset:3072 nt
    s_waitcnt vmcnt(11)
    s_mov_b32 s48, 196608
    buffer_load_dwordx4 v[108:111], v2, s[20:23], s48 offen offset:0 nt
    s_waitcnt vmcnt(11)
    buffer_load_dwordx4 v[112:115], v2, s[20:23], s48 offen offset:1024 nt
    s_waitcnt vmcnt(11)
    buffer_load_dwordx4 v[116:119], v2, s[20:23], s48 offen offset:2048 nt
    s_waitcnt vmcnt(11)
    buffer_load_dwordx4 v[120:123], v2, s[20:23], s48 offen offset:3072 nt
    v_perm_b32 v20, v128, v124, s74
    v_perm_b32 v21, v136, v132, s74
    v_perm_b32 v22, v144, v140, s74
    v_perm_b32 v23, v152, v148, s74
    s_waitcnt vmcnt(11)
    s_mov_b32 s48, 212992
    buffer_load_dwordx4 a[124:127], v2, s[20:23], s48 offen offset:0 nt
    v_perm_b32 v24, v128, v124, s75
    v_perm_b32 v25, v136, v132, s75
    v_perm_b32 v26, v144, v140, s75
    v_perm_b32 v27, v152, v148, s75
    v_mfma_f32_16x16x32_bf16 v[44:47], v[28:31], v[20:23], v[44:47]
    v_perm_b32 v20, v129, v125, s74
    v_perm_b32 v21, v137, v133, s74
    v_perm_b32 v22, v145, v141, s74
    v_perm_b32 v23, v153, v149, s74
    v_mfma_f32_16x16x32_bf16 v[44:47], v[32:35], v[24:27], v[44:47]
    v_perm_b32 v24, v129, v125, s75
    v_perm_b32 v25, v137, v133, s75
    v_perm_b32 v26, v145, v141, s75
    v_perm_b32 v27, v153, v149, s75
    v_mfma_f32_16x16x32_bf16 v[44:47], v[36:39], v[20:23], v[44:47]
    s_waitcnt vmcnt(11)
    buffer_load_dwordx4 a[128:131], v2, s[20:23], s48 offen offset:1024 nt
    v_perm_b32 v20, v130, v126, s74
    v_perm_b32 v21, v138, v134, s74
    v_perm_b32 v22, v146, v142, s74
    v_perm_b32 v23, v154, v150, s74
    v_mfma_f32_16x16x32_bf16 v[44:47], v[40:43], v[24:27], v[44:47]
    v_perm_b32 v24, v130, v126, s75
    v_perm_b32 v25, v138, v134, s75
    v_perm_b32 v26, v146, v142, s75
    v_perm_b32 v27, v154, v150, s75
    v_mfma_f32_16x16x32_bf16 v[48:51], v[28:31], v[20:23], v[48:51]
    v_perm_b32 v20, v131, v127, s74
    v_perm_b32 v21, v139, v135, s74
    v_perm_b32 v22, v147, v143, s74
    v_perm_b32 v23, v155, v151, s74
    v_mfma_f32_16x16x32_bf16 v[48:51], v[32:35], v[24:27], v[48:51]
    v_perm_b32 v24, v131, v127, s75
    v_perm_b32 v25, v139, v135, s75
    v_perm_b32 v26, v147, v143, s75
    v_perm_b32 v27, v155, v151, s75
    v_mfma_f32_16x16x32_bf16 v[48:51], v[36:39], v[20:23], v[48:51]
    s_nop 0
    v_mfma_f32_16x16x32_bf16 v[48:51], v[40:43], v[24:27], v[48:51]
    v_mov_b32_dpp v28, v17 quad_perm:[0,1,2,3] row_mask:0xf bank_mask:0x1
    v_mov_b32_dpp v29, v17 row_shl:4 row_mask:0xf bank_mask:0x1
    v_mov_b32_dpp v30, v17 row_shl:8 row_mask:0xf bank_mask:0x1
    v_mov_b32_dpp v31, v17 row_shl:12 row_mask:0xf bank_mask:0x1
    v_mov_b32_dpp v32, v17 row_shr:4 row_mask:0xf bank_mask:0x2
    v_mov_b32_dpp v33, v17 quad_perm:[0,1,2,3] row_mask:0xf bank_mask:0x2
    v_mov_b32_dpp v34, v17 row_shl:4 row_mask:0xf bank_mask:0x2
    v_mov_b32_dpp v35, v17 row_shl:8 row_mask:0xf bank_mask:0x2
    v_mov_b32_dpp v36, v17 row_shr:8 row_mask:0xf bank_mask:0x4
    v_mov_b32_dpp v37, v17 row_shr:4 row_mask:0xf bank_mask:0x4
    v_mov_b32_dpp v38, v17 quad_perm:[0,1,2,3] row_mask:0xf bank_mask:0x4
    v_mov_b32_dpp v39, v17 row_shl:4 row_mask:0xf bank_mask:0x4
    v_mov_b32_dpp v40, v17 row_shr:12 row_mask:0xf bank_mask:0x8
    v_mov_b32_dpp v41, v17 row_shr:8 row_mask:0xf bank_mask:0x8
    v_mov_b32_dpp v42, v17 row_shr:4 row_mask:0xf bank_mask:0x8
    v_mov_b32_dpp v43, v17 quad_perm:[0,1,2,3] row_mask:0xf bank_mask:0x8
    s_waitcnt vmcnt(11)
    buffer_load_dwordx4 v[124:127], v2, s[20:23], s48 offen offset:2048 nt
    s_waitcnt vmcnt(11)
    buffer_load_dwordx4 v[128:131], v2, s[20:23], s48 offen offset:3072 nt
    s_waitcnt vmcnt(11)
    s_mov_b32 s48, 229376
    buffer_load_dwordx4 v[132:135], v2, s[20:23], s48 offen offset:0 nt
    s_waitcnt vmcnt(11)
    buffer_load_dwordx4 v[136:139], v2, s[20:23], s48 offen offset:1024 nt
    s_waitcnt vmcnt(11)
    buffer_load_dwordx4 v[140:143], v2, s[20:23], s48 offen offset:2048 nt
    s_waitcnt vmcnt(11)
    buffer_load_dwordx4 v[144:147], v2, s[20:23], s48 offen offset:3072 nt
    v_accvgpr_read_b32 v54, a112
    v_accvgpr_read_b32 v55, a116
    v_accvgpr_read_b32 v56, a120
    v_perm_b32 v20, v160, v156, s74
    v_perm_b32 v21, v55, v54, s74
    v_perm_b32 v22, v96, v56, s74
    v_perm_b32 v23, v104, v100, s74
    s_waitcnt vmcnt(11)
    s_mov_b32 s48, 245760
    buffer_load_dwordx4 v[148:151], v2, s[20:23], s48 offen offset:0 nt
    v_perm_b32 v24, v160, v156, s75
    v_perm_b32 v25, v55, v54, s75
    v_perm_b32 v26, v96, v56, s75
    v_perm_b32 v27, v104, v100, s75
    v_mfma_f32_16x16x32_bf16 v[44:47], v[28:31], v[20:23], v[44:47]
    v_accvgpr_write_b32 a132, v20
    v_accvgpr_write_b32 a133, v21
    v_accvgpr_write_b32 a134, v22
    v_accvgpr_write_b32 a135, v23
    v_accvgpr_read_b32 v54, a113
    v_accvgpr_read_b32 v55, a117
    v_accvgpr_read_b32 v56, a121
    v_perm_b32 v20, v161, v157, s74
    v_perm_b32 v21, v55, v54, s74
    v_perm_b32 v22, v97, v56, s74
    v_perm_b32 v23, v105, v101, s74
    v_mfma_f32_16x16x32_bf16 v[44:47], v[32:35], v[24:27], v[44:47]
    v_accvgpr_write_b32 a136, v24
    v_accvgpr_write_b32 a137, v25
    v_accvgpr_write_b32 a138, v26
    v_accvgpr_write_b32 a139, v27
    v_perm_b32 v24, v161, v157, s75
    v_perm_b32 v25, v55, v54, s75
    v_perm_b32 v26, v97, v56, s75
    v_perm_b32 v27, v105, v101, s75
    v_mfma_f32_16x16x32_bf16 v[44:47], v[36:39], v[20:23], v[44:47]
    v_accvgpr_write_b32 a140, v20
    v_accvgpr_write_b32 a141, v21
    v_accvgpr_write_b32 a142, v22
    v_accvgpr_write_b32 a143, v23
    v_accvgpr_read_b32 v54, a114
    v_accvgpr_read_b32 v55, a118
    v_accvgpr_read_b32 v56, a122
    v_perm_b32 v20, v162, v158, s74
    v_perm_b32 v21, v55, v54, s74
    v_perm_b32 v22, v98, v56, s74
    v_perm_b32 v23, v106, v102, s74
    v_mfma_f32_16x16x32_bf16 v[44:47], v[40:43], v[24:27], v[44:47]
    v_accvgpr_write_b32 a164, v24
    v_accvgpr_write_b32 a165, v25
    v_accvgpr_write_b32 a166, v26
    v_accvgpr_write_b32 a167, v27
    s_waitcnt vmcnt(11)
    buffer_load_dwordx4 v[152:155], v2, s[20:23], s48 offen offset:1024 nt
    v_perm_b32 v24, v162, v158, s75
    v_perm_b32 v25, v55, v54, s75
    v_perm_b32 v26, v98, v56, s75
    v_perm_b32 v27, v106, v102, s75
    v_mfma_f32_16x16x32_bf16 v[48:51], v[28:31], v[20:23], v[48:51]
    v_accvgpr_write_b32 a168, v20
    v_accvgpr_write_b32 a169, v21
    v_accvgpr_write_b32 a170, v22
    v_accvgpr_write_b32 a171, v23
    v_accvgpr_read_b32 v54, a115
    v_accvgpr_read_b32 v55, a119
    v_accvgpr_read_b32 v56, a123
    v_perm_b32 v20, v163, v159, s74
    v_perm_b32 v21, v55, v54, s74
    v_perm_b32 v22, v99, v56, s74
    v_perm_b32 v23, v107, v103, s74
    v_mfma_f32_16x16x32_bf16 v[48:51], v[32:35], v[24:27], v[48:51]
    v_accvgpr_write_b32 a172, v24
    v_accvgpr_write_b32 a173, v25
    v_accvgpr_write_b32 a174, v26
    v_accvgpr_write_b32 a175, v27
    v_perm_b32 v24, v163, v159, s75
    v_perm_b32 v25, v55, v54, s75
    v_perm_b32 v26, v99, v56, s75
    v_perm_b32 v27, v107, v103, s75
    v_mfma_f32_16x16x32_bf16 v[48:51], v[36:39], v[20:23], v[48:51]
    v_accvgpr_write_b32 a176, v20
    v_accvgpr_write_b32 a177, v21
    v_accvgpr_write_b32 a178, v22
    v_accvgpr_write_b32 a179, v23
    v_mfma_f32_16x16x32_bf16 v[48:51], v[40:43], v[24:27], v[48:51]
    v_accvgpr_write_b32 a180, v24
    v_accvgpr_write_b32 a181, v25
    v_accvgpr_write_b32 a182, v26
    v_accvgpr_write_b32 a183, v27
    v_mov_b32_dpp v28, v18 quad_perm:[0,1,2,3] row_mask:0xf bank_mask:0x1
    v_mov_b32_dpp v29, v18 row_shl:4 row_mask:0xf bank_mask:0x1
    v_mov_b32_dpp v30, v18 row_shl:8 row_mask:0xf bank_mask:0x1
    v_mov_b32_dpp v31, v18 row_shl:12 row_mask:0xf bank_mask:0x1
    v_mov_b32_dpp v32, v18 row_shr:4 row_mask:0xf bank_mask:0x2
    v_mov_b32_dpp v33, v18 quad_perm:[0,1,2,3] row_mask:0xf bank_mask:0x2
    v_mov_b32_dpp v34, v18 row_shl:4 row_mask:0xf bank_mask:0x2
    v_mov_b32_dpp v35, v18 row_shl:8 row_mask:0xf bank_mask:0x2
    v_mov_b32_dpp v36, v18 row_shr:8 row_mask:0xf bank_mask:0x4
    v_mov_b32_dpp v37, v18 row_shr:4 row_mask:0xf bank_mask:0x4
    v_mov_b32_dpp v38, v18 quad_perm:[0,1,2,3] row_mask:0xf bank_mask:0x4
    v_mov_b32_dpp v39, v18 row_shl:4 row_mask:0xf bank_mask:0x4
    v_mov_b32_dpp v40, v18 row_shr:12 row_mask:0xf bank_mask:0x8
    v_mov_b32_dpp v41, v18 row_shr:8 row_mask:0xf bank_mask:0x8
    v_mov_b32_dpp v42, v18 row_shr:4 row_mask:0xf bank_mask:0x8
    v_mov_b32_dpp v43, v18 quad_perm:[0,1,2,3] row_mask:0xf bank_mask:0x8
    s_waitcnt vmcnt(11)
    buffer_load_dwordx4 v[156:159], v2, s[20:23], s48 offen offset:2048 nt
    s_waitcnt vmcnt(11)
    buffer_load_dwordx4 v[160:163], v2, s[20:23], s48 offen offset:3072 nt
    s_waitcnt vmcnt(11)
    s_waitcnt vmcnt(10)
    s_waitcnt vmcnt(9)
    s_waitcnt vmcnt(8)
    v_accvgpr_read_b32 v56, a124
    v_accvgpr_read_b32 v57, a128
    v_perm_b32 v20, v112, v108, s74
    v_perm_b32 v21, v120, v116, s74
    v_perm_b32 v22, v57, v56, s74
    v_perm_b32 v23, v128, v124, s74
    v_perm_b32 v24, v112, v108, s75
    v_perm_b32 v25, v120, v116, s75
    v_perm_b32 v26, v57, v56, s75
    v_perm_b32 v27, v128, v124, s75
    v_mfma_f32_16x16x32_bf16 v[44:47], v[28:31], v[20:23], v[44:47]
    v_accvgpr_write_b32 a184, v20
    v_accvgpr_write_b32 a185, v21
    v_accvgpr_write_b32 a186, v22
    v_accvgpr_write_b32 a187, v23
    v_accvgpr_read_b32 v56, a125
    v_accvgpr_read_b32 v57, a129
    v_perm_b32 v20, v113, v109, s74
    v_perm_b32 v21, v121, v117, s74
    v_perm_b32 v22, v57, v56, s74
    v_perm_b32 v23, v129, v125, s74
    v_mfma_f32_16x16x32_bf16 v[44:47], v[32:35], v[24:27], v[44:47]
    v_accvgpr_write_b32 a188, v24
    v_accvgpr_write_b32 a189, v25
    v_accvgpr_write_b32 a190, v26
    v_accvgpr_write_b32 a191, v27
    v_perm_b32 v24, v113, v109, s75
    v_perm_b32 v25, v121, v117, s75
    v_perm_b32 v26, v57, v56, s75
    v_perm_b32 v27, v129, v125, s75
    v_mfma_f32_16x16x32_bf16 v[44:47], v[36:39], v[20:23], v[44:47]
    v_accvgpr_write_b32 a108, v20
    v_accvgpr_write_b32 a109, v21
    v_accvgpr_write_b32 a110, v22
    v_accvgpr_write_b32 a111, v23
    v_accvgpr_read_b32 v56, a126
    v_accvgpr_read_b32 v57, a130
    v_perm_b32 v20, v114, v110, s74
    v_perm_b32 v21, v122, v118, s74
    v_perm_b32 v22, v57, v56, s74
    v_perm_b32 v23, v130, v126, s74
    v_mfma_f32_16x16x32_bf16 v[44:47], v[40:43], v[24:27], v[44:47]
    v_accvgpr_write_b32 a112, v24
    v_accvgpr_write_b32 a113, v25
    v_accvgpr_write_b32 a114, v26
    v_accvgpr_write_b32 a115, v27
    v_perm_b32 v24, v114, v110, s75
    v_perm_b32 v25, v122, v118, s75
    v_perm_b32 v26, v57, v56, s75
    v_perm_b32 v27, v130, v126, s75
    v_mfma_f32_16x16x32_bf16 v[48:51], v[28:31], v[20:23], v[48:51]
    v_accvgpr_write_b32 a116, v20
    v_accvgpr_write_b32 a117, v21
    v_accvgpr_write_b32 a118, v22
    v_accvgpr_write_b32 a119, v23
    v_accvgpr_read_b32 v56, a127
    v_accvgpr_read_b32 v57, a131
    v_perm_b32 v96, v115, v111, s74
    v_perm_b32 v97, v123, v119, s74
    v_perm_b32 v98, v57, v56, s74
    v_perm_b32 v99, v131, v127, s74
    v_mfma_f32_16x16x32_bf16 v[48:51], v[32:35], v[24:27], v[48:51]
    v_accvgpr_write_b32 a120, v24
    v_accvgpr_write_b32 a121, v25
    v_accvgpr_write_b32 a122, v26
    v_accvgpr_write_b32 a123, v27
    v_perm_b32 v100, v115, v111, s75
    v_perm_b32 v101, v123, v119, s75
    v_perm_b32 v102, v57, v56, s75
    v_perm_b32 v103, v131, v127, s75
    v_mfma_f32_16x16x32_bf16 v[48:51], v[36:39], v[96:99], v[48:51]
    s_nop 0
    v_mfma_f32_16x16x32_bf16 v[48:51], v[40:43], v[100:103], v[48:51]
    v_mov_b32_dpp v28, v19 quad_perm:[0,1,2,3] row_mask:0xf bank_mask:0x1
    v_mov_b32_dpp v29, v19 row_shl:4 row_mask:0xf bank_mask:0x1
    v_mov_b32_dpp v30, v19 row_shl:8 row_mask:0xf bank_mask:0x1
    v_mov_b32_dpp v31, v19 row_shl:12 row_mask:0xf bank_mask:0x1
    v_mov_b32_dpp v32, v19 row_shr:4 row_mask:0xf bank_mask:0x2
    v_mov_b32_dpp v33, v19 quad_perm:[0,1,2,3] row_mask:0xf bank_mask:0x2
    v_mov_b32_dpp v34, v19 row_shl:4 row_mask:0xf bank_mask:0x2
    v_mov_b32_dpp v35, v19 row_shl:8 row_mask:0xf bank_mask:0x2
    v_mov_b32_dpp v36, v19 row_shr:8 row_mask:0xf bank_mask:0x4
    v_mov_b32_dpp v37, v19 row_shr:4 row_mask:0xf bank_mask:0x4
    v_mov_b32_dpp v38, v19 quad_perm:[0,1,2,3] row_mask:0xf bank_mask:0x4
    v_mov_b32_dpp v39, v19 row_shl:4 row_mask:0xf bank_mask:0x4
    v_mov_b32_dpp v40, v19 row_shr:12 row_mask:0xf bank_mask:0x8
    v_mov_b32_dpp v41, v19 row_shr:8 row_mask:0xf bank_mask:0x8
    v_mov_b32_dpp v42, v19 row_shr:4 row_mask:0xf bank_mask:0x8
    v_mov_b32_dpp v43, v19 quad_perm:[0,1,2,3] row_mask:0xf bank_mask:0x8
    s_waitcnt vmcnt(7)
    s_waitcnt vmcnt(6)
    s_waitcnt vmcnt(5)
    s_waitcnt vmcnt(4)
    s_waitcnt vmcnt(3)
    s_waitcnt vmcnt(2)
    s_waitcnt vmcnt(1)
    s_waitcnt vmcnt(0)
    s_mov_b32 s60, 262144
    s_mov_b32 s62, 1310720
    s_mov_b32 s63, 1
    s_mov_b32 s82, 2
    s_mov_b32 s78, 1
    s_mov_b32 s83, 2
    s_mov_b32 s64, 32
    v_perm_b32 v20, v136, v132, s74
    v_perm_b32 v21, v144, v140, s74
    v_perm_b32 v22, v152, v148, s74
    v_perm_b32 v23, v160, v156, s74
    v_perm_b32 v24, v136, v132, s75
    v_perm_b32 v25, v144, v140, s75
    v_perm_b32 v26, v152, v148, s75
    v_perm_b32 v27, v160, v156, s75
    v_mfma_f32_16x16x32_bf16 v[44:47], v[28:31], v[20:23], v[44:47]
    v_perm_b32 v20, v137, v133, s74
    v_perm_b32 v21, v145, v141, s74
    v_perm_b32 v22, v153, v149, s74
    v_perm_b32 v23, v161, v157, s74
    v_mfma_f32_16x16x32_bf16 v[44:47], v[32:35], v[24:27], v[44:47]
    v_perm_b32 v24, v137, v133, s75
    v_perm_b32 v25, v145, v141, s75
    v_perm_b32 v26, v153, v149, s75
    v_perm_b32 v27, v161, v157, s75
    v_mfma_f32_16x16x32_bf16 v[44:47], v[36:39], v[20:23], v[44:47]
    v_perm_b32 v20, v138, v134, s74
    v_perm_b32 v21, v146, v142, s74
    v_perm_b32 v22, v154, v150, s74
    v_perm_b32 v23, v162, v158, s74
    v_mfma_f32_16x16x32_bf16 v[44:47], v[40:43], v[24:27], v[44:47]
    v_perm_b32 v24, v138, v134, s75
    v_perm_b32 v25, v146, v142, s75
    v_perm_b32 v26, v154, v150, s75
    v_perm_b32 v27, v162, v158, s75
    v_mfma_f32_16x16x32_bf16 v[48:51], v[28:31], v[20:23], v[48:51]
    v_perm_b32 v20, v139, v135, s74
    v_perm_b32 v21, v147, v143, s74
    v_perm_b32 v22, v155, v151, s74
    v_perm_b32 v23, v163, v159, s74
    v_mfma_f32_16x16x32_bf16 v[48:51], v[32:35], v[24:27], v[48:51]
    v_perm_b32 v24, v139, v135, s75
    v_perm_b32 v25, v147, v143, s75
    v_perm_b32 v26, v155, v151, s75
    v_perm_b32 v27, v163, v159, s75
    v_mfma_f32_16x16x32_bf16 v[48:51], v[36:39], v[20:23], v[48:51]
    s_nop 0
    v_mfma_f32_16x16x32_bf16 v[48:51], v[40:43], v[24:27], v[48:51]
    s_mov_b32 s65, 0
    s_mov_b32 s81, 4
    s_mov_b32 s100, 2
    s_mov_b32 s101, 4
    s_mov_b32 s5, 4
    s_mov_b32 s80, -2
    s_add_u32 s88, s94, NB_g1_0-L_pc
    s_addc_u32 s89, s95, 0
    s_call_b64 s[86:87], S_epi
    v_mfma_f32_16x16x32_bf16 v[28:31], a[0:3], v[8:11], 0
    s_mov_b32 s48, 32768
    buffer_load_dwordx4 a[128:131], v2, s[12:15], s48 offen offset:0 nt
    buffer_load_dwordx4 a[0:3], v2, s[12:15], s48 offen offset:1024 nt
    v_mfma_f32_16x16x32_bf16 v[32:35], a[4:7], v[8:11], 0
    buffer_load_dwordx4 a[4:7], v2, s[12:15], s48 offen offset:2048 nt
    v_mfma_f32_16x16x32_bf16 v[36:39], a[8:11], v[8:11], 0
    buffer_load_dwordx4 a[8:11], v2, s[12:15], s48 offen offset:3072 nt
    s_nop 0
    v_add_f32_dpp v40, v31, v30 row_ror:12 row_mask:0xf bank_mask:0xf
    v_add_f32_dpp v41, v29, v28 row_ror:12 row_mask:0xf bank_mask:0xf
    v_mfma_f32_16x16x32_bf16 v[28:31], a[12:15], v[8:11], 0
    s_mov_b32 s48, 49152
    buffer_load_dwordx4 a[12:15], v2, s[12:15], s48 offen offset:0 nt
    v_add_f32_dpp v21, v41, v40 row_ror:8 row_mask:0xf bank_mask:0x4
    v_add_f32_dpp v40, v32, v35 row_ror:12 row_mask:0xf bank_mask:0xf
    v_add_f32_dpp v41, v34, v33 row_ror:12 row_mask:0xf bank_mask:0xf
    v_mfma_f32_16x16x32_bf16 v[32:35], a[16:19], v[8:11], 0
    buffer_load_dwordx4 a[16:19], v2, s[12:15], s48 offen offset:1024 nt
    v_add_f32_dpp v20, v41, v40 row_ror:8 row_mask:0xf bank_mask:0x8
    v_add_f32_dpp v40, v36, v39 row_ror:12 row_mask:0xf bank_mask:0xf
    v_add_f32_dpp v41, v38, v37 row_ror:12 row_mask:0xf bank_mask:0xf
    v_mfma_f32_16x16x32_bf16 v[36:39], a[20:23], v[8:11], 0
    buffer_load_dwordx4 a[20:23], v2, s[12:15], s48 offen offset:2048 nt
    v_add_f32_dpp v21, v41, v40 row_ror:8 row_mask:0xf bank_mask:0x8
    v_add_f32_dpp v40, v29, v28 row_ror:12 row_mask:0xf bank_mask:0xf
    v_add_f32_dpp v41, v31, v30 row_ror:12 row_mask:0xf bank_mask:0xf
    v_mfma_f32_16x16x32_bf16 v[28:31], a[24:27], v[8:11], 0
    buffer_load_dwordx4 a[24:27], v2, s[12:15], s48 offen offset:3072 nt
    v_add_f32_dpp v22, v41, v40 row_ror:8 row_mask:0xf bank_mask:0x1
    v_add_f32_dpp v40, v33, v32 row_ror:12 row_mask:0xf bank_mask:0xf
    v_add_f32_dpp v41, v35, v34 row_ror:12 row_mask:0xf bank_mask:0xf
    v_mfma_f32_16x16x32_bf16 v[32:35], a[28:31], v[8:11], 0
    s_mov_b32 s48, 65536
    buffer_load_dwordx4 a[28:31], v2, s[12:15], s48 offen offset:0 nt
    v_add_f32_dpp v23, v41, v40 row_ror:8 row_mask:0xf bank_mask:0x1
    v_add_f32_dpp v40, v38, v37 row_ror:12 row_mask:0xf bank_mask:0xf
    v_add_f32_dpp v41, v36, v39 row_ror:12 row_mask:0xf bank_mask:0xf
    v_mfma_f32_16x16x32_bf16 v[36:39], a[32:35], v[8:11], 0
    buffer_load_dwordx4 a[32:35], v2, s[12:15], s48 offen offset:1024 nt
    v_add_f32_dpp v22, v41, v40 row_ror:8 row_mask:0xf bank_mask:0x2
    v_add_f32_dpp v40, v30, v29 row_ror:12 row_mask:0xf bank_mask:0xf
    v_add_f32_dpp v41, v28, v31 row_ror:12 row_mask:0xf bank_mask:0xf
    v_mfma_f32_16x16x32_bf16 v[28:31], a[36:39], v[8:11], 0
    buffer_load_dwordx4 a[36:39], v2, s[12:15], s48 offen offset:2048 nt
    v_add_f32_dpp v23, v41, v40 row_ror:8 row_mask:0xf bank_mask:0x2
    v_add_f32_dpp v40, v35, v34 row_ror:12 row_mask:0xf bank_mask:0xf
    v_add_f32_dpp v41, v33, v32 row_ror:12 row_mask:0xf bank_mask:0xf
    v_mfma_f32_16x16x32_bf16 v[32:35], a[40:43], v[8:11], 0
    buffer_load_dwordx4 a[40:43], v2, s[12:15], s48 offen offset:3072 nt
    v_add_f32_dpp v22, v41, v40 row_ror:8 row_mask:0xf bank_mask:0x4
    v_add_f32_dpp v40, v39, v38 row_ror:12 row_mask:0xf bank_mask:0xf
    v_add_f32_dpp v41, v37, v36 row_ror:12 row_mask:0xf bank_mask:0xf
    v_mfma_f32_16x16x32_bf16 v[36:39], a[44:47], v[8:11], 0
    s_mov_b32 s48, 81920
    buffer_load_dwordx4 a[44:47], v2, s[12:15], s48 offen offset:0 nt
    v_add_f32_dpp v23, v41, v40 row_ror:8 row_mask:0xf bank_mask:0x4
    v_add_f32_dpp v40, v28, v31 row_ror:12 row_mask:0xf bank_mask:0xf
    v_add_f32_dpp v41, v30, v29 row_ror:12 row_mask:0xf bank_mask:0xf
    v_mfma_f32_16x16x32_bf16 v[28:31], a[48:51], v[8:11], 0
    buffer_load_dwordx4 a[48:51], v2, s[12:15], s48 offen offset:1024 nt
    v_add_f32_dpp v22, v41, v40 row_ror:8 row_mask:0xf bank_mask:0x8
    v_add_f32_dpp v40, v32, v35 row_ror:12 row_mask:0xf bank_mask:0xf
    v_add_f32_dpp v41, v34, v33 row_ror:12 row_mask:0xf bank_mask:0xf
    v_mfma_f32_16x16x32_bf16 v[32:35], a[52:55], v[8:11], 0
    buffer_load_dwordx4 a[52:55], v2, s[12:15], s48 offen offset:2048 nt
    v_add_f32_dpp v23, v41, v40 row_ror:8 row_mask:0xf bank_mask:0x8
    v_add_f32_dpp v40, v37, v36 row_ror:12 row_mask:0xf bank_mask:0xf
    v_add_f32_dpp v41, v39, v38 row_ror:12 row_mask:0xf bank_mask:0xf
    v_mfma_f32_16x16x32_bf16 v[36:39], a[56:59], v[8:11], 0
    buffer_load_dwordx4 a[56:59], v2, s[12:15], s48 offen offset:3072 nt
    v_add_f32_dpp v24, v41, v40 row_ror:8 row_mask:0xf bank_mask:0x1
    v_add_f32_dpp v40, v29, v28 row_ror:12 row_mask:0xf bank_mask:0xf
    v_add_f32_dpp v41, v31, v30 row_ror:12 row_mask:0xf bank_mask:0xf
    v_mfma_f32_16x16x32_bf16 v[28:31], a[60:63], v[8:11], 0
    s_mov_b32 s48, 98304
    buffer_load_dwordx4 a[60:63], v2, s[12:15], s48 offen offset:0 nt
    v_add_f32_dpp v25, v41, v40 row_ror:8 row_mask:0xf bank_mask:0x1
    v_add_f32_dpp v40, v34, v33 row_ror:12 row_mask:0xf bank_mask:0xf
    v_add_f32_dpp v41, v32, v35 row_ror:12 row_mask:0xf bank_mask:0xf
    v_mfma_f32_16x16x32_bf16 v[32:35], a[64:67], v[8:11], 0
    buffer_load_dwordx4 a[64:67], v2, s[12:15], s48 offen offset:1024 nt
    v_add_f32_dpp v24, v41, v40 row_ror:8 row_mask:0xf bank_mask:0x2
    v_add_f32_dpp v40, v38, v37 row_ror:12 row_mask:0xf bank_mask:0xf
    v_add_f32_dpp v41, v36, v39 row_ror:12 row_mask:0xf bank_mask:0xf
    v_mfma_f32_16x16x32_bf16 v[36:39], a[68:71], v[8:11], 0
    buffer_load_dwordx4 a[68:71], v2, s[12:15], s48 offen offset:2048 nt
    v_add_f32_dpp v25, v41, v40 row_ror:8 row_mask:0xf bank_mask:0x2
    v_add_f32_dpp v40, v31, v30 row_ror:12 row_mask:0xf bank_mask:0xf
    v_add_f32_dpp v41, v29, v28 row_ror:12 row_mask:0xf bank_mask:0xf
    v_mfma_f32_16x16x32_bf16 v[28:31], a[72:75], v[8:11], 0
    buffer_load_dwordx4 a[72:75], v2, s[12:15], s48 offen offset:3072 nt
    v_add_f32_dpp v24, v41, v40 row_ror:8 row_mask:0xf bank_mask:0x4
    v_add_f32_dpp v40, v35, v34 row_ror:12 row_mask:0xf bank_mask:0xf
    v_add_f32_dpp v41, v33, v32 row_ror:12 row_mask:0xf bank_mask:0xf
    v_mfma_f32_16x16x32_bf16 v[32:35], a[76:79], v[8:11], 0
    s_mov_b32 s48, 114688
    buffer_load_dwordx4 a[76:79], v2, s[12:15], s48 offen offset:0 nt
    v_add_f32_dpp v25, v41, v40 row_ror:8 row_mask:0xf bank_mask:0x4
    v_add_f32_dpp v40, v36, v39 row_ror:12 row_mask:0xf bank_mask:0xf
    v_add_f32_dpp v41, v38, v37 row_ror:12 row_mask:0xf bank_mask:0xf
    v_mfma_f32_16x16x32_bf16 v[36:39], a[80:83], v[8:11], 0
    buffer_load_dwordx4 a[80:83], v2, s[12:15], s48 offen offset:1024 nt
    v_add_f32_dpp v24, v41, v40 row_ror:8 row_mask:0xf bank_mask:0x8
    v_add_f32_dpp v40, v28, v31 row_ror:12 row_mask:0xf bank_mask:0xf
    v_add_f32_dpp v41, v30, v29 row_ror:12 row_mask:0xf bank_mask:0xf
    v_mfma_f32_16x16x32_bf16 v[28:31], a[84:87], v[8:11], 0
    buffer_load_dwordx4 a[84:87], v2, s[12:15], s48 offen offset:2048 nt
    v_add_f32_dpp v25, v41, v40 row_ror:8 row_mask:0xf bank_mask:0x8
    v_add_f32_dpp v40, v33, v32 row_ror:12 row_mask:0xf bank_mask:0xf
    v_add_f32_dpp v41, v35, v34 row_ror:12 row_mask:0xf bank_mask:0xf
    v_mfma_f32_16x16x32_bf16 v[32:35], a[88:91], v[8:11], 0
    buffer_load_dwordx4 a[88:91], v2, s[12:15], s48 offen offset:3072 nt
    v_add_f32_dpp v26, v41, v40 row_ror:8 row_mask:0xf bank_mask:0x1
    v_add_f32_dpp v40, v37, v36 row_ror:12 row_mask:0xf bank_mask:0xf
    v_add_f32_dpp v41, v39, v38 row_ror:12 row_mask:0xf bank_mask:0xf
    v_mfma_f32_16x16x32_bf16 v[36:39], a[92:95], v[8:11], 0
    s_mov_b32 s48, 131072
    buffer_load_dwordx4 a[92:95], v2, s[12:15], s48 offen offset:0 nt
    v_add_f32_dpp v27, v41, v40 row_ror:8 row_mask:0xf bank_mask:0x1
    v_add_f32_dpp v40, v30, v29 row_ror:12 row_mask:0xf bank_mask:0xf
    v_add_f32_dpp v41, v28, v31 row_ror:12 row_mask:0xf bank_mask:0xf
    v_mfma_f32_16x16x32_bf16 v[28:31], a[96:99], v[8:11], 0
    ds_read_b128 v[44:47], v3 offset:0
    buffer_load_dwordx4 a[96:99], v2, s[12:15], s48 offen offset:1024 nt
    v_add_f32_dpp v26, v41, v40 row_ror:8 row_mask:0xf bank_mask:0x2
    v_add_f32_dpp v40, v34, v33 row_ror:12 row_mask:0xf bank_mask:0xf
    v_add_f32_dpp v41, v32, v35 row_ror:12 row_mask:0xf bank_mask:0xf
    v_mfma_f32_16x16x32_bf16 v[32:35], a[100:103], v[8:11], 0
    ds_read_b128 v[48:51], v3 offset:1024
    buffer_load_dwordx4 a[100:103], v2, s[12:15], s48 offen offset:2048 nt
    v_add_f32_dpp v27, v41, v40 row_ror:8 row_mask:0xf bank_mask:0x2
    v_add_f32_dpp v40, v39, v38 row_ror:12 row_mask:0xf bank_mask:0xf
    v_add_f32_dpp v41, v37, v36 row_ror:12 row_mask:0xf bank_mask:0xf
    v_mfma_f32_16x16x32_bf16 v[36:39], a[104:107], v[8:11], 0
    ds_read_b128 v[52:55], v3 offset:2048
    buffer_load_dwordx4 a[104:107], v2, s[12:15], s48 offen offset:3072 nt
    v_add_f32_dpp v26, v41, v40 row_ror:8 row_mask:0xf bank_mask:0x4
    v_add_f32_dpp v40, v31, v30 row_ror:12 row_mask:0xf bank_mask:0xf
    v_add_f32_dpp v41, v29, v28 row_ror:12 row_mask:0xf bank_mask:0xf
    s_waitcnt lgkmcnt(2)
    v_mfma_f32_16x16x32_bf16 v[28:31], v[44:47], v[8:11], 0
    ds_read_b128 v[56:59], v3 offset:3072
    v_add_f32_dpp v27, v41, v40 row_ror:8 row_mask:0xf bank_mask:0x4
    v_add_f32_dpp v40, v32, v35 row_ror:12 row_mask:0xf bank_mask:0xf
    v_add_f32_dpp v41, v34, v33 row_ror:12 row_mask:0xf bank_mask:0xf
    s_waitcnt lgkmcnt(2)
    v_mfma_f32_16x16x32_bf16 v[32:35], v[48:51], v[8:11], 0
    ds_read_b128 v[44:47], v3 offset:4096
    v_add_f32_dpp v26, v41, v40 row_ror:8 row_mask:0xf bank_mask:0x8
    v_add_f32_dpp v40, v36, v39 row_ror:12 row_mask:0xf bank_mask:0xf
    v_add_f32_dpp v41, v38, v37 row_ror:12 row_mask:0xf bank_mask:0xf
    s_waitcnt lgkmcnt(2)
    v_mfma_f32_16x16x32_bf16 v[36:39], v[52:55], v[8:11], 0
    ds_read_b128 v[48:51], v3 offset:5120
    v_add_f32_dpp v27, v41, v40 row_ror:8 row_mask:0xf bank_mask:0x8
    v_add_f32_dpp v40, v29, v28 row_ror:12 row_mask:0xf bank_mask:0xf
    v_add_f32_dpp v41, v31, v30 row_ror:12 row_mask:0xf bank_mask:0xf
    s_waitcnt lgkmcnt(2)
    v_mfma_f32_16x16x32_bf16 v[28:31], v[56:59], v[8:11], 0
    ds_read_b128 v[52:55], v3 offset:6144
    v_add_f32_dpp v12, v41, v40 row_ror:8 row_mask:0xf bank_mask:0x1
    v_add_f32_dpp v40, v33, v32 row_ror:12 row_mask:0xf bank_mask:0xf
    v_add_f32_dpp v41, v35, v34 row_ror:12 row_mask:0xf bank_mask:0xf
    s_waitcnt lgkmcnt(2)
    v_mfma_f32_16x16x32_bf16 v[32:35], v[44:47], v[8:11], 0
    ds_read_b128 v[56:59], v3 offset:7168
    v_add_f32_dpp v13, v41, v40 row_ror:8 row_mask:0xf bank_mask:0x1
    v_add_f32_dpp v40, v38, v37 row_ror:12 row_mask:0xf bank_mask:0xf
    v_add_f32_dpp v41, v36, v39 row_ror:12 row_mask:0xf bank_mask:0xf
    s_waitcnt lgkmcnt(2)
    v_mfma_f32_16x16x32_bf16 v[36:39], v[48:51], v[8:11], 0
    ds_read_b128 v[44:47], v3 offset:8192
    v_add_f32_dpp v12, v41, v40 row_ror:8 row_mask:0xf bank_mask:0x2
    v_add_f32_dpp v40, v30, v29 row_ror:12 row_mask:0xf bank_mask:0xf
    v_add_f32_dpp v41, v28, v31 row_ror:12 row_mask:0xf bank_mask:0xf
    s_waitcnt lgkmcnt(2)
    v_mfma_f32_16x16x32_bf16 v[28:31], v[52:55], v[8:11], 0
    ds_read_b128 v[48:51], v3 offset:9216
    v_add_f32_dpp v13, v41, v40 row_ror:8 row_mask:0xf bank_mask:0x2
    v_add_f32_dpp v40, v35, v34 row_ror:12 row_mask:0xf bank_mask:0xf
    v_add_f32_dpp v41, v33, v32 row_ror:12 row_mask:0xf bank_mask:0xf
    s_waitcnt lgkmcnt(2)
    v_mfma_f32_16x16x32_bf16 v[32:35], v[56:59], v[8:11], 0
    ds_read_b128 v[52:55], v3 offset:10240
    v_add_f32_dpp v12, v41, v40 row_ror:8 row_mask:0xf bank_mask:0x4
    v_add_f32_dpp v40, v39, v38 row_ror:12 row_mask:0xf bank_mask:0xf
    v_add_f32_dpp v41, v37, v36 row_ror:12 row_mask:0xf bank_mask:0xf
    s_waitcnt lgkmcnt(2)
    v_mfma_f32_16x16x32_bf16 v[36:39], v[44:47], v[8:11], 0
    ds_read_b128 v[56:59], v3 offset:11264
    v_add_f32_dpp v13, v41, v40 row_ror:8 row_mask:0xf bank_mask:0x4
    v_add_f32_dpp v40, v28, v31 row_ror:12 row_mask:0xf bank_mask:0xf
    v_add_f32_dpp v41, v30, v29 row_ror:12 row_mask:0xf bank_mask:0xf
    s_waitcnt lgkmcnt(2)
    v_mfma_f32_16x16x32_bf16 v[28:31], v[48:51], v[8:11], 0
    ds_read_b128 v[44:47], v3 offset:12288
    v_add_f32_dpp v12, v41, v40 row_ror:8 row_mask:0xf bank_mask:0x8
    v_add_f32_dpp v40, v32, v35 row_ror:12 row_mask:0xf bank_mask:0xf
    v_add_f32_dpp v41, v34, v33 row_ror:12 row_mask:0xf bank_mask:0xf
    s_waitcnt lgkmcnt(2)
    v_mfma_f32_16x16x32_bf16 v[32:35], v[52:55], v[8:11], 0
    ds_read_b128 v[48:51], v3 offset:13312
    v_add_f32_dpp v13, v41, v40 row_ror:8 row_mask:0xf bank_mask:0x8
    v_add_f32_dpp v40, v37, v36 row_ror:12 row_mask:0xf bank_mask:0xf
    v_add_f32_dpp v41, v39, v38 row_ror:12 row_mask:0xf bank_mask:0xf
    s_waitcnt lgkmcnt(2)
    v_mfma_f32_16x16x32_bf16 v[36:39], v[56:59], v[8:11], 0
    ds_read_b128 v[52:55], v3 offset:14336
    v_add_f32_dpp v14, v41, v40 row_ror:8 row_mask:0xf bank_mask:0x1
    v_add_f32_dpp v40, v29, v28 row_ror:12 row_mask:0xf bank_mask:0xf
    v_add_f32_dpp v41, v31, v30 row_ror:12 row_mask:0xf bank_mask:0xf
    s_waitcnt lgkmcnt(2)
    v_mfma_f32_16x16x32_bf16 v[28:31], v[44:47], v[8:11], 0
    ds_read_b128 v[56:59], v3 offset:15360
    v_add_f32_dpp v15, v41, v40 row_ror:8 row_mask:0xf bank_mask:0x1
    v_add_f32_dpp v40, v34, v33 row_ror:12 row_mask:0xf bank_mask:0xf
    v_add_f32_dpp v41, v32, v35 row_ror:12 row_mask:0xf bank_mask:0xf
    s_waitcnt lgkmcnt(2)
    v_mfma_f32_16x16x32_bf16 v[32:35], v[48:51], v[8:11], 0
    ds_read_b128 v[44:47], v3 offset:16384
    v_add_f32_dpp v14, v41, v40 row_ror:8 row_mask:0xf bank_mask:0x2
    v_add_f32_dpp v40, v38, v37 row_ror:12 row_mask:0xf bank_mask:0xf
    v_add_f32_dpp v41, v36, v39 row_ror:12 row_mask:0xf bank_mask:0xf
    s_waitcnt lgkmcnt(2)
    v_mfma_f32_16x16x32_bf16 v[36:39], v[52:55], v[8:11], 0
    ds_read_b128 v[48:51], v3 offset:17408
    v_add_f32_dpp v15, v41, v40 row_ror:8 row_mask:0xf bank_mask:0x2
    v_add_f32_dpp v40, v31, v30 row_ror:12 row_mask:0xf bank_mask:0xf
    v_add_f32_dpp v41, v29, v28 row_ror:12 row_mask:0xf bank_mask:0xf
    s_waitcnt lgkmcnt(2)
    v_mfma_f32_16x16x32_bf16 v[28:31], v[56:59], v[8:11], 0
    ds_read_b128 v[52:55], v3 offset:18432
    v_add_f32_dpp v14, v41, v40 row_ror:8 row_mask:0xf bank_mask:0x4
    v_add_f32_dpp v40, v35, v34 row_ror:12 row_mask:0xf bank_mask:0xf
    v_add_f32_dpp v41, v33, v32 row_ror:12 row_mask:0xf bank_mask:0xf
    s_waitcnt lgkmcnt(2)
    v_mfma_f32_16x16x32_bf16 v[32:35], v[44:47], v[8:11], 0
    ds_read_b128 v[56:59], v3 offset:19456
    v_add_f32_dpp v15, v41, v40 row_ror:8 row_mask:0xf bank_mask:0x4
    v_add_f32_dpp v40, v36, v39 row_ror:12 row_mask:0xf bank_mask:0xf
    v_add_f32_dpp v41, v38, v37 row_ror:12 row_mask:0xf bank_mask:0xf
    s_waitcnt lgkmcnt(2)
    v_mfma_f32_16x16x32_bf16 v[36:39], v[48:51], v[8:11], 0
    ds_read_b128 v[44:47], v3 offset:20480
    v_add_f32_dpp v14, v41, v40 row_ror:8 row_mask:0xf bank_mask:0x8
    v_add_f32_dpp v40, v28, v31 row_ror:12 row_mask:0xf bank_mask:0xf
    v_add_f32_dpp v41, v30, v29 row_ror:12 row_mask:0xf bank_mask:0xf
    s_waitcnt lgkmcnt(2)
    v_mfma_f32_16x16x32_bf16 v[28:31], v[52:55], v[8:11], 0
    ds_read_b128 v[48:51], v3 offset:21504
    v_add_f32_dpp v15, v41, v40 row_ror:8 row_mask:0xf bank_mask:0x8
    v_add_f32_dpp v40, v33, v32 row_ror:12 row_mask:0xf bank_mask:0xf
    v_add_f32_dpp v41, v35, v34 row_ror:12 row_mask:0xf bank_mask:0xf
    s_waitcnt lgkmcnt(2)
    v_mfma_f32_16x16x32_bf16 v[32:35], v[56:59], v[8:11], 0
    ds_read_b128 v[52:55], v3 offset:22528
    v_add_f32_dpp v16, v41, v40 row_ror:8 row_mask:0xf bank_mask:0x1
    v_add_f32_dpp v40, v37, v36 row_ror:12 row_mask:0xf bank_mask:0xf
    v_add_f32_dpp v41, v39, v38 row_ror:12 row_mask:0xf bank_mask:0xf
    s_waitcnt lgkmcnt(2)
    v_mfma_f32_16x16x32_bf16 v[36:39], v[44:47], v[8:11], 0
    ds_read_b128 v[56:59], v3 offset:23552
    v_add_f32_dpp v17, v41, v40 row_ror:8 row_mask:0xf bank_mask:0x1
    v_add_f32_dpp v40, v30, v29 row_ror:12 row_mask:0xf bank_mask:0xf
    v_add_f32_dpp v41, v28, v31 row_ror:12 row_mask:0xf bank_mask:0xf
    s_waitcnt lgkmcnt(2)
    v_mfma_f32_16x16x32_bf16 v[28:31], v[48:51], v[8:11], 0
    ds_read_b128 v[44:47], v3 offset:24576
    v_add_f32_dpp v16, v41, v40 row_ror:8 row_mask:0xf bank_mask:0x2
    v_add_f32_dpp v40, v34, v33 row_ror:12 row_mask:0xf bank_mask:0xf
    v_add_f32_dpp v41, v32, v35 row_ror:12 row_mask:0xf bank_mask:0xf
    s_waitcnt lgkmcnt(2)
    v_mfma_f32_16x16x32_bf16 v[32:35], v[52:55], v[8:11], 0
    ds_read_b128 v[48:51], v3 offset:25600
    v_add_f32_dpp v17, v41, v40 row_ror:8 row_mask:0xf bank_mask:0x2
    v_add_f32_dpp v40, v39, v38 row_ror:12 row_mask:0xf bank_mask:0xf
    v_add_f32_dpp v41, v37, v36 row_ror:12 row_mask:0xf bank_mask:0xf
    s_waitcnt lgkmcnt(2)
    v_mfma_f32_16x16x32_bf16 v[36:39], v[56:59], v[8:11], 0
    ds_read_b128 v[52:55], v3 offset:26624
    v_add_f32_dpp v16, v41, v40 row_ror:8 row_mask:0xf bank_mask:0x4
    v_add_f32_dpp v40, v31, v30 row_ror:12 row_mask:0xf bank_mask:0xf
    v_add_f32_dpp v41, v29, v28 row_ror:12 row_mask:0xf bank_mask:0xf
    s_waitcnt lgkmcnt(2)
    v_mfma_f32_16x16x32_bf16 v[28:31], v[44:47], v[8:11], 0
    ds_read_b128 v[56:59], v3 offset:27648
    v_add_f32_dpp v17, v41, v40 row_ror:8 row_mask:0xf bank_mask:0x4
    v_add_f32_dpp v40, v32, v35 row_ror:12 row_mask:0xf bank_mask:0xf
    v_add_f32_dpp v41, v34, v33 row_ror:12 row_mask:0xf bank_mask:0xf
    s_waitcnt lgkmcnt(2)
    v_mfma_f32_16x16x32_bf16 v[32:35], v[48:51], v[8:11], 0
    ds_read_b128 v[44:47], v3 offset:28672
    v_add_f32_dpp v16, v41, v40 row_ror:8 row_mask:0xf bank_mask:0x8
    v_add_f32_dpp v40, v36, v39 row_ror:12 row_mask:0xf bank_mask:0xf
    v_add_f32_dpp v41, v38, v37 row_ror:12 row_mask:0xf bank_mask:0xf
    s_waitcnt lgkmcnt(2)
    v_mfma_f32_16x16x32_bf16 v[36:39], v[52:55], v[8:11], 0
    ds_read_b128 v[48:51], v3 offset:29696
    v_add_f32_dpp v17, v41, v40 row_ror:8 row_mask:0xf bank_mask:0x8
    v_add_f32_dpp v40, v29, v28 row_ror:12 row_mask:0xf bank_mask:0xf
    v_add_f32_dpp v41, v31, v30 row_ror:12 row_mask:0xf bank_mask:0xf
    s_waitcnt lgkmcnt(2)
    v_mfma_f32_16x16x32_bf16 v[28:31], v[56:59], v[8:11], 0
    ds_read_b128 v[52:55], v3 offset:30720
    v_add_f32_dpp v18, v41, v40 row_ror:8 row_mask:0xf bank_mask:0x1
    v_add_f32_dpp v40, v33, v32 row_ror:12 row_mask:0xf bank_mask:0xf
    v_add_f32_dpp v41, v35, v34 row_ror:12 row_mask:0xf bank_mask:0xf
    s_waitcnt lgkmcnt(2)
    v_mfma_f32_16x16x32_bf16 v[32:35], v[44:47], v[8:11], 0
    ds_read_b128 v[56:59], v3 offset:31744
    v_add_f32_dpp v19, v41, v40 row_ror:8 row_mask:0xf bank_mask:0x1
    v_add_f32_dpp v40, v38, v37 row_ror:12 row_mask:0xf bank_mask:0xf
    v_add_f32_dpp v41, v36, v39 row_ror:12 row_mask:0xf bank_mask:0xf
    s_waitcnt lgkmcnt(2)
    v_mfma_f32_16x16x32_bf16 v[36:39], v[48:51], v[8:11], 0
    ds_read_b128 v[44:47], v3 offset:32768
    v_add_f32_dpp v18, v41, v40 row_ror:8 row_mask:0xf bank_mask:0x2
    v_add_f32_dpp v40, v30, v29 row_ror:12 row_mask:0xf bank_mask:0xf
    v_add_f32_dpp v41, v28, v31 row_ror:12 row_mask:0xf bank_mask:0xf
    s_waitcnt lgkmcnt(2)
    v_mfma_f32_16x16x32_bf16 v[28:31], v[52:55], v[8:11], 0
    ds_read_b128 v[48:51], v3 offset:33792
    v_add_f32_dpp v19, v41, v40 row_ror:8 row_mask:0xf bank_mask:0x2
    v_add_f32_dpp v40, v35, v34 row_ror:12 row_mask:0xf bank_mask:0xf
    v_add_f32_dpp v41, v33, v32 row_ror:12 row_mask:0xf bank_mask:0xf
    s_waitcnt lgkmcnt(2)
    v_mfma_f32_16x16x32_bf16 v[32:35], v[56:59], v[8:11], 0
    ds_read_b128 v[52:55], v3 offset:34816
    v_add_f32_dpp v18, v41, v40 row_ror:8 row_mask:0xf bank_mask:0x4
    v_add_f32_dpp v40, v39, v38 row_ror:12 row_mask:0xf bank_mask:0xf
    v_add_f32_dpp v41, v37, v36 row_ror:12 row_mask:0xf bank_mask:0xf
    s_waitcnt lgkmcnt(2)
    v_mfma_f32_16x16x32_bf16 v[36:39], v[44:47], v[8:11], 0
    ds_read_b128 v[56:59], v3 offset:35840
    v_add_f32_dpp v19, v41, v40 row_ror:8 row_mask:0xf bank_mask:0x4
    v_add_f32_dpp v40, v28, v31 row_ror:12 row_mask:0xf bank_mask:0xf
    v_add_f32_dpp v41, v30, v29 row_ror:12 row_mask:0xf bank_mask:0xf
    s_waitcnt lgkmcnt(2)
    v_mfma_f32_16x16x32_bf16 v[28:31], v[48:51], v[8:11], 0
    ds_read_b128 v[44:47], v3 offset:36864
    v_add_f32_dpp v18, v41, v40 row_ror:8 row_mask:0xf bank_mask:0x8
    v_add_f32_dpp v40, v32, v35 row_ror:12 row_mask:0xf bank_mask:0xf
    v_add_f32_dpp v41, v34, v33 row_ror:12 row_mask:0xf bank_mask:0xf
    s_waitcnt lgkmcnt(2)
    v_mfma_f32_16x16x32_bf16 v[32:35], v[52:55], v[8:11], 0
    v_add_f32_dpp v19, v41, v40 row_ror:8 row_mask:0xf bank_mask:0x8
    v_add_f32_dpp v40, v37, v36 row_ror:12 row_mask:0xf bank_mask:0xf
    v_add_f32_dpp v41, v39, v38 row_ror:12 row_mask:0xf bank_mask:0xf
    s_waitcnt lgkmcnt(1)
    v_mfma_f32_16x16x32_bf16 v[36:39], v[56:59], v[8:11], 0
    v_add_f32_dpp v20, v41, v40 row_ror:8 row_mask:0xf bank_mask:0x1
    v_add_f32_dpp v40, v29, v28 row_ror:12 row_mask:0xf bank_mask:0xf
    v_add_f32_dpp v41, v31, v30 row_ror:12 row_mask:0xf bank_mask:0xf
    s_waitcnt lgkmcnt(0)
    v_mfma_f32_16x16x32_bf16 v[28:31], v[44:47], v[8:11], 0
    v_add_f32_dpp v21, v41, v40 row_ror:8 row_mask:0xf bank_mask:0x1
    v_add_f32_dpp v40, v34, v33 row_ror:12 row_mask:0xf bank_mask:0xf
    v_add_f32_dpp v41, v32, v35 row_ror:12 row_mask:0xf bank_mask:0xf
    s_nop 1
    v_add_f32_dpp v20, v41, v40 row_ror:8 row_mask:0xf bank_mask:0x2
    v_add_f32_dpp v40, v38, v37 row_ror:12 row_mask:0xf bank_mask:0xf
    v_add_f32_dpp v41, v36, v39 row_ror:12 row_mask:0xf bank_mask:0xf
    s_nop 1
    v_add_f32_dpp v21, v41, v40 row_ror:8 row_mask:0xf bank_mask:0x2
    v_add_f32_dpp v40, v31, v30 row_ror:12 row_mask:0xf bank_mask:0xf
    v_add_f32_dpp v41, v29, v28 row_ror:12 row_mask:0xf bank_mask:0xf
    s_nop 1
    v_add_f32_dpp v20, v41, v40 row_ror:8 row_mask:0xf bank_mask:0x4
    s_mov_b32 s61, 1114112
    s_waitcnt lgkmcnt(0)
    s_call_b64 s[86:87], S_sm
    v_mov_b32 v28, 0
    v_mov_b32 v29, 0
    v_mov_b32 v30, 0
    v_mov_b32 v31, 0
    v_mov_b32 v32, 0
    v_mov_b32 v33, 0
    v_mov_b32 v34, 0
    v_mov_b32 v35, 0
    v_mov_b32 v36, 0
    v_mov_b32 v37, 0
    v_mov_b32 v38, 0
    v_mov_b32 v39, 0
    v_mov_b32 v40, 0
    v_mov_b32 v41, 0
    v_mov_b32 v42, 0
    v_mov_b32 v43, 0
    v_mov_b32_dpp v28, v19 quad_perm:[0,1,2,3] row_mask:0xf bank_mask:0x1
    v_mov_b32_dpp v29, v19 row_shl:4 row_mask:0xf bank_mask:0x1
    v_mov_b32_dpp v30, v19 row_shl:8 row_mask:0xf bank_mask:0x1
    v_mov_b32_dpp v31, v19 row_shl:12 row_mask:0xf bank_mask:0x1
    v_mov_b32_dpp v32, v19 row_shr:4 row_mask:0xf bank_mask:0x2
    v_mov_b32_dpp v33, v19 quad_perm:[0,1,2,3] row_mask:0xf bank_mask:0x2
    v_mov_b32_dpp v34, v19 row_shl:4 row_mask:0xf bank_mask:0x2
    v_mov_b32_dpp v35, v19 row_shl:8 row_mask:0xf bank_mask:0x2
    v_mov_b32_dpp v36, v19 row_shr:8 row_mask:0xf bank_mask:0x4
    v_mov_b32_dpp v37, v19 row_shr:4 row_mask:0xf bank_mask:0x4
    v_mov_b32_dpp v38, v19 quad_perm:[0,1,2,3] row_mask:0xf bank_mask:0x4
    v_mov_b32_dpp v39, v19 row_shl:4 row_mask:0xf bank_mask:0x4
    v_mov_b32_dpp v40, v19 row_shr:12 row_mask:0xf bank_mask:0x8
    v_mov_b32_dpp v41, v19 row_shr:8 row_mask:0xf bank_mask:0x8
    v_mov_b32_dpp v42, v19 row_shr:4 row_mask:0xf bank_mask:0x8
    v_mov_b32_dpp v43, v19 quad_perm:[0,1,2,3] row_mask:0xf bank_mask:0x8
    v_accvgpr_read_b32 v52, a144
    v_perm_b32 v20, v68, v52, s74
    v_perm_b32 v21, v76, v72, s74
    v_perm_b32 v22, v84, v80, s74
    v_perm_b32 v23, v92, v88, s74
    v_perm_b32 v24, v68, v52, s75
    v_perm_b32 v25, v76, v72, s75
    v_perm_b32 v26, v84, v80, s75
    v_perm_b32 v27, v92, v88, s75
    v_mfma_f32_16x16x32_bf16 v[44:47], v[28:31], v[20:23], 0
    v_accvgpr_read_b32 v52, a145
    v_perm_b32 v20, v69, v52, s74
    v_perm_b32 v21, v77, v73, s74
    v_perm_b32 v22, v85, v81, s74
    v_perm_b32 v23, v93, v89, s74
    v_mfma_f32_16x16x32_bf16 v[44:47], v[32:35], v[24:27], v[44:47]
    v_perm_b32 v24, v69, v52, s75
    v_perm_b32 v25, v77, v73, s75
    v_perm_b32 v26, v85, v81, s75
    v_perm_b32 v27, v93, v89, s75
    v_mfma_f32_16x16x32_bf16 v[44:47], v[36:39], v[20:23], v[44:47]
    v_accvgpr_read_b32 v52, a146
    v_perm_b32 v20, v70, v52, s74
    v_perm_b32 v21, v78, v74, s74
    v_perm_b32 v22, v86, v82, s74
    v_perm_b32 v23, v94, v90, s74
    v_mfma_f32_16x16x32_bf16 v[44:47], v[40:43], v[24:27], v[44:47]
    v_perm_b32 v24, v70, v52, s75
    v_perm_b32 v25, v78, v74, s75
    v_perm_b32 v26, v86, v82, s75
    v_perm_b32 v27, v94, v90, s75
    v_mfma_f32_16x16x32_bf16 v[48:51], v[28:31], v[20:23], 0
    v_accvgpr_read_b32 v52, a147
    v_perm_b32 v20, v71, v52, s74
    v_perm_b32 v21, v79, v75, s74
    v_perm_b32 v22, v87, v83, s74
    v_perm_b32 v23, v95, v91, s74
    v_mfma_f32_16x16x32_bf16 v[48:51], v[32:35], v[24:27], v[48:51]
    v_perm_b32 v24, v71, v52, s75
    v_perm_b32 v25, v79, v75, s75
    v_perm_b32 v26, v87, v83, s75
    v_perm_b32 v27, v95, v91, s75
    v_mfma_f32_16x16x32_bf16 v[48:51], v[36:39], v[20:23], v[48:51]
    s_mov_b32 s48, 147456
    buffer_load_dwordx4 v[68:71], v2, s[12:15], s48 offen offset:0 nt
    buffer_load_dwordx4 v[72:75], v2, s[12:15], s48 offen offset:1024 nt
    buffer_load_dwordx4 v[76:79], v2, s[12:15], s48 offen offset:2048 nt
    buffer_load_dwordx4 v[80:83], v2, s[12:15], s48 offen offset:3072 nt
    v_mfma_f32_16x16x32_bf16 v[48:51], v[40:43], v[24:27], v[48:51]
    s_nop 6
    s_call_b64 s[86:87], S_sm2
    v_mov_b32_dpp v28, v12 quad_perm:[0,1,2,3] row_mask:0xf bank_mask:0x1
    v_mov_b32_dpp v29, v12 row_shl:4 row_mask:0xf bank_mask:0x1
    v_mov_b32_dpp v30, v12 row_shl:8 row_mask:0xf bank_mask:0x1
    v_mov_b32_dpp v31, v12 row_shl:12 row_mask:0xf bank_mask:0x1
    v_mov_b32_dpp v32, v12 row_shr:4 row_mask:0xf bank_mask:0x2
    v_mov_b32_dpp v33, v12 quad_perm:[0,1,2,3] row_mask:0xf bank_mask:0x2
    v_mov_b32_dpp v34, v12 row_shl:4 row_mask:0xf bank_mask:0x2
    v_mov_b32_dpp v35, v12 row_shl:8 row_mask:0xf bank_mask:0x2
    v_mov_b32_dpp v36, v12 row_shr:8 row_mask:0xf bank_mask:0x4
    v_mov_b32_dpp v37, v12 row_shr:4 row_mask:0xf bank_mask:0x4
    v_mov_b32_dpp v38, v12 quad_perm:[0,1,2,3] row_mask:0xf bank_mask:0x4
    v_mov_b32_dpp v39, v12 row_shl:4 row_mask:0xf bank_mask:0x4
    v_mov_b32_dpp v40, v12 row_shr:12 row_mask:0xf bank_mask:0x8
    v_mov_b32_dpp v41, v12 row_shr:8 row_mask:0xf bank_mask:0x8
    v_mov_b32_dpp v42, v12 row_shr:4 row_mask:0xf bank_mask:0x8
    v_mov_b32_dpp v43, v12 quad_perm:[0,1,2,3] row_mask:0xf bank_mask:0x8
    s_waitcnt vmcnt(39)
    s_mov_b32 s48, 163840
    buffer_load_dwordx4 v[84:87], v2, s[12:15], s48 offen offset:0 nt
    s_waitcnt vmcnt(39)
    buffer_load_dwordx4 v[88:91], v2, s[12:15], s48 offen offset:1024 nt
    s_waitcnt vmcnt(39)
    buffer_load_dwordx4 v[92:95], v2, s[12:15], s48 offen offset:2048 nt
    s_waitcnt vmcnt(39)
    buffer_load_dwordx4 a[144:147], v2, s[12:15], s48 offen offset:3072 nt
    s_waitcnt vmcnt(39)
    s_waitcnt vmcnt(38)
    s_waitcnt vmcnt(37)
    s_waitcnt vmcnt(36)
    v_accvgpr_read_b32 v59, a124
    v_perm_b32 v20, v108, v104, s74
    v_perm_b32 v21, v116, v112, s74
    v_perm_b32 v22, v124, v120, s74
    v_perm_b32 v23, v59, v128, s74
    v_perm_b32 v24, v108, v104, s75
    v_perm_b32 v25, v116, v112, s75
    v_perm_b32 v26, v124, v120, s75
    v_perm_b32 v27, v59, v128, s75
    v_mfma_f32_16x16x32_bf16 v[44:47], v[28:31], v[20:23], v[44:47]
    v_accvgpr_read_b32 v59, a125
    v_perm_b32 v20, v109, v105, s74
    v_perm_b32 v21, v117, v113, s74
    v_perm_b32 v22, v125, v121, s74
    v_perm_b32 v23, v59, v129, s74
    v_mfma_f32_16x16x32_bf16 v[44:47], v[32:35], v[24:27], v[44:47]
    v_perm_b32 v24, v109, v105, s75
    v_perm_b32 v25, v117, v113, s75
    v_perm_b32 v26, v125, v121, s75
    v_perm_b32 v27, v59, v129, s75
    v_mfma_f32_16x16x32_bf16 v[44:47], v[36:39], v[20:23], v[44:47]
    v_accvgpr_read_b32 v59, a126
    v_perm_b32 v20, v110, v106, s74
    v_perm_b32 v21, v118, v114, s74
    v_perm_b32 v22, v126, v122, s74
    v_perm_b32 v23, v59, v130, s74
    v_mfma_f32_16x16x32_bf16 v[44:47], v[40:43], v[24:27], v[44:47]
    v_perm_b32 v24, v110, v106, s75
    v_perm_b32 v25, v118, v114, s75
    v_perm_b32 v26, v126, v122, s75
    v_perm_b32 v27, v59, v130, s75
    v_mfma_f32_16x16x32_bf16 v[48:51], v[28:31], v[20:23], v[48:51]
    v_accvgpr_read_b32 v59, a127
    v_perm_b32 v20, v111, v107, s74
    v_perm_b32 v21, v119, v115, s74
    v_perm_b32 v22, v127, v123, s74
    v_perm_b32 v23, v59, v131, s74
    v_mfma_f32_16x16x32_bf16 v[48:51], v[32:35], v[24:27], v[48:51]
    v_perm_b32 v24, v111, v107, s75
    v_perm_b32 v25, v119, v115, s75
    v_perm_b32 v26, v127, v123, s75
    v_perm_b32 v27, v59, v131, s75
    v_mfma_f32_16x16x32_bf16 v[48:51], v[36:39], v[20:23], v[48:51]
    s_mov_b32 s48, 180224
    buffer_load_dwordx4 v[104:107], v2, s[12:15], s48 offen offset:0 nt
    buffer_load_dwordx4 v[108:111], v2, s[12:15], s48 offen offset:1024 nt
    buffer_load_dwordx4 v[112:115], v2, s[12:15], s48 offen offset:2048 nt
    buffer_load_dwordx4 v[116:119], v2, s[12:15], s48 offen offset:3072 nt
    v_mfma_f32_16x16x32_bf16 v[48:51], v[40:43], v[24:27], v[48:51]
    v_mov_b32_dpp v28, v13 quad_perm:[0,1,2,3] row_mask:0xf bank_mask:0x1
    v_mov_b32_dpp v29, v13 row_shl:4 row_mask:0xf bank_mask:0x1
    v_mov_b32_dpp v30, v13 row_shl:8 row_mask:0xf bank_mask:0x1
    v_mov_b32_dpp v31, v13 row_shl:12 row_mask:0xf bank_mask:0x1
    v_mov_b32_dpp v32, v13 row_shr:4 row_mask:0xf bank_mask:0x2
    v_mov_b32_dpp v33, v13 quad_perm:[0,1,2,3] row_mask:0xf bank_mask:0x2
    v_mov_b32_dpp v34, v13 row_shl:4 row_mask:0xf bank_mask:0x2
    v_mov_b32_dpp v35, v13 row_shl:8 row_mask:0xf bank_mask:0x2
    v_mov_b32_dpp v36, v13 row_shr:8 row_mask:0xf bank_mask:0x4
    v_mov_b32_dpp v37, v13 row_shr:4 row_mask:0xf bank_mask:0x4
    v_mov_b32_dpp v38, v13 quad_perm:[0,1,2,3] row_mask:0xf bank_mask:0x4
    v_mov_b32_dpp v39, v13 row_shl:4 row_mask:0xf bank_mask:0x4
    v_mov_b32_dpp v40, v13 row_shr:12 row_mask:0xf bank_mask:0x8
    v_mov_b32_dpp v41, v13 row_shr:8 row_mask:0xf bank_mask:0x8
    v_mov_b32_dpp v42, v13 row_shr:4 row_mask:0xf bank_mask:0x8
    v_mov_b32_dpp v43, v13 quad_perm:[0,1,2,3] row_mask:0xf bank_mask:0x8
    s_waitcnt vmcnt(39)
    s_mov_b32 s48, 196608
    buffer_load_dwordx4 v[120:123], v2, s[12:15], s48 offen offset:0 nt
    s_waitcnt vmcnt(39)
    buffer_load_dwordx4 v[124:127], v2, s[12:15], s48 offen offset:1024 nt
    s_waitcnt vmcnt(39)
    buffer_load_dwordx4 v[128:131], v2, s[12:15], s48 offen offset:2048 nt
    s_waitcnt vmcnt(39)
    buffer_load_dwordx4 a[124:127], v2, s[12:15], s48 offen offset:3072 nt
    s_waitcnt vmcnt(39)
    s_waitcnt vmcnt(38)
    s_waitcnt vmcnt(37)
    s_waitcnt vmcnt(36)
    v_accvgpr_read_b32 v52, a128
    v_accvgpr_read_b32 v53, a0
    v_accvgpr_read_b32 v54, a4
    v_accvgpr_read_b32 v55, a8
    v_accvgpr_read_b32 v56, a12
    v_accvgpr_read_b32 v57, a16
    v_accvgpr_read_b32 v58, a20
    v_accvgpr_read_b32 v59, a24
    v_perm_b32 v20, v53, v52, s74
    v_perm_b32 v21, v55, v54, s74
    v_perm_b32 v22, v57, v56, s74
    v_perm_b32 v23, v59, v58, s74
    v_perm_b32 v24, v53, v52, s75
    v_perm_b32 v25, v55, v54, s75
    v_perm_b32 v26, v57, v56, s75
    v_perm_b32 v27, v59, v58, s75
    v_mfma_f32_16x16x32_bf16 v[44:47], v[28:31], v[20:23], v[44:47]
    v_accvgpr_read_b32 v52, a129
    v_accvgpr_read_b32 v53, a1
    v_accvgpr_read_b32 v54, a5
    v_accvgpr_read_b32 v55, a9
    v_accvgpr_read_b32 v56, a13
    v_accvgpr_read_b32 v57, a17
    v_accvgpr_read_b32 v58, a21
    v_accvgpr_read_b32 v59, a25
    v_perm_b32 v20, v53, v52, s74
    v_perm_b32 v21, v55, v54, s74
    v_perm_b32 v22, v57, v56, s74
    v_perm_b32 v23, v59, v58, s74
    v_mfma_f32_16x16x32_bf16 v[44:47], v[32:35], v[24:27], v[44:47]
    v_perm_b32 v24, v53, v52, s75
    v_perm_b32 v25, v55, v54, s75
    v_perm_b32 v26, v57, v56, s75
    v_perm_b32 v27, v59, v58, s75
    v_mfma_f32_16x16x32_bf16 v[44:47], v[36:39], v[20:23], v[44:47]
    v_accvgpr_read_b32 v52, a130
    v_accvgpr_read_b32 v53, a2
    v_accvgpr_read_b32 v54, a6
    v_accvgpr_read_b32 v55, a10
    v_accvgpr_read_b32 v56, a14
    v_accvgpr_read_b32 v57, a18
    v_accvgpr_read_b32 v58, a22
    v_accvgpr_read_b32 v59, a26
    v_perm_b32 v20, v53, v52, s74
    v_perm_b32 v21, v55, v54, s74
    v_perm_b32 v22, v57, v56, s74
    v_perm_b32 v23, v59, v58, s74
    v_mfma_f32_16x16x32_bf16 v[44:47], v[40:43], v[24:27], v[44:47]
    v_perm_b32 v24, v53, v52, s75
    v_perm_b32 v25, v55, v54, s75
    v_perm_b32 v26, v57, v56, s75
    v_perm_b32 v27, v59, v58, s75
    v_mfma_f32_16x16x32_bf16 v[48:51], v[28:31], v[20:23], v[48:51]
    v_accvgpr_read_b32 v52, a131
    v_accvgpr_read_b32 v53, a3
    v_accvgpr_read_b32 v54, a7
    v_accvgpr_read_b32 v55, a11
    v_accvgpr_read_b32 v56, a15
    v_accvgpr_read_b32 v57, a19
    v_accvgpr_read_b32 v58, a23
    v_accvgpr_read_b32 v59, a27
    v_perm_b32 v20, v53, v52, s74
    v_perm_b32 v21, v55, v54, s74
    v_perm_b32 v22, v57, v56, s74
    v_perm_b32 v23, v59, v58, s74
    v_mfma_f32_16x16x32_bf16 v[48:51], v[32:35], v[24:27], v[48:51]
    v_perm_b32 v24, v53, v52, s75
    v_perm_b32 v25, v55, v54, s75
    v_perm_b32 v26, v57, v56, s75
    v_perm_b32 v27, v59, v58, s75
    v_mfma_f32_16x16x32_bf16 v[48:51], v[36:39], v[20:23], v[48:51]
    s_mov_b32 s48, 212992
    buffer_load_dwordx4 a[128:131], v2, s[12:15], s48 offen offset:0 nt
    buffer_load_dwordx4 a[0:3], v2, s[12:15], s48 offen offset:1024 nt
    buffer_load_dwordx4 a[4:7], v2, s[12:15], s48 offen offset:2048 nt
    buffer_load_dwordx4 a[8:11], v2, s[12:15], s48 offen offset:3072 nt
    v_mfma_f32_16x16x32_bf16 v[48:51], v[40:43], v[24:27], v[48:51]
    v_mov_b32_dpp v28, v14 quad_perm:[0,1,2,3] row_mask:0xf bank_mask:0x1
    v_mov_b32_dpp v29, v14 row_shl:4 row_mask:0xf bank_mask:0x1
    v_mov_b32_dpp v30, v14 row_shl:8 row_mask:0xf bank_mask:0x1
    v_mov_b32_dpp v31, v14 row_shl:12 row_mask:0xf bank_mask:0x1
    v_mov_b32_dpp v32, v14 row_shr:4 row_mask:0xf bank_mask:0x2
    v_mov_b32_dpp v33, v14 quad_perm:[0,1,2,3] row_mask:0xf bank_mask:0x2
    v_mov_b32_dpp v34, v14 row_shl:4 row_mask:0xf bank_mask:0x2
    v_mov_b32_dpp v35, v14 row_shl:8 row_mask:0xf bank_mask:0x2
    v_mov_b32_dpp v36, v14 row_shr:8 row_mask:0xf bank_mask:0x4
    v_mov_b32_dpp v37, v14 row_shr:4 row_mask:0xf bank_mask:0x4
    v_mov_b32_dpp v38, v14 quad_perm:[0,1,2,3] row_mask:0xf bank_mask:0x4
    v_mov_b32_dpp v39, v14 row_shl:4 row_mask:0xf bank_mask:0x4
    v_mov_b32_dpp v40, v14 row_shr:12 row_mask:0xf bank_mask:0x8
    v_mov_b32_dpp v41, v14 row_shr:8 row_mask:0xf bank_mask:0x8
    v_mov_b32_dpp v42, v14 row_shr:4 row_mask:0xf bank_mask:0x8
    v_mov_b32_dpp v43, v14 quad_perm:[0,1,2,3] row_mask:0xf bank_mask:0x8
    s_waitcnt vmcnt(39)
    s_waitcnt vmcnt(38)
    s_waitcnt vmcnt(37)
    s_waitcnt vmcnt(36)
    s_waitcnt vmcnt(35)
    s_waitcnt vmcnt(34)
    s_waitcnt vmcnt(33)
    s_waitcnt vmcnt(32)
    v_accvgpr_read_b32 v52, a28
    v_accvgpr_read_b32 v53, a32
    v_accvgpr_read_b32 v54, a36
    v_accvgpr_read_b32 v55, a40
    v_accvgpr_read_b32 v56, a44
    v_accvgpr_read_b32 v57, a48
    v_accvgpr_read_b32 v58, a52
    v_accvgpr_read_b32 v59, a56
    v_perm_b32 v20, v53, v52, s74
    v_perm_b32 v21, v55, v54, s74
    v_perm_b32 v22, v57, v56, s74
    v_perm_b32 v23, v59, v58, s74
    v_perm_b32 v24, v53, v52, s75
    v_perm_b32 v25, v55, v54, s75
    v_perm_b32 v26, v57, v56, s75
    v_perm_b32 v27, v59, v58, s75
    v_mfma_f32_16x16x32_bf16 v[44:47], v[28:31], v[20:23], v[44:47]
    v_accvgpr_read_b32 v52, a29
    v_accvgpr_read_b32 v53, a33
    v_accvgpr_read_b32 v54, a37
    v_accvgpr_read_b32 v55, a41
    v_accvgpr_read_b32 v56, a45
    v_accvgpr_read_b32 v57, a49
    v_accvgpr_read_b32 v58, a53
    v_accvgpr_read_b32 v59, a57
    v_perm_b32 v20, v53, v52, s74
    v_perm_b32 v21, v55, v54, s74
    v_perm_b32 v22, v57, v56, s74
    v_perm_b32 v23, v59, v58, s74
    v_mfma_f32_16x16x32_bf16 v[44:47], v[32:35], v[24:27], v[44:47]
    v_perm_b32 v24, v53, v52, s75
    v_perm_b32 v25, v55, v54, s75
    v_perm_b32 v26, v57, v56, s75
    v_perm_b32 v27, v59, v58, s75
    v_mfma_f32_16x16x32_bf16 v[44:47], v[36:39], v[20:23], v[44:47]
    v_accvgpr_read_b32 v52, a30
    v_accvgpr_read_b32 v53, a34
    v_accvgpr_read_b32 v54, a38
    v_accvgpr_read_b32 v55, a42
    v_accvgpr_read_b32 v56, a46
    v_accvgpr_read_b32 v57, a50
    v_accvgpr_read_b32 v58, a54
    v_accvgpr_read_b32 v59, a58
    v_perm_b32 v20, v53, v52, s74
    v_perm_b32 v21, v55, v54, s74
    v_perm_b32 v22, v57, v56, s74
    v_perm_b32 v23, v59, v58, s74
    v_mfma_f32_16x16x32_bf16 v[44:47], v[40:43], v[24:27], v[44:47]
    v_perm_b32 v24, v53, v52, s75
    v_perm_b32 v25, v55, v54, s75
    v_perm_b32 v26, v57, v56, s75
    v_perm_b32 v27, v59, v58, s75
    v_mfma_f32_16x16x32_bf16 v[48:51], v[28:31], v[20:23], v[48:51]
    v_accvgpr_read_b32 v52, a31
    v_accvgpr_read_b32 v53, a35
    v_accvgpr_read_b32 v54, a39
    v_accvgpr_read_b32 v55, a43
    v_accvgpr_read_b32 v56, a47
    v_accvgpr_read_b32 v57, a51
    v_accvgpr_read_b32 v58, a55
    v_accvgpr_read_b32 v59, a59
    v_perm_b32 v20, v53, v52, s74
    v_perm_b32 v21, v55, v54, s74
    v_perm_b32 v22, v57, v56, s74
    v_perm_b32 v23, v59, v58, s74
    v_mfma_f32_16x16x32_bf16 v[48:51], v[32:35], v[24:27], v[48:51]
    v_perm_b32 v24, v53, v52, s75
    v_perm_b32 v25, v55, v54, s75
    v_perm_b32 v26, v57, v56, s75
    v_perm_b32 v27, v59, v58, s75
    v_mfma_f32_16x16x32_bf16 v[48:51], v[36:39], v[20:23], v[48:51]
    s_nop 0
    v_mfma_f32_16x16x32_bf16 v[48:51], v[40:43], v[24:27], v[48:51]
    v_mov_b32_dpp v28, v15 quad_perm:[0,1,2,3] row_mask:0xf bank_mask:0x1
    v_mov_b32_dpp v29, v15 row_shl:4 row_mask:0xf bank_mask:0x1
    v_mov_b32_dpp v30, v15 row_shl:8 row_mask:0xf bank_mask:0x1
    v_mov_b32_dpp v31, v15 row_shl:12 row_mask:0xf bank_mask:0x1
    v_mov_b32_dpp v32, v15 row_shr:4 row_mask:0xf bank_mask:0x2
    v_mov_b32_dpp v33, v15 quad_perm:[0,1,2,3] row_mask:0xf bank_mask:0x2
    v_mov_b32_dpp v34, v15 row_shl:4 row_mask:0xf bank_mask:0x2
    v_mov_b32_dpp v35, v15 row_shl:8 row_mask:0xf bank_mask:0x2
    v_mov_b32_dpp v36, v15 row_shr:8 row_mask:0xf bank_mask:0x4
    v_mov_b32_dpp v37, v15 row_shr:4 row_mask:0xf bank_mask:0x4
    v_mov_b32_dpp v38, v15 quad_perm:[0,1,2,3] row_mask:0xf bank_mask:0x4
    v_mov_b32_dpp v39, v15 row_shl:4 row_mask:0xf bank_mask:0x4
    v_mov_b32_dpp v40, v15 row_shr:12 row_mask:0xf bank_mask:0x8
    v_mov_b32_dpp v41, v15 row_shr:8 row_mask:0xf bank_mask:0x8
    v_mov_b32_dpp v42, v15 row_shr:4 row_mask:0xf bank_mask:0x8
    v_mov_b32_dpp v43, v15 quad_perm:[0,1,2,3] row_mask:0xf bank_mask:0x8
    s_waitcnt vmcnt(31)
    s_waitcnt vmcnt(30)
    s_waitcnt vmcnt(29)
    s_waitcnt vmcnt(28)
    s_waitcnt vmcnt(27)
    s_waitcnt vmcnt(26)
    s_waitcnt vmcnt(25)
    s_waitcnt vmcnt(24)
    v_accvgpr_read_b32 v52, a60
    v_accvgpr_read_b32 v53, a64
    v_accvgpr_read_b32 v54, a68
    v_accvgpr_read_b32 v55, a72
    v_accvgpr_read_b32 v56, a76
    v_accvgpr_read_b32 v57, a80
    v_accvgpr_read_b32 v58, a84
    v_accvgpr_read_b32 v59, a88
    v_perm_b32 v20, v53, v52, s74
    v_perm_b32 v21, v55, v54, s74
    v_perm_b32 v22, v57, v56, s74
    v_perm_b32 v23, v59, v58, s74
    v_perm_b32 v24, v53, v52, s75
    v_perm_b32 v25, v55, v54, s75
    v_perm_b32 v26, v57, v56, s75
    v_perm_b32 v27, v59, v58, s75
    v_mfma_f32_16x16x32_bf16 v[44:47], v[28:31], v[20:23], v[44:47]
    v_accvgpr_read_b32 v52, a61
    v_accvgpr_read_b32 v53, a65
    v_accvgpr_read_b32 v54, a69
    v_accvgpr_read_b32 v55, a73
    v_accvgpr_read_b32 v56, a77
    v_accvgpr_read_b32 v57, a81
    v_accvgpr_read_b32 v58, a85
    v_accvgpr_read_b32 v59, a89
    v_perm_b32 v20, v53, v52, s74
    v_perm_b32 v21, v55, v54, s74
    v_perm_b32 v22, v57, v56, s74
    v_perm_b32 v23, v59, v58, s74
    v_mfma_f32_16x16x32_bf16 v[44:47], v[32:35], v[24:27], v[44:47]
    v_perm_b32 v24, v53, v52, s75
    v_perm_b32 v25, v55, v54, s75
    v_perm_b32 v26, v57, v56, s75
    v_perm_b32 v27, v59, v58, s75
    v_mfma_f32_16x16x32_bf16 v[44:47], v[36:39], v[20:23], v[44:47]
    v_accvgpr_read_b32 v52, a62
    v_accvgpr_read_b32 v53, a66
    v_accvgpr_read_b32 v54, a70
    v_accvgpr_read_b32 v55, a74
    v_accvgpr_read_b32 v56, a78
    v_accvgpr_read_b32 v57, a82
    v_accvgpr_read_b32 v58, a86
    v_accvgpr_read_b32 v59, a90
    v_perm_b32 v20, v53, v52, s74
    v_perm_b32 v21, v55, v54, s74
    v_perm_b32 v22, v57, v56, s74
    v_perm_b32 v23, v59, v58, s74
    v_mfma_f32_16x16x32_bf16 v[44:47], v[40:43], v[24:27], v[44:47]
    v_perm_b32 v24, v53, v52, s75
    v_perm_b32 v25, v55, v54, s75
    v_perm_b32 v26, v57, v56, s75
    v_perm_b32 v27, v59, v58, s75
    v_mfma_f32_16x16x32_bf16 v[48:51], v[28:31], v[20:23], v[48:51]
    v_accvgpr_read_b32 v52, a63
    v_accvgpr_read_b32 v53, a67
    v_accvgpr_read_b32 v54, a71
    v_accvgpr_read_b32 v55, a75
    v_accvgpr_read_b32 v56, a79
    v_accvgpr_read_b32 v57, a83
    v_accvgpr_read_b32 v58, a87
    v_accvgpr_read_b32 v59, a91
    v_perm_b32 v20, v53, v52, s74
    v_perm_b32 v21, v55, v54, s74
    v_perm_b32 v22, v57, v56, s74
    v_perm_b32 v23, v59, v58, s74
    v_mfma_f32_16x16x32_bf16 v[48:51], v[32:35], v[24:27], v[48:51]
    v_perm_b32 v24, v53, v52, s75
    v_perm_b32 v25, v55, v54, s75
    v_perm_b32 v26, v57, v56, s75
    v_perm_b32 v27, v59, v58, s75
    v_mfma_f32_16x16x32_bf16 v[48:51], v[36:39], v[20:23], v[48:51]
    s_nop 0
    v_mfma_f32_16x16x32_bf16 v[48:51], v[40:43], v[24:27], v[48:51]
    v_mov_b32_dpp v28, v16 quad_perm:[0,1,2,3] row_mask:0xf bank_mask:0x1
    v_mov_b32_dpp v29, v16 row_shl:4 row_mask:0xf bank_mask:0x1
    v_mov_b32_dpp v30, v16 row_shl:8 row_mask:0xf bank_mask:0x1
    v_mov_b32_dpp v31, v16 row_shl:12 row_mask:0xf bank_mask:0x1
    v_mov_b32_dpp v32, v16 row_shr:4 row_mask:0xf bank_mask:0x2
    v_mov_b32_dpp v33, v16 quad_perm:[0,1,2,3] row_mask:0xf bank_mask:0x2
    v_mov_b32_dpp v34, v16 row_shl:4 row_mask:0xf bank_mask:0x2
    v_mov_b32_dpp v35, v16 row_shl:8 row_mask:0xf bank_mask:0x2
    v_mov_b32_dpp v36, v16 row_shr:8 row_mask:0xf bank_mask:0x4
    v_mov_b32_dpp v37, v16 row_shr:4 row_mask:0xf bank_mask:0x4
    v_mov_b32_dpp v38, v16 quad_perm:[0,1,2,3] row_mask:0xf bank_mask:0x4
    v_mov_b32_dpp v39, v16 row_shl:4 row_mask:0xf bank_mask:0x4
    v_mov_b32_dpp v40, v16 row_shr:12 row_mask:0xf bank_mask:0x8
    v_mov_b32_dpp v41, v16 row_shr:8 row_mask:0xf bank_mask:0x8
    v_mov_b32_dpp v42, v16 row_shr:4 row_mask:0xf bank_mask:0x8
    v_mov_b32_dpp v43, v16 quad_perm:[0,1,2,3] row_mask:0xf bank_mask:0x8
    s_waitcnt vmcnt(23)
    s_waitcnt vmcnt(22)
    s_waitcnt vmcnt(21)
    s_waitcnt vmcnt(20)
    s_waitcnt vmcnt(19)
    s_waitcnt vmcnt(18)
    s_waitcnt vmcnt(17)
    s_waitcnt vmcnt(16)
    v_accvgpr_read_b32 v52, a92
    v_accvgpr_read_b32 v53, a96
    v_accvgpr_read_b32 v54, a100
    v_accvgpr_read_b32 v55, a104
    v_perm_b32 v20, v53, v52, s74
    v_perm_b32 v21, v55, v54, s74
    v_perm_b32 v22, v72, v68, s74
    v_perm_b32 v23, v80, v76, s74
    v_perm_b32 v24, v53, v52, s75
    v_perm_b32 v25, v55, v54, s75
    v_perm_b32 v26, v72, v68, s75
    v_perm_b32 v27, v80, v76, s75
    v_mfma_f32_16x16x32_bf16 v[44:47], v[28:31], v[20:23], v[44:47]
    v_accvgpr_read_b32 v52, a93
    v_accvgpr_read_b32 v53, a97
    v_accvgpr_read_b32 v54, a101
    v_accvgpr_read_b32 v55, a105
    v_perm_b32 v20, v53, v52, s74
    v_perm_b32 v21, v55, v54, s74
    v_perm_b32 v22, v73, v69, s74
    v_perm_b32 v23, v81, v77, s74
    v_mfma_f32_16x16x32_bf16 v[44:47], v[32:35], v[24:27], v[44:47]
    v_perm_b32 v24, v53, v52, s75
    v_perm_b32 v25, v55, v54, s75
    v_perm_b32 v26, v73, v69, s75
    v_perm_b32 v27, v81, v77, s75
    v_mfma_f32_16x16x32_bf16 v[44:47], v[36:39], v[20:23], v[44:47]
    v_accvgpr_read_b32 v52, a94
    v_accvgpr_read_b32 v53, a98
    v_accvgpr_read_b32 v54, a102
    v_accvgpr_read_b32 v55, a106
    v_perm_b32 v20, v53, v52, s74
    v_perm_b32 v21, v55, v54, s74
    v_perm_b32 v22, v74, v70, s74
    v_perm_b32 v23, v82, v78, s74
    v_mfma_f32_16x16x32_bf16 v[44:47], v[40:43], v[24:27], v[44:47]
    v_perm_b32 v24, v53, v52, s75
    v_perm_b32 v25, v55, v54, s75
    v_perm_b32 v26, v74, v70, s75
    v_perm_b32 v27, v82, v78, s75
    v_mfma_f32_16x16x32_bf16 v[48:51], v[28:31], v[20:23], v[48:51]
    v_accvgpr_read_b32 v52, a95
    v_accvgpr_read_b32 v53, a99
    v_accvgpr_read_b32 v54, a103
    v_accvgpr_read_b32 v55, a107
    v_perm_b32 v20, v53, v52, s74
    v_perm_b32 v21, v55, v54, s74
    v_perm_b32 v22, v75, v71, s74
    v_perm_b32 v23, v83, v79, s74
    v_mfma_f32_16x16x32_bf16 v[48:51], v[32:35], v[24:27], v[48:51]
    v_perm_b32 v24, v53, v52, s75
    v_perm_b32 v25, v55, v54, s75
    v_perm_b32 v26, v75, v71, s75
    v_perm_b32 v27, v83, v79, s75
    v_mfma_f32_16x16x32_bf16 v[48:51], v[36:39], v[20:23], v[48:51]
    s_nop 0
    v_mfma_f32_16x16x32_bf16 v[48:51], v[40:43], v[24:27], v[48:51]
    v_mov_b32_dpp v28, v17 quad_perm:[0,1,2,3] row_mask:0xf bank_mask:0x1
    v_mov_b32_dpp v29, v17 row_shl:4 row_mask:0xf bank_mask:0x1
    v_mov_b32_dpp v30, v17 row_shl:8 row_mask:0xf bank_mask:0x1
    v_mov_b32_dpp v31, v17 row_shl:12 row_mask:0xf bank_mask:0x1
    v_mov_b32_dpp v32, v17 row_shr:4 row_mask:0xf bank_mask:0x2
    v_mov_b32_dpp v33, v17 quad_perm:[0,1,2,3] row_mask:0xf bank_mask:0x2
    v_mov_b32_dpp v34, v17 row_shl:4 row_mask:0xf bank_mask:0x2
    v_mov_b32_dpp v35, v17 row_shl:8 row_mask:0xf bank_mask:0x2
    v_mov_b32_dpp v36, v17 row_shr:8 row_mask:0xf bank_mask:0x4
    v_mov_b32_dpp v37, v17 row_shr:4 row_mask:0xf bank_mask:0x4
    v_mov_b32_dpp v38, v17 quad_perm:[0,1,2,3] row_mask:0xf bank_mask:0x4
    v_mov_b32_dpp v39, v17 row_shl:4 row_mask:0xf bank_mask:0x4
    v_mov_b32_dpp v40, v17 row_shr:12 row_mask:0xf bank_mask:0x8
    v_mov_b32_dpp v41, v17 row_shr:8 row_mask:0xf bank_mask:0x8
    v_mov_b32_dpp v42, v17 row_shr:4 row_mask:0xf bank_mask:0x8
    v_mov_b32_dpp v43, v17 quad_perm:[0,1,2,3] row_mask:0xf bank_mask:0x8
    s_waitcnt vmcnt(15)
    s_mov_b32 s48, 0
    s_add_u32 m0, s77, 4096
    s_nop 0
    buffer_load_dwordx4 v1, s[16:19], s48 offen offset:0 nt lds
    s_waitcnt vmcnt(15)
    s_add_u32 m0, s77, 4096
    s_nop 0
    buffer_load_dwordx4 v1, s[16:19], s48 offen offset:1024 nt lds
    s_waitcnt vmcnt(15)
    s_add_u32 m0, s77, 4096
    s_nop 0
    buffer_load_dwordx4 v1, s[16:19], s48 offen offset:2048 nt lds
    s_waitcnt vmcnt(15)
    s_add_u32 m0, s77, 4096
    s_nop 0
    buffer_load_dwordx4 v1, s[16:19], s48 offen offset:3072 nt lds
    s_waitcnt vmcnt(15)
    s_mov_b32 s48, 16384
    s_add_u32 m0, s77, 8192
    s_nop 0
    buffer_load_dwordx4 v1, s[16:19], s48 offen offset:0 nt lds
    s_waitcnt vmcnt(15)
    s_add_u32 m0, s77, 8192
    s_nop 0
    buffer_load_dwordx4 v1, s[16:19], s48 offen offset:1024 nt lds
    s_waitcnt vmcnt(15)
    s_add_u32 m0, s77, 8192
    s_nop 0
    buffer_load_dwordx4 v1, s[16:19], s48 offen offset:2048 nt lds
    s_waitcnt vmcnt(15)
    s_add_u32 m0, s77, 8192
    s_nop 0
    buffer_load_dwordx4 v1, s[16:19], s48 offen offset:3072 nt lds
    v_accvgpr_read_b32 v55, a144
    v_perm_b32 v20, v88, v84, s74
    v_perm_b32 v21, v55, v92, s74
    v_perm_b32 v22, v108, v104, s74
    v_perm_b32 v23, v116, v112, s74
    v_perm_b32 v24, v88, v84, s75
    v_perm_b32 v25, v55, v92, s75
    v_perm_b32 v26, v108, v104, s75
    v_perm_b32 v27, v116, v112, s75
    v_mfma_f32_16x16x32_bf16 v[44:47], v[28:31], v[20:23], v[44:47]
    v_accvgpr_read_b32 v55, a145
    v_perm_b32 v20, v89, v85, s74
    v_perm_b32 v21, v55, v93, s74
    v_perm_b32 v22, v109, v105, s74
    v_perm_b32 v23, v117, v113, s74
    v_mfma_f32_16x16x32_bf16 v[44:47], v[32:35], v[24:27], v[44:47]
    v_perm_b32 v24, v89, v85, s75
    v_perm_b32 v25, v55, v93, s75
    v_perm_b32 v26, v109, v105, s75
    v_perm_b32 v27, v117, v113, s75
    v_mfma_f32_16x16x32_bf16 v[44:47], v[36:39], v[20:23], v[44:47]
    v_accvgpr_read_b32 v55, a146
    v_perm_b32 v20, v90, v86, s74
    v_perm_b32 v21, v55, v94, s74
    v_perm_b32 v22, v110, v106, s74
    v_perm_b32 v23, v118, v114, s74
    v_mfma_f32_16x16x32_bf16 v[44:47], v[40:43], v[24:27], v[44:47]
    v_perm_b32 v24, v90, v86, s75
    v_perm_b32 v25, v55, v94, s75
    v_perm_b32 v26, v110, v106, s75
    v_perm_b32 v27, v118, v114, s75
    v_mfma_f32_16x16x32_bf16 v[48:51], v[28:31], v[20:23], v[48:51]
    v_accvgpr_read_b32 v55, a147
    v_perm_b32 v20, v91, v87, s74
    v_perm_b32 v21, v55, v95, s74
    v_perm_b32 v22, v111, v107, s74
    v_perm_b32 v23, v119, v115, s74
    v_mfma_f32_16x16x32_bf16 v[48:51], v[32:35], v[24:27], v[48:51]
    v_perm_b32 v24, v91, v87, s75
    v_perm_b32 v25, v55, v95, s75
    v_perm_b32 v26, v111, v107, s75
    v_perm_b32 v27, v119, v115, s75
    v_mfma_f32_16x16x32_bf16 v[48:51], v[36:39], v[20:23], v[48:51]
    s_nop 0
    v_mfma_f32_16x16x32_bf16 v[48:51], v[40:43], v[24:27], v[48:51]
    v_mov_b32_dpp v28, v18 quad_perm:[0,1,2,3] row_mask:0xf bank_mask:0x1
    v_mov_b32_dpp v29, v18 row_shl:4 row_mask:0xf bank_mask:0x1
    v_mov_b32_dpp v30, v18 row_shl:8 row_mask:0xf bank_mask:0x1
    v_mov_b32_dpp v31, v18 row_shl:12 row_mask:0xf bank_mask:0x1
    v_mov_b32_dpp v32, v18 row_shr:4 row_mask:0xf bank_mask:0x2
    v_mov_b32_dpp v33, v18 quad_perm:[0,1,2,3] row_mask:0xf bank_mask:0x2
    v_mov_b32_dpp v34, v18 row_shl:4 row_mask:0xf bank_mask:0x2
    v_mov_b32_dpp v35, v18 row_shl:8 row_mask:0xf bank_mask:0x2
    v_mov_b32_dpp v36, v18 row_shr:8 row_mask:0xf bank_mask:0x4
    v_mov_b32_dpp v37, v18 row_shr:4 row_mask:0xf bank_mask:0x4
    v_mov_b32_dpp v38, v18 quad_perm:[0,1,2,3] row_mask:0xf bank_mask:0x4
    v_mov_b32_dpp v39, v18 row_shl:4 row_mask:0xf bank_mask:0x4
    v_mov_b32_dpp v40, v18 row_shr:12 row_mask:0xf bank_mask:0x8
    v_mov_b32_dpp v41, v18 row_shr:8 row_mask:0xf bank_mask:0x8
    v_mov_b32_dpp v42, v18 row_shr:4 row_mask:0xf bank_mask:0x8
    v_mov_b32_dpp v43, v18 quad_perm:[0,1,2,3] row_mask:0xf bank_mask:0x8
    s_waitcnt vmcnt(15)
    s_mov_b32 s48, 32768
    s_add_u32 m0, s77, 12288
    s_nop 0
    buffer_load_dwordx4 v1, s[16:19], s48 offen offset:0 nt lds
    s_waitcnt vmcnt(15)
    s_add_u32 m0, s77, 12288
    s_nop 0
    buffer_load_dwordx4 v1, s[16:19], s48 offen offset:1024 nt lds
    s_waitcnt vmcnt(15)
    s_add_u32 m0, s77, 12288
    s_nop 0
    buffer_load_dwordx4 v1, s[16:19], s48 offen offset:2048 nt lds
    s_waitcnt vmcnt(15)
    s_add_u32 m0, s77, 12288
    s_nop 0
    buffer_load_dwordx4 v1, s[16:19], s48 offen offset:3072 nt lds
    s_waitcnt vmcnt(15)
    s_mov_b32 s48, 49152
    s_add_u32 m0, s77, 16384
    s_nop 0
    buffer_load_dwordx4 v1, s[16:19], s48 offen offset:0 nt lds
    s_waitcnt vmcnt(15)
    s_add_u32 m0, s77, 16384
    s_nop 0
    buffer_load_dwordx4 v1, s[16:19], s48 offen offset:1024 nt lds
    s_waitcnt vmcnt(15)
    s_add_u32 m0, s77, 16384
    s_nop 0
    buffer_load_dwordx4 v1, s[16:19], s48 offen offset:2048 nt lds
    s_waitcnt vmcnt(15)
    s_add_u32 m0, s77, 16384
    s_nop 0
    buffer_load_dwordx4 v1, s[16:19], s48 offen offset:3072 nt lds
    s_mov_b32 s60, 524288
    s_mov_b32 s62, 1179648
    s_mov_b32 s63, 2
    s_mov_b32 s82, 1
    s_mov_b32 s78, 2
    s_mov_b32 s83, 1
    s_mov_b32 s64, 64
    v_accvgpr_read_b32 v55, a124
    v_accvgpr_read_b32 v56, a128
    v_accvgpr_read_b32 v57, a0
    v_accvgpr_read_b32 v58, a4
    v_accvgpr_read_b32 v59, a8
    v_perm_b32 v20, v124, v120, s74
    v_perm_b32 v21, v55, v128, s74
    v_perm_b32 v22, v57, v56, s74
    v_perm_b32 v23, v59, v58, s74
    v_perm_b32 v24, v124, v120, s75
    v_perm_b32 v25, v55, v128, s75
    v_perm_b32 v26, v57, v56, s75
    v_perm_b32 v27, v59, v58, s75
    v_mfma_f32_16x16x32_bf16 v[44:47], v[28:31], v[20:23], v[44:47]
    v_accvgpr_read_b32 v55, a125
    v_accvgpr_read_b32 v56, a129
    v_accvgpr_read_b32 v57, a1
    v_accvgpr_read_b32 v58, a5
    v_accvgpr_read_b32 v59, a9
    v_perm_b32 v20, v125, v121, s74
    v_perm_b32 v21, v55, v129, s74
    v_perm_b32 v22, v57, v56, s74
    v_perm_b32 v23, v59, v58, s74
    v_mfma_f32_16x16x32_bf16 v[44:47], v[32:35], v[24:27], v[44:47]
    v_perm_b32 v24, v125, v121, s75
    v_perm_b32 v25, v55, v129, s75
    v_perm_b32 v26, v57, v56, s75
    v_perm_b32 v27, v59, v58, s75
    v_mfma_f32_16x16x32_bf16 v[44:47], v[36:39], v[20:23], v[44:47]
    v_accvgpr_read_b32 v55, a126
    v_accvgpr_read_b32 v56, a130
    v_accvgpr_read_b32 v57, a2
    v_accvgpr_read_b32 v58, a6
    v_accvgpr_read_b32 v59, a10
    v_perm_b32 v20, v126, v122, s74
    v_perm_b32 v21, v55, v130, s74
    v_perm_b32 v22, v57, v56, s74
    v_perm_b32 v23, v59, v58, s74
    v_mfma_f32_16x16x32_bf16 v[44:47], v[40:43], v[24:27], v[44:47]
    v_perm_b32 v24, v126, v122, s75
    v_perm_b32 v25, v55, v130, s75
    v_perm_b32 v26, v57, v56, s75
    v_perm_b32 v27, v59, v58, s75
    v_mfma_f32_16x16x32_bf16 v[48:51], v[28:31], v[20:23], v[48:51]
    v_accvgpr_read_b32 v55, a127
    v_accvgpr_read_b32 v56, a131
    v_accvgpr_read_b32 v57, a3
    v_accvgpr_read_b32 v58, a7
    v_accvgpr_read_b32 v59, a11
    v_perm_b32 v20, v127, v123, s74
    v_perm_b32 v21, v55, v131, s74
    v_perm_b32 v22, v57, v56, s74
    v_perm_b32 v23, v59, v58, s74
    v_mfma_f32_16x16x32_bf16 v[48:51], v[32:35], v[24:27], v[48:51]
    v_perm_b32 v24, v127, v123, s75
    v_perm_b32 v25, v55, v131, s75
    v_perm_b32 v26, v57, v56, s75
    v_perm_b32 v27, v59, v58, s75
    v_mfma_f32_16x16x32_bf16 v[48:51], v[36:39], v[20:23], v[48:51]
    s_nop 0
    v_mfma_f32_16x16x32_bf16 v[48:51], v[40:43], v[24:27], v[48:51]
    s_mov_b32 s65, 0
    s_mov_b32 s81, 0
    s_mov_b32 s100, 6
    s_mov_b32 s101, 4
    s_mov_b32 s5, 6
    s_mov_b32 s80, 0
    s_add_u32 s88, s94, NB_g2_0-L_pc
    s_addc_u32 s89, s95, 0
    s_call_b64 s[86:87], S_epi
    s_add_u32 s72, s65, 4
    s_min_u32 s72, s72, 19
L_flush_11:
    s_cmp_ge_u32 s65, s72
    s_cbranch_scc1 L_flushed_12
    s_swappc_b64 s[90:91], s[88:89]
    s_branch L_flush_11
L_flushed_12:
    v_mfma_f32_16x16x32_bf16 v[28:31], v[164:167], v[8:11], 0
    v_mfma_f32_16x16x32_bf16 v[32:35], v[168:171], v[8:11], 0
    v_mfma_f32_16x16x32_bf16 v[36:39], v[172:175], v[8:11], 0
    s_nop 5
    v_add_f32_dpp v40, v31, v30 row_ror:12 row_mask:0xf bank_mask:0xf
    v_add_f32_dpp v41, v29, v28 row_ror:12 row_mask:0xf bank_mask:0xf
    v_mfma_f32_16x16x32_bf16 v[28:31], v[176:179], v[8:11], 0
    s_nop 0
    v_add_f32_dpp v21, v41, v40 row_ror:8 row_mask:0xf bank_mask:0x4
    v_add_f32_dpp v40, v32, v35 row_ror:12 row_mask:0xf bank_mask:0xf
    v_add_f32_dpp v41, v34, v33 row_ror:12 row_mask:0xf bank_mask:0xf
    v_mfma_f32_16x16x32_bf16 v[32:35], v[180:183], v[8:11], 0
    s_nop 0
    v_add_f32_dpp v20, v41, v40 row_ror:8 row_mask:0xf bank_mask:0x8
    v_add_f32_dpp v40, v36, v39 row_ror:12 row_mask:0xf bank_mask:0xf
    v_add_f32_dpp v41, v38, v37 row_ror:12 row_mask:0xf bank_mask:0xf
    v_mfma_f32_16x16x32_bf16 v[36:39], v[184:187], v[8:11], 0
    s_nop 0
    v_add_f32_dpp v21, v41, v40 row_ror:8 row_mask:0xf bank_mask:0x8
    v_add_f32_dpp v40, v29, v28 row_ror:12 row_mask:0xf bank_mask:0xf
    v_add_f32_dpp v41, v31, v30 row_ror:12 row_mask:0xf bank_mask:0xf
    v_mfma_f32_16x16x32_bf16 v[28:31], v[188:191], v[8:11], 0
    s_nop 0
    v_add_f32_dpp v22, v41, v40 row_ror:8 row_mask:0xf bank_mask:0x1
    v_add_f32_dpp v40, v33, v32 row_ror:12 row_mask:0xf bank_mask:0xf
    v_add_f32_dpp v41, v35, v34 row_ror:12 row_mask:0xf bank_mask:0xf
    v_mfma_f32_16x16x32_bf16 v[32:35], v[192:195], v[8:11], 0
    s_nop 0
    v_add_f32_dpp v23, v41, v40 row_ror:8 row_mask:0xf bank_mask:0x1
    v_add_f32_dpp v40, v38, v37 row_ror:12 row_mask:0xf bank_mask:0xf
    v_add_f32_dpp v41, v36, v39 row_ror:12 row_mask:0xf bank_mask:0xf
    v_mfma_f32_16x16x32_bf16 v[36:39], v[196:199], v[8:11], 0
    s_nop 0
    v_add_f32_dpp v22, v41, v40 row_ror:8 row_mask:0xf bank_mask:0x2
    v_add_f32_dpp v40, v30, v29 row_ror:12 row_mask:0xf bank_mask:0xf
    v_add_f32_dpp v41, v28, v31 row_ror:12 row_mask:0xf bank_mask:0xf
    v_mfma_f32_16x16x32_bf16 v[28:31], v[200:203], v[8:11], 0
    s_nop 0
    v_add_f32_dpp v23, v41, v40 row_ror:8 row_mask:0xf bank_mask:0x2
    v_add_f32_dpp v40, v35, v34 row_ror:12 row_mask:0xf bank_mask:0xf
    v_add_f32_dpp v41, v33, v32 row_ror:12 row_mask:0xf bank_mask:0xf
    v_mfma_f32_16x16x32_bf16 v[32:35], v[204:207], v[8:11], 0
    s_nop 0
    v_add_f32_dpp v22, v41, v40 row_ror:8 row_mask:0xf bank_mask:0x4
    v_add_f32_dpp v40, v39, v38 row_ror:12 row_mask:0xf bank_mask:0xf
    v_add_f32_dpp v41, v37, v36 row_ror:12 row_mask:0xf bank_mask:0xf
    v_mfma_f32_16x16x32_bf16 v[36:39], v[208:211], v[8:11], 0
    s_nop 0
    v_add_f32_dpp v23, v41, v40 row_ror:8 row_mask:0xf bank_mask:0x4
    v_add_f32_dpp v40, v28, v31 row_ror:12 row_mask:0xf bank_mask:0xf
    v_add_f32_dpp v41, v30, v29 row_ror:12 row_mask:0xf bank_mask:0xf
    v_mfma_f32_16x16x32_bf16 v[28:31], v[212:215], v[8:11], 0
    s_nop 0
    v_add_f32_dpp v22, v41, v40 row_ror:8 row_mask:0xf bank_mask:0x8
    v_add_f32_dpp v40, v32, v35 row_ror:12 row_mask:0xf bank_mask:0xf
    v_add_f32_dpp v41, v34, v33 row_ror:12 row_mask:0xf bank_mask:0xf
    v_mfma_f32_16x16x32_bf16 v[32:35], v[216:219], v[8:11], 0
    s_nop 0
    v_add_f32_dpp v23, v41, v40 row_ror:8 row_mask:0xf bank_mask:0x8
    v_add_f32_dpp v40, v37, v36 row_ror:12 row_mask:0xf bank_mask:0xf
    v_add_f32_dpp v41, v39, v38 row_ror:12 row_mask:0xf bank_mask:0xf
    v_mfma_f32_16x16x32_bf16 v[36:39], v[220:223], v[8:11], 0
    s_nop 0
    v_add_f32_dpp v24, v41, v40 row_ror:8 row_mask:0xf bank_mask:0x1
    v_add_f32_dpp v40, v29, v28 row_ror:12 row_mask:0xf bank_mask:0xf
    v_add_f32_dpp v41, v31, v30 row_ror:12 row_mask:0xf bank_mask:0xf
    v_mfma_f32_16x16x32_bf16 v[28:31], v[224:227], v[8:11], 0
    s_nop 0
    v_add_f32_dpp v25, v41, v40 row_ror:8 row_mask:0xf bank_mask:0x1
    v_add_f32_dpp v40, v34, v33 row_ror:12 row_mask:0xf bank_mask:0xf
    v_add_f32_dpp v41, v32, v35 row_ror:12 row_mask:0xf bank_mask:0xf
    v_mfma_f32_16x16x32_bf16 v[32:35], v[228:231], v[8:11], 0
    s_nop 0
    v_add_f32_dpp v24, v41, v40 row_ror:8 row_mask:0xf bank_mask:0x2
    v_add_f32_dpp v40, v38, v37 row_ror:12 row_mask:0xf bank_mask:0xf
    v_add_f32_dpp v41, v36, v39 row_ror:12 row_mask:0xf bank_mask:0xf
    v_mfma_f32_16x16x32_bf16 v[36:39], v[232:235], v[8:11], 0
    s_nop 0
    v_add_f32_dpp v25, v41, v40 row_ror:8 row_mask:0xf bank_mask:0x2
    v_add_f32_dpp v40, v31, v30 row_ror:12 row_mask:0xf bank_mask:0xf
    v_add_f32_dpp v41, v29, v28 row_ror:12 row_mask:0xf bank_mask:0xf
    v_mfma_f32_16x16x32_bf16 v[28:31], v[236:239], v[8:11], 0
    s_nop 0
    v_add_f32_dpp v24, v41, v40 row_ror:8 row_mask:0xf bank_mask:0x4
    v_add_f32_dpp v40, v35, v34 row_ror:12 row_mask:0xf bank_mask:0xf
    v_add_f32_dpp v41, v33, v32 row_ror:12 row_mask:0xf bank_mask:0xf
    v_mfma_f32_16x16x32_bf16 v[32:35], v[240:243], v[8:11], 0
    s_nop 0
    v_add_f32_dpp v25, v41, v40 row_ror:8 row_mask:0xf bank_mask:0x4
    v_add_f32_dpp v40, v36, v39 row_ror:12 row_mask:0xf bank_mask:0xf
    v_add_f32_dpp v41, v38, v37 row_ror:12 row_mask:0xf bank_mask:0xf
    v_mfma_f32_16x16x32_bf16 v[36:39], v[244:247], v[8:11], 0
    s_nop 0
    v_add_f32_dpp v24, v41, v40 row_ror:8 row_mask:0xf bank_mask:0x8
    v_add_f32_dpp v40, v28, v31 row_ror:12 row_mask:0xf bank_mask:0xf
    v_add_f32_dpp v41, v30, v29 row_ror:12 row_mask:0xf bank_mask:0xf
    v_mfma_f32_16x16x32_bf16 v[28:31], v[248:251], v[8:11], 0
    s_nop 0
    v_add_f32_dpp v25, v41, v40 row_ror:8 row_mask:0xf bank_mask:0x8
    v_add_f32_dpp v40, v33, v32 row_ror:12 row_mask:0xf bank_mask:0xf
    v_add_f32_dpp v41, v35, v34 row_ror:12 row_mask:0xf bank_mask:0xf
    v_mfma_f32_16x16x32_bf16 v[32:35], v[252:255], v[8:11], 0
    s_nop 0
    v_add_f32_dpp v26, v41, v40 row_ror:8 row_mask:0xf bank_mask:0x1
    v_add_f32_dpp v40, v37, v36 row_ror:12 row_mask:0xf bank_mask:0xf
    v_add_f32_dpp v41, v39, v38 row_ror:12 row_mask:0xf bank_mask:0xf
    v_mfma_f32_16x16x32_bf16 v[36:39], a[148:151], v[8:11], 0
    s_nop 0
    v_add_f32_dpp v27, v41, v40 row_ror:8 row_mask:0xf bank_mask:0x1
    v_add_f32_dpp v40, v30, v29 row_ror:12 row_mask:0xf bank_mask:0xf
    v_add_f32_dpp v41, v28, v31 row_ror:12 row_mask:0xf bank_mask:0xf
    v_mfma_f32_16x16x32_bf16 v[28:31], a[152:155], v[8:11], 0
    s_nop 0
    v_add_f32_dpp v26, v41, v40 row_ror:8 row_mask:0xf bank_mask:0x2
    v_add_f32_dpp v40, v34, v33 row_ror:12 row_mask:0xf bank_mask:0xf
    v_add_f32_dpp v41, v32, v35 row_ror:12 row_mask:0xf bank_mask:0xf
    v_mfma_f32_16x16x32_bf16 v[32:35], a[156:159], v[8:11], 0
    s_nop 0
    v_add_f32_dpp v27, v41, v40 row_ror:8 row_mask:0xf bank_mask:0x2
    v_add_f32_dpp v40, v39, v38 row_ror:12 row_mask:0xf bank_mask:0xf
    v_add_f32_dpp v41, v37, v36 row_ror:12 row_mask:0xf bank_mask:0xf
    v_mfma_f32_16x16x32_bf16 v[36:39], a[160:163], v[8:11], 0
    s_nop 0
    v_add_f32_dpp v26, v41, v40 row_ror:8 row_mask:0xf bank_mask:0x4
    v_add_f32_dpp v40, v31, v30 row_ror:12 row_mask:0xf bank_mask:0xf
    v_add_f32_dpp v41, v29, v28 row_ror:12 row_mask:0xf bank_mask:0xf
    s_nop 1
    v_add_f32_dpp v27, v41, v40 row_ror:8 row_mask:0xf bank_mask:0x4
    v_add_f32_dpp v40, v32, v35 row_ror:12 row_mask:0xf bank_mask:0xf
    v_add_f32_dpp v41, v34, v33 row_ror:12 row_mask:0xf bank_mask:0xf
    s_nop 1
    v_add_f32_dpp v26, v41, v40 row_ror:8 row_mask:0xf bank_mask:0x8
    v_add_f32_dpp v40, v36, v39 row_ror:12 row_mask:0xf bank_mask:0xf
    v_add_f32_dpp v41, v38, v37 row_ror:12 row_mask:0xf bank_mask:0xf
    s_nop 1
    v_add_f32_dpp v27, v41, v40 row_ror:8 row_mask:0xf bank_mask:0x8
    s_add_u32 s72, s65, 3
    s_min_u32 s72, s72, 19
L_flush_13:
    s_cmp_ge_u32 s65, s72
    s_cbranch_scc1 L_flushed_14
    s_swappc_b64 s[90:91], s[88:89]
    s_branch L_flush_13
L_flushed_14:
    v_max_f32 v28, v22, v23
    v_max3_f32 v28, v24, v25, v28
    v_max3_f32 v28, v26, v27, v28
    s_nop 1
    v_max_f32_dpp v28, v28, v28 row_ror:4 row_mask:0xf bank_mask:0xf
    s_nop 1
    v_max_f32_dpp v28, v28, v28 row_ror:8 row_mask:0xf bank_mask:0xf
    v_mov_b32 v29, v28
    s_nop 1
    v_permlane16_swap_b32 v28, v29
    v_max_f32 v28, v28, v29
    v_mov_b32 v29, v28
    s_nop 1
    v_permlane32_swap_b32 v28, v29
    v_max_f32 v28, v28, v29
    v_mul_f32 v5, s76, v28
    v_fma_f32 v22, v22, s76, -v5
    v_fma_f32 v23, v23, s76, -v5
    v_fma_f32 v24, v24, s76, -v5
    v_fma_f32 v25, v25, s76, -v5
    v_fma_f32 v26, v26, s76, -v5
    v_fma_f32 v27, v27, s76, -v5
    v_exp_f32 v22, v22
    v_exp_f32 v23, v23
    v_exp_f32 v24, v24
    v_exp_f32 v25, v25
    v_exp_f32 v26, v26
    v_exp_f32 v27, v27
    v_pk_add_f32 v[32:33], v[22:23], v[24:25]
    v_pk_add_f32 v[32:33], v[32:33], v[26:27]
    v_cvt_pk_bf16_f32 v22, v22, v23
    v_cvt_pk_bf16_f32 v23, v24, v25
    v_cvt_pk_bf16_f32 v24, v26, v27
    v_add_f32 v6, v32, v33
    v_mov_b32 v28, 0
    v_mov_b32 v29, 0
    v_mov_b32 v30, 0
    v_mov_b32 v31, 0
    v_mov_b32 v32, 0
    v_mov_b32 v33, 0
    v_mov_b32 v34, 0
    v_mov_b32 v35, 0
    v_mov_b32 v36, 0
    v_mov_b32 v37, 0
    v_mov_b32 v38, 0
    v_mov_b32 v39, 0
    v_mov_b32 v40, 0
    v_mov_b32 v41, 0
    v_mov_b32 v42, 0
    v_mov_b32 v43, 0
    v_mov_b32_dpp v28, v22 quad_perm:[0,1,2,3] row_mask:0xf bank_mask:0x1
    v_mov_b32_dpp v29, v22 row_shl:4 row_mask:0xf bank_mask:0x1
    v_mov_b32_dpp v30, v22 row_shl:8 row_mask:0xf bank_mask:0x1
    v_mov_b32_dpp v31, v22 row_shl:12 row_mask:0xf bank_mask:0x1
    v_mov_b32_dpp v32, v22 row_shr:4 row_mask:0xf bank_mask:0x2
    v_mov_b32_dpp v33, v22 quad_perm:[0,1,2,3] row_mask:0xf bank_mask:0x2
    v_mov_b32_dpp v34, v22 row_shl:4 row_mask:0xf bank_mask:0x2
    v_mov_b32_dpp v35, v22 row_shl:8 row_mask:0xf bank_mask:0x2
    v_mov_b32_dpp v36, v22 row_shr:8 row_mask:0xf bank_mask:0x4
    v_mov_b32_dpp v37, v22 row_shr:4 row_mask:0xf bank_mask:0x4
    v_mov_b32_dpp v38, v22 quad_perm:[0,1,2,3] row_mask:0xf bank_mask:0x4
    v_mov_b32_dpp v39, v22 row_shl:4 row_mask:0xf bank_mask:0x4
    v_mov_b32_dpp v40, v22 row_shr:12 row_mask:0xf bank_mask:0x8
    v_mov_b32_dpp v41, v22 row_shr:8 row_mask:0xf bank_mask:0x8
    v_mov_b32_dpp v42, v22 row_shr:4 row_mask:0xf bank_mask:0x8
    v_mov_b32_dpp v43, v22 quad_perm:[0,1,2,3] row_mask:0xf bank_mask:0x8
    v_mfma_f32_16x16x32_bf16 v[44:47], v[28:31], a[132:135], 0
    v_mfma_f32_16x16x32_bf16 v[44:47], v[32:35], a[136:139], v[44:47]
    v_mfma_f32_16x16x32_bf16 v[44:47], v[36:39], a[140:143], v[44:47]
    v_mfma_f32_16x16x32_bf16 v[44:47], v[40:43], a[164:167], v[44:47]
    v_mfma_f32_16x16x32_bf16 v[48:51], v[28:31], a[168:171], 0
    v_mfma_f32_16x16x32_bf16 v[48:51], v[32:35], a[172:175], v[48:51]
    v_mfma_f32_16x16x32_bf16 v[48:51], v[36:39], a[176:179], v[48:51]
    v_mfma_f32_16x16x32_bf16 v[48:51], v[40:43], a[180:183], v[48:51]
    v_mov_b32_dpp v28, v23 quad_perm:[0,1,2,3] row_mask:0xf bank_mask:0x1
    v_mov_b32_dpp v29, v23 row_shl:4 row_mask:0xf bank_mask:0x1
    v_mov_b32_dpp v30, v23 row_shl:8 row_mask:0xf bank_mask:0x1
    v_mov_b32_dpp v31, v23 row_shl:12 row_mask:0xf bank_mask:0x1
    v_mov_b32_dpp v32, v23 row_shr:4 row_mask:0xf bank_mask:0x2
    v_mov_b32_dpp v33, v23 quad_perm:[0,1,2,3] row_mask:0xf bank_mask:0x2
    v_mov_b32_dpp v34, v23 row_shl:4 row_mask:0xf bank_mask:0x2
    v_mov_b32_dpp v35, v23 row_shl:8 row_mask:0xf bank_mask:0x2
    v_mov_b32_dpp v36, v23 row_shr:8 row_mask:0xf bank_mask:0x4
    v_mov_b32_dpp v37, v23 row_shr:4 row_mask:0xf bank_mask:0x4
    v_mov_b32_dpp v38, v23 quad_perm:[0,1,2,3] row_mask:0xf bank_mask:0x4
    v_mov_b32_dpp v39, v23 row_shl:4 row_mask:0xf bank_mask:0x4
    v_mov_b32_dpp v40, v23 row_shr:12 row_mask:0xf bank_mask:0x8
    v_mov_b32_dpp v41, v23 row_shr:8 row_mask:0xf bank_mask:0x8
    v_mov_b32_dpp v42, v23 row_shr:4 row_mask:0xf bank_mask:0x8
    v_mov_b32_dpp v43, v23 quad_perm:[0,1,2,3] row_mask:0xf bank_mask:0x8
    v_mfma_f32_16x16x32_bf16 v[44:47], v[28:31], a[184:187], v[44:47]
    v_mfma_f32_16x16x32_bf16 v[44:47], v[32:35], a[188:191], v[44:47]
    v_mfma_f32_16x16x32_bf16 v[44:47], v[36:39], a[108:111], v[44:47]
    v_mfma_f32_16x16x32_bf16 v[44:47], v[40:43], a[112:115], v[44:47]
    v_mfma_f32_16x16x32_bf16 v[48:51], v[28:31], a[116:119], v[48:51]
    v_mfma_f32_16x16x32_bf16 v[48:51], v[32:35], a[120:123], v[48:51]
    v_mfma_f32_16x16x32_bf16 v[48:51], v[36:39], v[96:99], v[48:51]
    v_mfma_f32_16x16x32_bf16 v[48:51], v[40:43], v[100:103], v[48:51]
    v_mov_b32_dpp v28, v24 quad_perm:[0,1,2,3] row_mask:0xf bank_mask:0x1
    v_mov_b32_dpp v29, v24 row_shl:4 row_mask:0xf bank_mask:0x1
    v_mov_b32_dpp v30, v24 row_shl:8 row_mask:0xf bank_mask:0x1
    v_mov_b32_dpp v31, v24 row_shl:12 row_mask:0xf bank_mask:0x1
    v_mov_b32_dpp v32, v24 row_shr:4 row_mask:0xf bank_mask:0x2
    v_mov_b32_dpp v33, v24 quad_perm:[0,1,2,3] row_mask:0xf bank_mask:0x2
    v_mov_b32_dpp v34, v24 row_shl:4 row_mask:0xf bank_mask:0x2
    v_mov_b32_dpp v35, v24 row_shl:8 row_mask:0xf bank_mask:0x2
    v_mov_b32_dpp v36, v24 row_shr:8 row_mask:0xf bank_mask:0x4
    v_mov_b32_dpp v37, v24 row_shr:4 row_mask:0xf bank_mask:0x4
    v_mov_b32_dpp v38, v24 quad_perm:[0,1,2,3] row_mask:0xf bank_mask:0x4
    v_mov_b32_dpp v39, v24 row_shl:4 row_mask:0xf bank_mask:0x4
    v_mov_b32_dpp v40, v24 row_shr:12 row_mask:0xf bank_mask:0x8
    v_mov_b32_dpp v41, v24 row_shr:8 row_mask:0xf bank_mask:0x8
    v_mov_b32_dpp v42, v24 row_shr:4 row_mask:0xf bank_mask:0x8
    v_mov_b32_dpp v43, v24 quad_perm:[0,1,2,3] row_mask:0xf bank_mask:0x8
    v_perm_b32 v52, v136, v132, s74
    v_perm_b32 v53, v144, v140, s74
    v_perm_b32 v54, v152, v148, s74
    v_perm_b32 v55, v160, v156, s74
    v_perm_b32 v56, v136, v132, s75
    v_perm_b32 v57, v144, v140, s75
    v_perm_b32 v58, v152, v148, s75
    v_perm_b32 v59, v160, v156, s75
    v_mfma_f32_16x16x32_bf16 v[44:47], v[28:31], v[52:55], v[44:47]
    v_perm_b32 v52, v137, v133, s74
    v_perm_b32 v53, v145, v141, s74
    v_perm_b32 v54, v153, v149, s74
    v_perm_b32 v55, v161, v157, s74
    v_mfma_f32_16x16x32_bf16 v[44:47], v[32:35], v[56:59], v[44:47]
    v_perm_b32 v56, v137, v133, s75
    v_perm_b32 v57, v145, v141, s75
    v_perm_b32 v58, v153, v149, s75
    v_perm_b32 v59, v161, v157, s75
    v_mfma_f32_16x16x32_bf16 v[44:47], v[36:39], v[52:55], v[44:47]
    v_perm_b32 v52, v138, v134, s74
    v_perm_b32 v53, v146, v142, s74
    v_perm_b32 v54, v154, v150, s74
    v_perm_b32 v55, v162, v158, s74
    v_mfma_f32_16x16x32_bf16 v[44:47], v[40:43], v[56:59], v[44:47]
    v_perm_b32 v56, v138, v134, s75
    v_perm_b32 v57, v146, v142, s75
    v_perm_b32 v58, v154, v150, s75
    v_perm_b32 v59, v162, v158, s75
    v_mfma_f32_16x16x32_bf16 v[48:51], v[28:31], v[52:55], v[48:51]
    v_perm_b32 v52, v139, v135, s74
    v_perm_b32 v53, v147, v143, s74
    v_perm_b32 v54, v155, v151, s74
    v_perm_b32 v55, v163, v159, s74
    v_mfma_f32_16x16x32_bf16 v[48:51], v[32:35], v[56:59], v[48:51]
    v_perm_b32 v56, v139, v135, s75
    v_perm_b32 v57, v147, v143, s75
    v_perm_b32 v58, v155, v151, s75
    v_perm_b32 v59, v163, v159, s75
    v_mfma_f32_16x16x32_bf16 v[48:51], v[36:39], v[52:55], v[48:51]
    s_nop 0
    v_mfma_f32_16x16x32_bf16 v[48:51], v[40:43], v[56:59], v[48:51]
L_flush_15:
    s_cmp_ge_u32 s65, 19
    s_cbranch_scc1 L_flushed_16
    s_nop 4
    s_swappc_b64 s[90:91], s[88:89]
    s_branch L_flush_15
L_flushed_16:
    ds_read_b128 v[52:55], v3 offset:0
    s_waitcnt lgkmcnt(0)
    v_mfma_f32_16x16x32_bf16 v[28:31], v[52:55], v[8:11], 0
    ds_read_b128 v[56:59], v3 offset:1024
    ds_read_b128 v[24:27], v3 offset:2048
    s_waitcnt lgkmcnt(1)
    v_mfma_f32_16x16x32_bf16 v[32:35], v[56:59], v[8:11], 0
    ds_read_b128 v[52:55], v3 offset:3072
    s_waitcnt lgkmcnt(1)
    v_mfma_f32_16x16x32_bf16 v[36:39], v[24:27], v[8:11], 0
    ds_read_b128 v[56:59], v3 offset:4096
    v_add_f32_dpp v40, v29, v28 row_ror:12 row_mask:0xf bank_mask:0xf
    v_add_f32_dpp v41, v31, v30 row_ror:12 row_mask:0xf bank_mask:0xf
    s_waitcnt lgkmcnt(1)
    v_mfma_f32_16x16x32_bf16 v[28:31], v[52:55], v[8:11], 0
    ds_read_b128 v[24:27], v3 offset:5120
    v_add_f32_dpp v12, v41, v40 row_ror:8 row_mask:0xf bank_mask:0x1
    v_add_f32_dpp v40, v33, v32 row_ror:12 row_mask:0xf bank_mask:0xf
    v_add_f32_dpp v41, v35, v34 row_ror:12 row_mask:0xf bank_mask:0xf
    s_waitcnt lgkmcnt(1)
    v_mfma_f32_16x16x32_bf16 v[32:35], v[56:59], v[8:11], 0
    ds_read_b128 v[52:55], v3 offset:6144
    v_add_f32_dpp v13, v41, v40 row_ror:8 row_mask:0xf bank_mask:0x1
    v_add_f32_dpp v40, v38, v37 row_ror:12 row_mask:0xf bank_mask:0xf
    v_add_f32_dpp v41, v36, v39 row_ror:12 row_mask:0xf bank_mask:0xf
    s_waitcnt lgkmcnt(1)
    v_mfma_f32_16x16x32_bf16 v[36:39], v[24:27], v[8:11], 0
    ds_read_b128 v[56:59], v3 offset:7168
    v_add_f32_dpp v12, v41, v40 row_ror:8 row_mask:0xf bank_mask:0x2
    v_add_f32_dpp v40, v30, v29 row_ror:12 row_mask:0xf bank_mask:0xf
    v_add_f32_dpp v41, v28, v31 row_ror:12 row_mask:0xf bank_mask:0xf
    s_waitcnt lgkmcnt(1)
    v_mfma_f32_16x16x32_bf16 v[28:31], v[52:55], v[8:11], 0
    ds_read_b128 v[24:27], v3 offset:8192
    v_add_f32_dpp v13, v41, v40 row_ror:8 row_mask:0xf bank_mask:0x2
    v_add_f32_dpp v40, v35, v34 row_ror:12 row_mask:0xf bank_mask:0xf
    v_add_f32_dpp v41, v33, v32 row_ror:12 row_mask:0xf bank_mask:0xf
    s_waitcnt lgkmcnt(1)
    v_mfma_f32_16x16x32_bf16 v[32:35], v[56:59], v[8:11], 0
    ds_read_b128 v[52:55], v3 offset:9216
    v_add_f32_dpp v12, v41, v40 row_ror:8 row_mask:0xf bank_mask:0x4
    v_add_f32_dpp v40, v39, v38 row_ror:12 row_mask:0xf bank_mask:0xf
    v_add_f32_dpp v41, v37, v36 row_ror:12 row_mask:0xf bank_mask:0xf
    s_waitcnt lgkmcnt(1)
    v_mfma_f32_16x16x32_bf16 v[36:39], v[24:27], v[8:11], 0
    ds_read_b128 v[56:59], v3 offset:10240
    v_add_f32_dpp v13, v41, v40 row_ror:8 row_mask:0xf bank_mask:0x4
    v_add_f32_dpp v40, v28, v31 row_ror:12 row_mask:0xf bank_mask:0xf
    v_add_f32_dpp v41, v30, v29 row_ror:12 row_mask:0xf bank_mask:0xf
    s_waitcnt lgkmcnt(1)
    v_mfma_f32_16x16x32_bf16 v[28:31], v[52:55], v[8:11], 0
    ds_read_b128 v[24:27], v3 offset:11264
    v_add_f32_dpp v12, v41, v40 row_ror:8 row_mask:0xf bank_mask:0x8
    v_add_f32_dpp v40, v32, v35 row_ror:12 row_mask:0xf bank_mask:0xf
    v_add_f32_dpp v41, v34, v33 row_ror:12 row_mask:0xf bank_mask:0xf
    s_waitcnt lgkmcnt(1)
    v_mfma_f32_16x16x32_bf16 v[32:35], v[56:59], v[8:11], 0
    ds_read_b128 v[52:55], v3 offset:12288
    v_add_f32_dpp v13, v41, v40 row_ror:8 row_mask:0xf bank_mask:0x8
    v_add_f32_dpp v40, v37, v36 row_ror:12 row_mask:0xf bank_mask:0xf
    v_add_f32_dpp v41, v39, v38 row_ror:12 row_mask:0xf bank_mask:0xf
    s_waitcnt lgkmcnt(1)
    v_mfma_f32_16x16x32_bf16 v[36:39], v[24:27], v[8:11], 0
    ds_read_b128 v[56:59], v3 offset:13312
    v_add_f32_dpp v14, v41, v40 row_ror:8 row_mask:0xf bank_mask:0x1
    v_add_f32_dpp v40, v29, v28 row_ror:12 row_mask:0xf bank_mask:0xf
    v_add_f32_dpp v41, v31, v30 row_ror:12 row_mask:0xf bank_mask:0xf
    s_waitcnt lgkmcnt(1)
    v_mfma_f32_16x16x32_bf16 v[28:31], v[52:55], v[8:11], 0
    ds_read_b128 v[24:27], v3 offset:14336
    v_add_f32_dpp v15, v41, v40 row_ror:8 row_mask:0xf bank_mask:0x1
    v_add_f32_dpp v40, v34, v33 row_ror:12 row_mask:0xf bank_mask:0xf
    v_add_f32_dpp v41, v32, v35 row_ror:12 row_mask:0xf bank_mask:0xf
    s_waitcnt lgkmcnt(1)
    v_mfma_f32_16x16x32_bf16 v[32:35], v[56:59], v[8:11], 0
    ds_read_b128 v[52:55], v3 offset:15360
    v_add_f32_dpp v14, v41, v40 row_ror:8 row_mask:0xf bank_mask:0x2
    v_add_f32_dpp v40, v38, v37 row_ror:12 row_mask:0xf bank_mask:0xf
    v_add_f32_dpp v41, v36, v39 row_ror:12 row_mask:0xf bank_mask:0xf
    s_waitcnt lgkmcnt(1)
    v_mfma_f32_16x16x32_bf16 v[36:39], v[24:27], v[8:11], 0
    v_add_f32_dpp v15, v41, v40 row_ror:8 row_mask:0xf bank_mask:0x2
    v_add_f32_dpp v40, v31, v30 row_ror:12 row_mask:0xf bank_mask:0xf
    v_add_f32_dpp v41, v29, v28 row_ror:12 row_mask:0xf bank_mask:0xf
    s_waitcnt lgkmcnt(0)
    v_mfma_f32_16x16x32_bf16 v[28:31], v[52:55], v[8:11], 0
    v_add_f32_dpp v14, v41, v40 row_ror:8 row_mask:0xf bank_mask:0x4
    v_add_f32_dpp v40, v35, v34 row_ror:12 row_mask:0xf bank_mask:0xf
    v_add_f32_dpp v41, v33, v32 row_ror:12 row_mask:0xf bank_mask:0xf
    s_waitcnt vmcnt(37)
    ds_read_b128 v[56:59], v3 offset:16384
    s_waitcnt lgkmcnt(0)
    v_mfma_f32_16x16x32_bf16 v[32:35], v[56:59], v[8:11], 0
    v_add_f32_dpp v15, v41, v40 row_ror:8 row_mask:0xf bank_mask:0x4
    v_add_f32_dpp v40, v36, v39 row_ror:12 row_mask:0xf bank_mask:0xf
    v_add_f32_dpp v41, v38, v37 row_ror:12 row_mask:0xf bank_mask:0xf
    s_waitcnt vmcnt(36)
    ds_read_b128 v[24:27], v3 offset:17408
    s_waitcnt lgkmcnt(0)
    v_mfma_f32_16x16x32_bf16 v[36:39], v[24:27], v[8:11], 0
    v_add_f32_dpp v14, v41, v40 row_ror:8 row_mask:0xf bank_mask:0x8
    v_add_f32_dpp v40, v28, v31 row_ror:12 row_mask:0xf bank_mask:0xf
    v_add_f32_dpp v41, v30, v29 row_ror:12 row_mask:0xf bank_mask:0xf
    s_waitcnt vmcnt(35)
    ds_read_b128 v[52:55], v3 offset:18432
    s_waitcnt lgkmcnt(0)
    v_mfma_f32_16x16x32_bf16 v[28:31], v[52:55], v[8:11], 0
    v_add_f32_dpp v15, v41, v40 row_ror:8 row_mask:0xf bank_mask:0x8
    v_add_f32_dpp v40, v33, v32 row_ror:12 row_mask:0xf bank_mask:0xf
    v_add_f32_dpp v41, v35, v34 row_ror:12 row_mask:0xf bank_mask:0xf
    s_waitcnt vmcnt(34)
    ds_read_b128 v[56:59], v3 offset:19456
    s_waitcnt lgkmcnt(0)
    v_mfma_f32_16x16x32_bf16 v[32:35], v[56:59], v[8:11], 0
    v_add_f32_dpp v16, v41, v40 row_ror:8 row_mask:0xf bank_mask:0x1
    v_add_f32_dpp v40, v37, v36 row_ror:12 row_mask:0xf bank_mask:0xf
    v_add_f32_dpp v41, v39, v38 row_ror:12 row_mask:0xf bank_mask:0xf
    s_waitcnt vmcnt(33)
    ds_read_b128 v[24:27], v3 offset:20480
    s_waitcnt lgkmcnt(0)
    v_mfma_f32_16x16x32_bf16 v[36:39], v[24:27], v[8:11], 0
    v_add_f32_dpp v17, v41, v40 row_ror:8 row_mask:0xf bank_mask:0x1
    v_add_f32_dpp v40, v30, v29 row_ror:12 row_mask:0xf bank_mask:0xf
    v_add_f32_dpp v41, v28, v31 row_ror:12 row_mask:0xf bank_mask:0xf
    s_waitcnt vmcnt(32)
    ds_read_b128 v[52:55], v3 offset:21504
    s_waitcnt lgkmcnt(0)
    v_mfma_f32_16x16x32_bf16 v[28:31], v[52:55], v[8:11], 0
    v_add_f32_dpp v16, v41, v40 row_ror:8 row_mask:0xf bank_mask:0x2
    v_add_f32_dpp v40, v34, v33 row_ror:12 row_mask:0xf bank_mask:0xf
    v_add_f32_dpp v41, v32, v35 row_ror:12 row_mask:0xf bank_mask:0xf
    s_waitcnt vmcnt(31)
    ds_read_b128 v[56:59], v3 offset:22528
    s_waitcnt lgkmcnt(0)
    v_mfma_f32_16x16x32_bf16 v[32:35], v[56:59], v[8:11], 0
    v_add_f32_dpp v17, v41, v40 row_ror:8 row_mask:0xf bank_mask:0x2
    v_add_f32_dpp v40, v39, v38 row_ror:12 row_mask:0xf bank_mask:0xf
    v_add_f32_dpp v41, v37, v36 row_ror:12 row_mask:0xf bank_mask:0xf
    s_waitcnt vmcnt(30)
    ds_read_b128 v[24:27], v3 offset:23552
    s_waitcnt lgkmcnt(0)
    v_mfma_f32_16x16x32_bf16 v[36:39], v[24:27], v[8:11], 0
    v_add_f32_dpp v16, v41, v40 row_ror:8 row_mask:0xf bank_mask:0x4
    v_add_f32_dpp v40, v31, v30 row_ror:12 row_mask:0xf bank_mask:0xf
    v_add_f32_dpp v41, v29, v28 row_ror:12 row_mask:0xf bank_mask:0xf
    s_waitcnt vmcnt(29)
    ds_read_b128 v[52:55], v3 offset:24576
    s_waitcnt lgkmcnt(0)
    v_mfma_f32_16x16x32_bf16 v[28:31], v[52:55], v[8:11], 0
    v_add_f32_dpp v17, v41, v40 row_ror:8 row_mask:0xf bank_mask:0x4
    v_add_f32_dpp v40, v32, v35 row_ror:12 row_mask:0xf bank_mask:0xf
    v_add_f32_dpp v41, v34, v33 row_ror:12 row_mask:0xf bank_mask:0xf
    s_waitcnt vmcnt(28)
    ds_read_b128 v[56:59], v3 offset:25600
    s_waitcnt lgkmcnt(0)
    v_mfma_f32_16x16x32_bf16 v[32:35], v[56:59], v[8:11], 0
    v_add_f32_dpp v16, v41, v40 row_ror:8 row_mask:0xf bank_mask:0x8
    v_add_f32_dpp v40, v36, v39 row_ror:12 row_mask:0xf bank_mask:0xf
    v_add_f32_dpp v41, v38, v37 row_ror:12 row_mask:0xf bank_mask:0xf
    s_waitcnt vmcnt(27)
    ds_read_b128 v[24:27], v3 offset:26624
    s_waitcnt lgkmcnt(0)
    v_mfma_f32_16x16x32_bf16 v[36:39], v[24:27], v[8:11], 0
    v_add_f32_dpp v17, v41, v40 row_ror:8 row_mask:0xf bank_mask:0x8
    v_add_f32_dpp v40, v29, v28 row_ror:12 row_mask:0xf bank_mask:0xf
    v_add_f32_dpp v41, v31, v30 row_ror:12 row_mask:0xf bank_mask:0xf
    s_waitcnt vmcnt(26)
    ds_read_b128 v[52:55], v3 offset:27648
    s_waitcnt lgkmcnt(0)
    v_mfma_f32_16x16x32_bf16 v[28:31], v[52:55], v[8:11], 0
    v_add_f32_dpp v18, v41, v40 row_ror:8 row_mask:0xf bank_mask:0x1
    v_add_f32_dpp v40, v33, v32 row_ror:12 row_mask:0xf bank_mask:0xf
    v_add_f32_dpp v41, v35, v34 row_ror:12 row_mask:0xf bank_mask:0xf
    s_waitcnt vmcnt(25)
    ds_read_b128 v[56:59], v3 offset:28672
    s_waitcnt lgkmcnt(0)
    v_mfma_f32_16x16x32_bf16 v[32:35], v[56:59], v[8:11], 0
    v_add_f32_dpp v19, v41, v40 row_ror:8 row_mask:0xf bank_mask:0x1
    v_add_f32_dpp v40, v38, v37 row_ror:12 row_mask:0xf bank_mask:0xf
    v_add_f32_dpp v41, v36, v39 row_ror:12 row_mask:0xf bank_mask:0xf
    s_waitcnt vmcnt(24)
    ds_read_b128 v[24:27], v3 offset:29696
    s_waitcnt lgkmcnt(0)
    v_mfma_f32_16x16x32_bf16 v[36:39], v[24:27], v[8:11], 0
    v_add_f32_dpp v18, v41, v40 row_ror:8 row_mask:0xf bank_mask:0x2
    v_add_f32_dpp v40, v30, v29 row_ror:12 row_mask:0xf bank_mask:0xf
    v_add_f32_dpp v41, v28, v31 row_ror:12 row_mask:0xf bank_mask:0xf
    s_waitcnt vmcnt(23)
    ds_read_b128 v[52:55], v3 offset:30720
    s_waitcnt lgkmcnt(0)
    v_mfma_f32_16x16x32_bf16 v[28:31], v[52:55], v[8:11], 0
    s_mov_b32 s48, 65536
    buffer_load_dwordx4 v[164:167], v2, s[20:23], s48 offen offset:1024 nt
    v_add_f32_dpp v19, v41, v40 row_ror:8 row_mask:0xf bank_mask:0x2
    v_add_f32_dpp v40, v35, v34 row_ror:12 row_mask:0xf bank_mask:0xf
    v_add_f32_dpp v41, v33, v32 row_ror:12 row_mask:0xf bank_mask:0xf
    s_waitcnt vmcnt(23)
    ds_read_b128 v[56:59], v3 offset:31744
    s_waitcnt lgkmcnt(0)
    v_mfma_f32_16x16x32_bf16 v[32:35], v[56:59], v[8:11], 0
    buffer_load_dwordx4 v[168:171], v2, s[20:23], s48 offen offset:2048 nt
    v_add_f32_dpp v18, v41, v40 row_ror:8 row_mask:0xf bank_mask:0x4
    v_add_f32_dpp v40, v39, v38 row_ror:12 row_mask:0xf bank_mask:0xf
    v_add_f32_dpp v41, v37, v36 row_ror:12 row_mask:0xf bank_mask:0xf
    s_waitcnt vmcnt(23)
    ds_read_b128 v[24:27], v3 offset:32768
    s_waitcnt lgkmcnt(0)
    v_mfma_f32_16x16x32_bf16 v[36:39], v[24:27], v[8:11], 0
    buffer_load_dwordx4 v[172:175], v2, s[20:23], s48 offen offset:3072 nt
    v_add_f32_dpp v19, v41, v40 row_ror:8 row_mask:0xf bank_mask:0x4
    v_add_f32_dpp v40, v28, v31 row_ror:12 row_mask:0xf bank_mask:0xf
    v_add_f32_dpp v41, v30, v29 row_ror:12 row_mask:0xf bank_mask:0xf
    s_waitcnt vmcnt(23)
    ds_read_b128 v[52:55], v3 offset:33792
    s_waitcnt lgkmcnt(0)
    v_mfma_f32_16x16x32_bf16 v[28:31], v[52:55], v[8:11], 0
    s_mov_b32 s48, 81920
    buffer_load_dwordx4 v[176:179], v2, s[20:23], s48 offen offset:0 nt
    v_add_f32_dpp v18, v41, v40 row_ror:8 row_mask:0xf bank_mask:0x8
    v_add_f32_dpp v40, v32, v35 row_ror:12 row_mask:0xf bank_mask:0xf
    v_add_f32_dpp v41, v34, v33 row_ror:12 row_mask:0xf bank_mask:0xf
    s_waitcnt vmcnt(23)
    ds_read_b128 v[56:59], v3 offset:34816
    s_waitcnt lgkmcnt(0)
    v_mfma_f32_16x16x32_bf16 v[32:35], v[56:59], v[8:11], 0
    buffer_load_dwordx4 v[180:183], v2, s[20:23], s48 offen offset:1024 nt
    v_add_f32_dpp v19, v41, v40 row_ror:8 row_mask:0xf bank_mask:0x8
    v_add_f32_dpp v40, v37, v36 row_ror:12 row_mask:0xf bank_mask:0xf
    v_add_f32_dpp v41, v39, v38 row_ror:12 row_mask:0xf bank_mask:0xf
    s_waitcnt vmcnt(23)
    ds_read_b128 v[24:27], v3 offset:35840
    s_waitcnt lgkmcnt(0)
    v_mfma_f32_16x16x32_bf16 v[36:39], v[24:27], v[8:11], 0
    buffer_load_dwordx4 v[184:187], v2, s[20:23], s48 offen offset:2048 nt
    v_add_f32_dpp v20, v41, v40 row_ror:8 row_mask:0xf bank_mask:0x1
    v_add_f32_dpp v40, v29, v28 row_ror:12 row_mask:0xf bank_mask:0xf
    v_add_f32_dpp v41, v31, v30 row_ror:12 row_mask:0xf bank_mask:0xf
    s_waitcnt vmcnt(23)
    ds_read_b128 v[52:55], v3 offset:36864
    s_waitcnt lgkmcnt(0)
    v_mfma_f32_16x16x32_bf16 v[28:31], v[52:55], v[8:11], 0
    buffer_load_dwordx4 v[188:191], v2, s[20:23], s48 offen offset:3072 nt
    v_add_f32_dpp v21, v41, v40 row_ror:8 row_mask:0xf bank_mask:0x1
    v_add_f32_dpp v40, v34, v33 row_ror:12 row_mask:0xf bank_mask:0xf
    v_add_f32_dpp v41, v32, v35 row_ror:12 row_mask:0xf bank_mask:0xf
    s_nop 1
    v_add_f32_dpp v20, v41, v40 row_ror:8 row_mask:0xf bank_mask:0x2
    v_add_f32_dpp v40, v38, v37 row_ror:12 row_mask:0xf bank_mask:0xf
    v_add_f32_dpp v41, v36, v39 row_ror:12 row_mask:0xf bank_mask:0xf
    s_nop 1
    v_add_f32_dpp v21, v41, v40 row_ror:8 row_mask:0xf bank_mask:0x2
    v_add_f32_dpp v40, v31, v30 row_ror:12 row_mask:0xf bank_mask:0xf
    v_add_f32_dpp v41, v29, v28 row_ror:12 row_mask:0xf bank_mask:0xf
    s_nop 1
    v_add_f32_dpp v20, v41, v40 row_ror:8 row_mask:0xf bank_mask:0x4
    s_mov_b32 s61, 1146880
    s_waitcnt lgkmcnt(0)
    v_max_f32 v28, v12, v13
    v_max3_f32 v28, v14, v15, v28
    v_max3_f32 v28, v16, v17, v28
    v_max3_f32 v28, v18, v19, v28
    v_max3_f32 v28, v20, v21, v28
    s_nop 1
    v_max_f32_dpp v28, v28, v28 row_ror:4 row_mask:0xf bank_mask:0xf
    s_nop 1
    v_max_f32_dpp v28, v28, v28 row_ror:8 row_mask:0xf bank_mask:0xf
    v_mov_b32 v29, v28
    s_nop 1
    v_permlane16_swap_b32 v28, v29
    v_max_f32 v28, v28, v29
    v_mov_b32 v29, v28
    s_nop 1
    v_permlane32_swap_b32 v28, v29
    v_max_f32 v28, v28, v29
    v_mul_f32 v28, s76, v28
    v_max_f32 v28, v28, v5
    v_sub_f32 v30, v5, v28
    v_exp_f32 v30, v30
    v_mov_b32 v5, v28
    v_fma_f32 v12, v12, s76, -v5
    v_fma_f32 v13, v13, s76, -v5
    v_fma_f32 v14, v14, s76, -v5
    v_fma_f32 v15, v15, s76, -v5
    v_fma_f32 v16, v16, s76, -v5
    v_fma_f32 v17, v17, s76, -v5
    v_fma_f32 v18, v18, s76, -v5
    v_fma_f32 v19, v19, s76, -v5
    v_fma_f32 v20, v20, s76, -v5
    v_fma_f32 v21, v21, s76, -v5
    v_readlane_b32 s28, v30, 0
    v_readlane_b32 s29, v30, 1
    v_readlane_b32 s30, v30, 2
    v_readlane_b32 s31, v30, 3
    v_exp_f32 v12, v12
    v_exp_f32 v13, v13
    v_exp_f32 v14, v14
    v_exp_f32 v15, v15
    v_exp_f32 v16, v16
    v_exp_f32 v17, v17
    v_exp_f32 v18, v18
    v_exp_f32 v19, v19
    v_exp_f32 v20, v20
    v_exp_f32 v21, v21
    v_mul_f32 v6, v6, v30
    v_mul_f32 v44, s28, v44
    v_mul_f32 v45, s29, v45
    v_mul_f32 v46, s30, v46
    v_mul_f32 v47, s31, v47
    v_mul_f32 v48, s28, v48
    v_mul_f32 v49, s29, v49
    v_mul_f32 v50, s30, v50
    v_mul_f32 v51, s31, v51
    v_pk_add_f32 v[32:33], v[12:13], v[14:15]
    v_pk_add_f32 v[34:35], v[16:17], v[18:19]
    v_pk_add_f32 v[32:33], v[32:33], v[20:21]
    v_cvt_pk_bf16_f32 v12, v12, v13
    v_cvt_pk_bf16_f32 v13, v14, v15
    v_cvt_pk_bf16_f32 v14, v16, v17
    v_cvt_pk_bf16_f32 v15, v18, v19
    v_cvt_pk_bf16_f32 v16, v20, v21
    v_pk_add_f32 v[32:33], v[32:33], v[34:35]
    v_add_f32 v6, v6, v32
    v_add_f32 v6, v6, v33
    v_and_b32 v30, 3, v0
    v_lshlrev_b32 v30, 4, v30
    s_lshl_b32 s68, s3, 2
    v_add_u32 v30, s68, v30
    ds_write_b32 v30, v5 offset:10368
    v_add_f32_dpp v6, v6, v6 row_ror:4 row_mask:0xf bank_mask:0xf
    s_nop 1
    v_add_f32_dpp v6, v6, v6 row_ror:8 row_mask:0xf bank_mask:0xf
    v_mov_b32 v29, v6
    s_nop 1
    v_permlane16_swap_b32 v6, v29
    v_add_f32 v6, v6, v29
    v_mov_b32 v29, v6
    s_nop 1
    v_permlane32_swap_b32 v6, v29
    v_add_f32 v6, v6, v29
    ds_write_b32 v30, v6 offset:10432
    v_mov_b32 v28, 0
    v_mov_b32 v29, 0
    v_mov_b32 v30, 0
    v_mov_b32 v31, 0
    v_mov_b32 v32, 0
    v_mov_b32 v33, 0
    v_mov_b32 v34, 0
    v_mov_b32 v35, 0
    v_mov_b32 v36, 0
    v_mov_b32 v37, 0
    v_mov_b32 v38, 0
    v_mov_b32 v39, 0
    v_mov_b32 v40, 0
    v_mov_b32 v41, 0
    v_mov_b32 v42, 0
    v_mov_b32 v43, 0
    v_mov_b32_dpp v28, v12 quad_perm:[0,1,2,3] row_mask:0xf bank_mask:0x1
    v_mov_b32_dpp v29, v12 row_shl:4 row_mask:0xf bank_mask:0x1
    v_mov_b32_dpp v30, v12 row_shl:8 row_mask:0xf bank_mask:0x1
    v_mov_b32_dpp v31, v12 row_shl:12 row_mask:0xf bank_mask:0x1
    v_mov_b32_dpp v32, v12 row_shr:4 row_mask:0xf bank_mask:0x2
    v_mov_b32_dpp v33, v12 quad_perm:[0,1,2,3] row_mask:0xf bank_mask:0x2
    v_mov_b32_dpp v34, v12 row_shl:4 row_mask:0xf bank_mask:0x2
    v_mov_b32_dpp v35, v12 row_shl:8 row_mask:0xf bank_mask:0x2
    v_mov_b32_dpp v36, v12 row_shr:8 row_mask:0xf bank_mask:0x4
    v_mov_b32_dpp v37, v12 row_shr:4 row_mask:0xf bank_mask:0x4
    v_mov_b32_dpp v38, v12 quad_perm:[0,1,2,3] row_mask:0xf bank_mask:0x4
    v_mov_b32_dpp v39, v12 row_shl:4 row_mask:0xf bank_mask:0x4
    v_mov_b32_dpp v40, v12 row_shr:12 row_mask:0xf bank_mask:0x8
    v_mov_b32_dpp v41, v12 row_shr:8 row_mask:0xf bank_mask:0x8
    v_mov_b32_dpp v42, v12 row_shr:4 row_mask:0xf bank_mask:0x8
    v_mov_b32_dpp v43, v12 quad_perm:[0,1,2,3] row_mask:0xf bank_mask:0x8
    s_waitcnt vmcnt(23)
    s_mov_b32 s48, 98304
    buffer_load_dwordx4 v[192:195], v2, s[20:23], s48 offen offset:0 nt
    s_waitcnt vmcnt(23)
    buffer_load_dwordx4 v[196:199], v2, s[20:23], s48 offen offset:1024 nt
    s_waitcnt vmcnt(23)
    buffer_load_dwordx4 v[200:203], v2, s[20:23], s48 offen offset:2048 nt
    s_waitcnt vmcnt(23)
    buffer_load_dwordx4 v[204:207], v2, s[20:23], s48 offen offset:3072 nt
    s_waitcnt vmcnt(23)
    s_mov_b32 s48, 114688
    buffer_load_dwordx4 v[208:211], v2, s[20:23], s48 offen offset:0 nt
    s_waitcnt vmcnt(23)
    buffer_load_dwordx4 v[212:215], v2, s[20:23], s48 offen offset:1024 nt
    s_waitcnt vmcnt(23)
    buffer_load_dwordx4 v[216:219], v2, s[20:23], s48 offen offset:2048 nt
    s_waitcnt vmcnt(23)
    buffer_load_dwordx4 v[220:223], v2, s[20:23], s48 offen offset:3072 nt
    v_perm_b32 v20, v72, v68, s74
    v_perm_b32 v21, v80, v76, s74
    v_perm_b32 v22, v88, v84, s74
    v_perm_b32 v23, v104, v92, s74
    v_perm_b32 v24, v72, v68, s75
    v_perm_b32 v25, v80, v76, s75
    v_perm_b32 v26, v88, v84, s75
    v_perm_b32 v27, v104, v92, s75
    v_mfma_f32_16x16x32_bf16 v[44:47], v[28:31], v[20:23], v[44:47]
    v_perm_b32 v20, v73, v69, s74
    v_perm_b32 v21, v81, v77, s74
    v_perm_b32 v22, v89, v85, s74
    v_perm_b32 v23, v105, v93, s74
    v_mfma_f32_16x16x32_bf16 v[44:47], v[32:35], v[24:27], v[44:47]
    v_perm_b32 v24, v73, v69, s75
    v_perm_b32 v25, v81, v77, s75
    v_perm_b32 v26, v89, v85, s75
    v_perm_b32 v27, v105, v93, s75
    v_mfma_f32_16x16x32_bf16 v[44:47], v[36:39], v[20:23], v[44:47]
    v_perm_b32 v20, v74, v70, s74
    v_perm_b32 v21, v82, v78, s74
    v_perm_b32 v22, v90, v86, s74
    v_perm_b32 v23, v106, v94, s74
    v_mfma_f32_16x16x32_bf16 v[44:47], v[40:43], v[24:27], v[44:47]
    v_perm_b32 v24, v74, v70, s75
    v_perm_b32 v25, v82, v78, s75
    v_perm_b32 v26, v90, v86, s75
    v_perm_b32 v27, v106, v94, s75
    v_mfma_f32_16x16x32_bf16 v[48:51], v[28:31], v[20:23], v[48:51]
    v_perm_b32 v20, v75, v71, s74
    v_perm_b32 v21, v83, v79, s74
    v_perm_b32 v22, v91, v87, s74
    v_perm_b32 v23, v107, v95, s74
    v_mfma_f32_16x16x32_bf16 v[48:51], v[32:35], v[24:27], v[48:51]
    v_perm_b32 v24, v75, v71, s75
    v_perm_b32 v25, v83, v79, s75
    v_perm_b32 v26, v91, v87, s75
    v_perm_b32 v27, v107, v95, s75
    v_mfma_f32_16x16x32_bf16 v[48:51], v[36:39], v[20:23], v[48:51]
    s_nop 0
    v_mfma_f32_16x16x32_bf16 v[48:51], v[40:43], v[24:27], v[48:51]
    s_nop 6
    s_call_b64 s[86:87], S_sm2
    v_mov_b32_dpp v28, v13 quad_perm:[0,1,2,3] row_mask:0xf bank_mask:0x1
    v_mov_b32_dpp v29, v13 row_shl:4 row_mask:0xf bank_mask:0x1
    v_mov_b32_dpp v30, v13 row_shl:8 row_mask:0xf bank_mask:0x1
    v_mov_b32_dpp v31, v13 row_shl:12 row_mask:0xf bank_mask:0x1
    v_mov_b32_dpp v32, v13 row_shr:4 row_mask:0xf bank_mask:0x2
    v_mov_b32_dpp v33, v13 quad_perm:[0,1,2,3] row_mask:0xf bank_mask:0x2
    v_mov_b32_dpp v34, v13 row_shl:4 row_mask:0xf bank_mask:0x2
    v_mov_b32_dpp v35, v13 row_shl:8 row_mask:0xf bank_mask:0x2
    v_mov_b32_dpp v36, v13 row_shr:8 row_mask:0xf bank_mask:0x4
    v_mov_b32_dpp v37, v13 row_shr:4 row_mask:0xf bank_mask:0x4
    v_mov_b32_dpp v38, v13 quad_perm:[0,1,2,3] row_mask:0xf bank_mask:0x4
    v_mov_b32_dpp v39, v13 row_shl:4 row_mask:0xf bank_mask:0x4
    v_mov_b32_dpp v40, v13 row_shr:12 row_mask:0xf bank_mask:0x8
    v_mov_b32_dpp v41, v13 row_shr:8 row_mask:0xf bank_mask:0x8
    v_mov_b32_dpp v42, v13 row_shr:4 row_mask:0xf bank_mask:0x8
    v_mov_b32_dpp v43, v13 quad_perm:[0,1,2,3] row_mask:0xf bank_mask:0x8
    s_waitcnt vmcnt(23)
    s_mov_b32 s48, 131072
    buffer_load_dwordx4 v[224:227], v2, s[20:23], s48 offen offset:0 nt
    s_waitcnt vmcnt(23)
    buffer_load_dwordx4 v[228:231], v2, s[20:23], s48 offen offset:1024 nt
    s_waitcnt vmcnt(23)
    buffer_load_dwordx4 v[232:235], v2, s[20:23], s48 offen offset:2048 nt
    s_waitcnt vmcnt(23)
    buffer_load_dwordx4 v[236:239], v2, s[20:23], s48 offen offset:3072 nt
    s_waitcnt vmcnt(23)
    s_mov_b32 s48, 147456
    buffer_load_dwordx4 v[240:243], v2, s[20:23], s48 offen offset:0 nt
    s_waitcnt vmcnt(23)
    buffer_load_dwordx4 v[244:247], v2, s[20:23], s48 offen offset:1024 nt
    s_waitcnt vmcnt(23)
    buffer_load_dwordx4 v[248:251], v2, s[20:23], s48 offen offset:2048 nt
    s_waitcnt vmcnt(23)
    buffer_load_dwordx4 v[252:255], v2, s[20:23], s48 offen offset:3072 nt
    v_accvgpr_read_b32 v58, a12
    v_accvgpr_read_b32 v59, a16
    v_perm_b32 v20, v112, v108, s74
    v_perm_b32 v21, v120, v116, s74
    v_perm_b32 v22, v128, v124, s74
    v_perm_b32 v23, v59, v58, s74
    v_perm_b32 v24, v112, v108, s75
    v_perm_b32 v25, v120, v116, s75
    v_perm_b32 v26, v128, v124, s75
    v_perm_b32 v27, v59, v58, s75
    v_mfma_f32_16x16x32_bf16 v[44:47], v[28:31], v[20:23], v[44:47]
    v_accvgpr_read_b32 v58, a13
    v_accvgpr_read_b32 v59, a17
    v_perm_b32 v20, v113, v109, s74
    v_perm_b32 v21, v121, v117, s74
    v_perm_b32 v22, v129, v125, s74
    v_perm_b32 v23, v59, v58, s74
    v_mfma_f32_16x16x32_bf16 v[44:47], v[32:35], v[24:27], v[44:47]
    v_perm_b32 v24, v113, v109, s75
    v_perm_b32 v25, v121, v117, s75
    v_perm_b32 v26, v129, v125, s75
    v_perm_b32 v27, v59, v58, s75
    v_mfma_f32_16x16x32_bf16 v[44:47], v[36:39], v[20:23], v[44:47]
    v_accvgpr_read_b32 v58, a14
    v_accvgpr_read_b32 v59, a18
    v_perm_b32 v20, v114, v110, s74
    v_perm_b32 v21, v122, v118, s74
    v_perm_b32 v22, v130, v126, s74
    v_perm_b32 v23, v59, v58, s74
    v_mfma_f32_16x16x32_bf16 v[44:47], v[40:43], v[24:27], v[44:47]
    v_perm_b32 v24, v114, v110, s75
    v_perm_b32 v25, v122, v118, s75
    v_perm_b32 v26, v130, v126, s75
    v_perm_b32 v27, v59, v58, s75
    v_mfma_f32_16x16x32_bf16 v[48:51], v[28:31], v[20:23], v[48:51]
    v_accvgpr_read_b32 v58, a15
    v_accvgpr_read_b32 v59, a19
    v_perm_b32 v20, v115, v111, s74
    v_perm_b32 v21, v123, v119, s74
    v_perm_b32 v22, v131, v127, s74
    v_perm_b32 v23, v59, v58, s74
    v_mfma_f32_16x16x32_bf16 v[48:51], v[32:35], v[24:27], v[48:51]
    v_perm_b32 v24, v115, v111, s75
    v_perm_b32 v25, v123, v119, s75
    v_perm_b32 v26, v131, v127, s75
    v_perm_b32 v27, v59, v58, s75
    v_mfma_f32_16x16x32_bf16 v[48:51], v[36:39], v[20:23], v[48:51]
    s_nop 0
    v_mfma_f32_16x16x32_bf16 v[48:51], v[40:43], v[24:27], v[48:51]
    v_mov_b32_dpp v28, v14 quad_perm:[0,1,2,3] row_mask:0xf bank_mask:0x1
    v_mov_b32_dpp v29, v14 row_shl:4 row_mask:0xf bank_mask:0x1
    v_mov_b32_dpp v30, v14 row_shl:8 row_mask:0xf bank_mask:0x1
    v_mov_b32_dpp v31, v14 row_shl:12 row_mask:0xf bank_mask:0x1
    v_mov_b32_dpp v32, v14 row_shr:4 row_mask:0xf bank_mask:0x2
    v_mov_b32_dpp v33, v14 quad_perm:[0,1,2,3] row_mask:0xf bank_mask:0x2
    v_mov_b32_dpp v34, v14 row_shl:4 row_mask:0xf bank_mask:0x2
    v_mov_b32_dpp v35, v14 row_shl:8 row_mask:0xf bank_mask:0x2
    v_mov_b32_dpp v36, v14 row_shr:8 row_mask:0xf bank_mask:0x4
    v_mov_b32_dpp v37, v14 row_shr:4 row_mask:0xf bank_mask:0x4
    v_mov_b32_dpp v38, v14 quad_perm:[0,1,2,3] row_mask:0xf bank_mask:0x4
    v_mov_b32_dpp v39, v14 row_shl:4 row_mask:0xf bank_mask:0x4
    v_mov_b32_dpp v40, v14 row_shr:12 row_mask:0xf bank_mask:0x8
    v_mov_b32_dpp v41, v14 row_shr:8 row_mask:0xf bank_mask:0x8
    v_mov_b32_dpp v42, v14 row_shr:4 row_mask:0xf bank_mask:0x8
    v_mov_b32_dpp v43, v14 quad_perm:[0,1,2,3] row_mask:0xf bank_mask:0x8
    s_waitcnt vmcnt(23)
    s_waitcnt vmcnt(22)
    s_waitcnt vmcnt(21)
    s_waitcnt vmcnt(20)
    s_waitcnt vmcnt(19)
    s_waitcnt vmcnt(18)
    s_waitcnt vmcnt(17)
    s_waitcnt vmcnt(16)
    v_accvgpr_read_b32 v52, a20
    v_perm_b32 v20, v164, v52, s74
    v_perm_b32 v21, v172, v168, s74
    v_perm_b32 v22, v180, v176, s74
    v_perm_b32 v23, v188, v184, s74
    v_perm_b32 v24, v164, v52, s75
    v_perm_b32 v25, v172, v168, s75
    v_perm_b32 v26, v180, v176, s75
    v_perm_b32 v27, v188, v184, s75
    v_mfma_f32_16x16x32_bf16 v[44:47], v[28:31], v[20:23], v[44:47]
    v_accvgpr_read_b32 v52, a21
    v_perm_b32 v20, v165, v52, s74
    v_perm_b32 v21, v173, v169, s74
    v_perm_b32 v22, v181, v177, s74
    v_perm_b32 v23, v189, v185, s74
    v_mfma_f32_16x16x32_bf16 v[44:47], v[32:35], v[24:27], v[44:47]
    v_perm_b32 v24, v165, v52, s75
    v_perm_b32 v25, v173, v169, s75
    v_perm_b32 v26, v181, v177, s75
    v_perm_b32 v27, v189, v185, s75
    v_mfma_f32_16x16x32_bf16 v[44:47], v[36:39], v[20:23], v[44:47]
    v_accvgpr_read_b32 v52, a22
    v_perm_b32 v20, v166, v52, s74
    v_perm_b32 v21, v174, v170, s74
    v_perm_b32 v22, v182, v178, s74
    v_perm_b32 v23, v190, v186, s74
    v_mfma_f32_16x16x32_bf16 v[44:47], v[40:43], v[24:27], v[44:47]
    v_perm_b32 v24, v166, v52, s75
    v_perm_b32 v25, v174, v170, s75
    v_perm_b32 v26, v182, v178, s75
    v_perm_b32 v27, v190, v186, s75
    v_mfma_f32_16x16x32_bf16 v[48:51], v[28:31], v[20:23], v[48:51]
    v_accvgpr_read_b32 v52, a23
    v_perm_b32 v20, v167, v52, s74
    v_perm_b32 v21, v175, v171, s74
    v_perm_b32 v22, v183, v179, s74
    v_perm_b32 v23, v191, v187, s74
    v_mfma_f32_16x16x32_bf16 v[48:51], v[32:35], v[24:27], v[48:51]
    v_perm_b32 v24, v167, v52, s75
    v_perm_b32 v25, v175, v171, s75
    v_perm_b32 v26, v183, v179, s75
    v_perm_b32 v27, v191, v187, s75
    v_mfma_f32_16x16x32_bf16 v[48:51], v[36:39], v[20:23], v[48:51]
    s_nop 0
    v_mfma_f32_16x16x32_bf16 v[48:51], v[40:43], v[24:27], v[48:51]
    v_mov_b32_dpp v28, v15 quad_perm:[0,1,2,3] row_mask:0xf bank_mask:0x1
    v_mov_b32_dpp v29, v15 row_shl:4 row_mask:0xf bank_mask:0x1
    v_mov_b32_dpp v30, v15 row_shl:8 row_mask:0xf bank_mask:0x1
    v_mov_b32_dpp v31, v15 row_shl:12 row_mask:0xf bank_mask:0x1
    v_mov_b32_dpp v32, v15 row_shr:4 row_mask:0xf bank_mask:0x2
    v_mov_b32_dpp v33, v15 quad_perm:[0,1,2,3] row_mask:0xf bank_mask:0x2
    v_mov_b32_dpp v34, v15 row_shl:4 row_mask:0xf bank_mask:0x2
    v_mov_b32_dpp v35, v15 row_shl:8 row_mask:0xf bank_mask:0x2
    v_mov_b32_dpp v36, v15 row_shr:8 row_mask:0xf bank_mask:0x4
    v_mov_b32_dpp v37, v15 row_shr:4 row_mask:0xf bank_mask:0x4
    v_mov_b32_dpp v38, v15 quad_perm:[0,1,2,3] row_mask:0xf bank_mask:0x4
    v_mov_b32_dpp v39, v15 row_shl:4 row_mask:0xf bank_mask:0x4
    v_mov_b32_dpp v40, v15 row_shr:12 row_mask:0xf bank_mask:0x8
    v_mov_b32_dpp v41, v15 row_shr:8 row_mask:0xf bank_mask:0x8
    v_mov_b32_dpp v42, v15 row_shr:4 row_mask:0xf bank_mask:0x8
    v_mov_b32_dpp v43, v15 quad_perm:[0,1,2,3] row_mask:0xf bank_mask:0x8
    s_waitcnt vmcnt(15)
    s_waitcnt vmcnt(14)
    s_waitcnt vmcnt(13)
    s_waitcnt vmcnt(12)
    s_waitcnt vmcnt(11)
    s_waitcnt vmcnt(10)
    s_waitcnt vmcnt(9)
    s_waitcnt vmcnt(8)
    v_perm_b32 v20, v196, v192, s74
    v_perm_b32 v21, v204, v200, s74
    v_perm_b32 v22, v212, v208, s74
    v_perm_b32 v23, v220, v216, s74
    v_perm_b32 v24, v196, v192, s75
    v_perm_b32 v25, v204, v200, s75
    v_perm_b32 v26, v212, v208, s75
    v_perm_b32 v27, v220, v216, s75
    v_mfma_f32_16x16x32_bf16 v[44:47], v[28:31], v[20:23], v[44:47]
    v_perm_b32 v20, v197, v193, s74
    v_perm_b32 v21, v205, v201, s74
    v_perm_b32 v22, v213, v209, s74
    v_perm_b32 v23, v221, v217, s74
    v_mfma_f32_16x16x32_bf16 v[44:47], v[32:35], v[24:27], v[44:47]
    v_perm_b32 v24, v197, v193, s75
    v_perm_b32 v25, v205, v201, s75
    v_perm_b32 v26, v213, v209, s75
    v_perm_b32 v27, v221, v217, s75
    v_mfma_f32_16x16x32_bf16 v[44:47], v[36:39], v[20:23], v[44:47]
    v_perm_b32 v20, v198, v194, s74
    v_perm_b32 v21, v206, v202, s74
    v_perm_b32 v22, v214, v210, s74
    v_perm_b32 v23, v222, v218, s74
    v_mfma_f32_16x16x32_bf16 v[44:47], v[40:43], v[24:27], v[44:47]
    v_perm_b32 v24, v198, v194, s75
    v_perm_b32 v25, v206, v202, s75
    v_perm_b32 v26, v214, v210, s75
    v_perm_b32 v27, v222, v218, s75
    v_mfma_f32_16x16x32_bf16 v[48:51], v[28:31], v[20:23], v[48:51]
    v_perm_b32 v20, v199, v195, s74
    v_perm_b32 v21, v207, v203, s74
    v_perm_b32 v22, v215, v211, s74
    v_perm_b32 v23, v223, v219, s74
    v_mfma_f32_16x16x32_bf16 v[48:51], v[32:35], v[24:27], v[48:51]
    v_perm_b32 v24, v199, v195, s75
    v_perm_b32 v25, v207, v203, s75
    v_perm_b32 v26, v215, v211, s75
    v_perm_b32 v27, v223, v219, s75
    v_mfma_f32_16x16x32_bf16 v[48:51], v[36:39], v[20:23], v[48:51]
    s_nop 0
    v_mfma_f32_16x16x32_bf16 v[48:51], v[40:43], v[24:27], v[48:51]
    v_mov_b32_dpp v28, v16 quad_perm:[0,1,2,3] row_mask:0xf bank_mask:0x1
    v_mov_b32_dpp v29, v16 row_shl:4 row_mask:0xf bank_mask:0x1
    v_mov_b32_dpp v30, v16 row_shl:8 row_mask:0xf bank_mask:0x1
    v_mov_b32_dpp v31, v16 row_shl:12 row_mask:0xf bank_mask:0x1
    v_mov_b32_dpp v32, v16 row_shr:4 row_mask:0xf bank_mask:0x2
    v_mov_b32_dpp v33, v16 quad_perm:[0,1,2,3] row_mask:0xf bank_mask:0x2
    v_mov_b32_dpp v34, v16 row_shl:4 row_mask:0xf bank_mask:0x2
    v_mov_b32_dpp v35, v16 row_shl:8 row_mask:0xf bank_mask:0x2
    v_mov_b32_dpp v36, v16 row_shr:8 row_mask:0xf bank_mask:0x4
    v_mov_b32_dpp v37, v16 row_shr:4 row_mask:0xf bank_mask:0x4
    v_mov_b32_dpp v38, v16 quad_perm:[0,1,2,3] row_mask:0xf bank_mask:0x4
    v_mov_b32_dpp v39, v16 row_shl:4 row_mask:0xf bank_mask:0x4
    v_mov_b32_dpp v40, v16 row_shr:12 row_mask:0xf bank_mask:0x8
    v_mov_b32_dpp v41, v16 row_shr:8 row_mask:0xf bank_mask:0x8
    v_mov_b32_dpp v42, v16 row_shr:4 row_mask:0xf bank_mask:0x8
    v_mov_b32_dpp v43, v16 quad_perm:[0,1,2,3] row_mask:0xf bank_mask:0x8
    s_waitcnt vmcnt(7)
    s_waitcnt vmcnt(6)
    s_waitcnt vmcnt(5)
    s_waitcnt vmcnt(4)
    s_waitcnt vmcnt(3)
    s_waitcnt vmcnt(2)
    s_waitcnt vmcnt(1)
    s_waitcnt vmcnt(0)
    s_mov_b32 s60, 786432
    s_mov_b32 s62, 1310720
    s_mov_b32 s63, 2
    s_mov_b32 s82, 1
    s_mov_b32 s78, 1
    s_mov_b32 s83, 2
    s_xor_b32 s68, s4, s6
    s_or_b32 s68, s68, s7
    s_cmp_eq_u32 s68, 0
    s_cselect_b32 s64, 34, 36
    s_load_dwordx2 s[44:45], s[0:1], 80
    s_mov_b32 s46, 8192
    s_waitcnt lgkmcnt(0)
    v_perm_b32 v20, v228, v224, s74
    v_perm_b32 v21, v236, v232, s74
    v_perm_b32 v22, v244, v240, s74
    v_perm_b32 v23, v252, v248, s74
    v_perm_b32 v24, v228, v224, s75
    v_perm_b32 v25, v236, v232, s75
    v_perm_b32 v26, v244, v240, s75
    v_perm_b32 v27, v252, v248, s75
    v_mfma_f32_16x16x32_bf16 v[44:47], v[28:31], v[20:23], v[44:47]
    v_perm_b32 v20, v229, v225, s74
    v_perm_b32 v21, v237, v233, s74
    v_perm_b32 v22, v245, v241, s74
    v_perm_b32 v23, v253, v249, s74
    v_mfma_f32_16x16x32_bf16 v[44:47], v[32:35], v[24:27], v[44:47]
    v_perm_b32 v24, v229, v225, s75
    v_perm_b32 v25, v237, v233, s75
    v_perm_b32 v26, v245, v241, s75
    v_perm_b32 v27, v253, v249, s75
    v_mfma_f32_16x16x32_bf16 v[44:47], v[36:39], v[20:23], v[44:47]
    v_perm_b32 v20, v230, v226, s74
    v_perm_b32 v21, v238, v234, s74
    v_perm_b32 v22, v246, v242, s74
    v_perm_b32 v23, v254, v250, s74
    v_mfma_f32_16x16x32_bf16 v[44:47], v[40:43], v[24:27], v[44:47]
    v_perm_b32 v24, v230, v226, s75
    v_perm_b32 v25, v238, v234, s75
    v_perm_b32 v26, v246, v242, s75
    v_perm_b32 v27, v254, v250, s75
    v_mfma_f32_16x16x32_bf16 v[48:51], v[28:31], v[20:23], v[48:51]
    v_perm_b32 v20, v231, v227, s74
    v_perm_b32 v21, v239, v235, s74
    v_perm_b32 v22, v247, v243, s74
    v_perm_b32 v23, v255, v251, s74
    v_mfma_f32_16x16x32_bf16 v[48:51], v[32:35], v[24:27], v[48:51]
    v_perm_b32 v24, v231, v227, s75
    v_perm_b32 v25, v239, v235, s75
    v_perm_b32 v26, v247, v243, s75
    v_perm_b32 v27, v255, v251, s75
    v_mfma_f32_16x16x32_bf16 v[48:51], v[36:39], v[20:23], v[48:51]
    s_nop 0
    v_mfma_f32_16x16x32_bf16 v[48:51], v[40:43], v[24:27], v[48:51]
    s_mov_b32 s65, 0
    s_mov_b32 s81, 0
    s_mov_b32 s100, -2
    s_mov_b32 s101, -2
    s_mov_b32 s5, -2
    s_mov_b32 s80, -2
    s_add_u32 s88, s94, NB_g3_0-L_pc
    s_addc_u32 s89, s95, 0
    s_call_b64 s[86:87], S_epi
L_out:
    v_bfe_u32 v52, v0, 2, 1
    v_lshlrev_b32 v52, 10, v52
    v_bfe_u32 v7, v0, 3, 2
    v_lshl_add_u32 v52, v7, 5, v52
    v_and_b32 v7, 3, v0
    v_lshl_add_u32 v52, v7, 3, v52
    s_lshl_b32 s71, s3, 11
    s_lshl_b32 s68, s6, 7
    s_add_u32 s71, s71, s68
    s_mov_b32 exec_hi, 0
    buffer_store_dwordx2 v[64:65], v52, s[44:47], s71 offen
    s_mov_b64 exec, -1
L_fin:
L_abort:
L_end:
    s_endpgm
L_restart:
    s_waitcnt vmcnt(0)
    s_barrier
    s_cmp_gt_u32 s68, 255
    s_cbranch_scc1 L_end
    s_and_b32 s4, s68, 7
    s_lshr_b32 s5, s68, 3
    s_mov_b32 s99, 1
    s_load_dwordx4 s[8:11], s[0:1], 8
    s_load_dwordx4 s[28:31], s[0:1], 24
    s_load_dwordx2 s[44:45], s[0:1], 0
    s_load_dwordx2 s[24:25], s[0:1], 96
    s_load_dwordx4 s[16:19], s[0:1], 48
    s_load_dwordx4 s[36:39], s[0:1], 64
    s_load_dwordx2 s[84:85], s[0:1], 88
    s_branch L_role
L_ovf:
    v_mov_b32 v60, 1
    s_lshl_b32 s68, s4, 5
    s_mov_b64 exec, 1
    buffer_atomic_add v60, v61, s[84:87], s68 offen offset:8 sc0
    s_mov_b64 exec, -1
    v_and_b32 v62, 7, v0
    v_lshlrev_b32 v62, 5, v62
    s_mov_b32 s98, 0
    s_waitcnt vmcnt(0)
    v_readfirstlane_b32 s65, v60
L_ovf_poll:
    buffer_load_dwordx2 v[54:55], v62, s[84:87], 0 offen offset:4 sc1
    s_waitcnt vmcnt(0)
    v_bcnt_u32_b32 v60, v54, v55
    s_mov_b32 s72, 0
    v_readlane_b32 s68, v60, 0
    s_nop 0
    s_add_u32 s72, s72, s68
    v_readlane_b32 s68, v60, 1
    s_nop 0
    s_add_u32 s72, s72, s68
    v_readlane_b32 s68, v60, 2
    s_nop 0
    s_add_u32 s72, s72, s68
    v_readlane_b32 s68, v60, 3
    s_nop 0
    s_add_u32 s72, s72, s68
    v_readlane_b32 s68, v60, 4
    s_nop 0
    s_add_u32 s72, s72, s68
    v_readlane_b32 s68, v60, 5
    s_nop 0
    s_add_u32 s72, s72, s68
    v_readlane_b32 s68, v60, 6
    s_nop 0
    s_add_u32 s72, s72, s68
    v_readlane_b32 s68, v60, 7
    s_nop 0
    s_add_u32 s72, s72, s68
    s_mov_b32 s69, 0x1000
    s_add_u32 s98, s98, 1
    s_cmp_gt_u32 s98, 1000000
    s_cbranch_scc1 L_ovf_done
    s_cmp_lt_u32 s72, 256
    s_cbranch_scc1 L_ovf_poll
    v_bcnt_u32_b32 v56, v54, 0
    v_sub_u32 v56, 32, v56
    v_min_u32 v59, v56, v55
    v_sub_u32 v57, v55, v59
    v_sub_u32 v58, v56, v59
    s_nop 1
    v_readlane_b32 s70, v56, s4
    s_mov_b32 s96, s4
    s_nop 1
    s_cmp_lt_u32 s65, s70
    s_cbranch_scc1 L_ovf_pick
    s_sub_u32 s65, s65, s70
    s_cmp_le_u32 s4, 0
    s_cbranch_scc1 L_ov_17
    v_readlane_b32 s68, v57, 0
    s_nop 0
    s_add_u32 s65, s65, s68
L_ov_17:
    s_cmp_le_u32 s4, 1
    s_cbranch_scc1 L_ov_18
    v_readlane_b32 s68, v57, 1
    s_nop 0
    s_add_u32 s65, s65, s68
L_ov_18:
    s_cmp_le_u32 s4, 2
    s_cbranch_scc1 L_ov_19
    v_readlane_b32 s68, v57, 2
    s_nop 0
    s_add_u32 s65, s65, s68
L_ov_19:
    s_cmp_le_u32 s4, 3
    s_cbranch_scc1 L_ov_20
    v_readlane_b32 s68, v57, 3
    s_nop 0
    s_add_u32 s65, s65, s68
L_ov_20:
    s_cmp_le_u32 s4, 4
    s_cbranch_scc1 L_ov_21
    v_readlane_b32 s68, v57, 4
    s_nop 0
    s_add_u32 s65, s65, s68
L_ov_21:
    s_cmp_le_u32 s4, 5
    s_cbranch_scc1 L_ov_22
    v_readlane_b32 s68, v57, 5
    s_nop 0
    s_add_u32 s65, s65, s68
L_ov_22:
    s_cmp_le_u32 s4, 6
    s_cbranch_scc1 L_ov_23
    v_readlane_b32 s68, v57, 6
    s_nop 0
    s_add_u32 s65, s65, s68
L_ov_23:
    s_cmp_le_u32 s4, 7
    s_cbranch_scc1 L_ov_24
    v_readlane_b32 s68, v57, 7
    s_nop 0
    s_add_u32 s65, s65, s68
L_ov_24:
    v_readlane_b32 s68, v58, 0
    v_readlane_b32 s71, v59, 0
    s_nop 0
    s_cmp_lt_u32 s65, s68
    s_cbranch_scc0 L_ov_25
    s_mov_b32 s96, 0
    s_add_u32 s65, s65, s71
    s_branch L_ovf_pick
L_ov_25:
    s_sub_u32 s65, s65, s68
    v_readlane_b32 s68, v58, 1
    v_readlane_b32 s71, v59, 1
    s_nop 0
    s_cmp_lt_u32 s65, s68
    s_cbranch_scc0 L_ov_26
    s_mov_b32 s96, 1
    s_add_u32 s65, s65, s71
    s_branch L_ovf_pick
L_ov_26:
    s_sub_u32 s65, s65, s68
    v_readlane_b32 s68, v58, 2
    v_readlane_b32 s71, v59, 2
    s_nop 0
    s_cmp_lt_u32 s65, s68
    s_cbranch_scc0 L_ov_27
    s_mov_b32 s96, 2
    s_add_u32 s65, s65, s71
    s_branch L_ovf_pick
L_ov_27:
    s_sub_u32 s65, s65, s68
    v_readlane_b32 s68, v58, 3
    v_readlane_b32 s71, v59, 3
    s_nop 0
    s_cmp_lt_u32 s65, s68
    s_cbranch_scc0 L_ov_28
    s_mov_b32 s96, 3
    s_add_u32 s65, s65, s71
    s_branch L_ovf_pick
L_ov_28:
    s_sub_u32 s65, s65, s68
    v_readlane_b32 s68, v58, 4
    v_readlane_b32 s71, v59, 4
    s_nop 0
    s_cmp_lt_u32 s65, s68
    s_cbranch_scc0 L_ov_29
    s_mov_b32 s96, 4
    s_add_u32 s65, s65, s71
    s_branch L_ovf_pick
L_ov_29:
    s_sub_u32 s65, s65, s68
    v_readlane_b32 s68, v58, 5
    v_readlane_b32 s71, v59, 5
    s_nop 0
    s_cmp_lt_u32 s65, s68
    s_cbranch_scc0 L_ov_30
    s_mov_b32 s96, 5
    s_add_u32 s65, s65, s71
    s_branch L_ovf_pick
L_ov_30:
    s_sub_u32 s65, s65, s68
    v_readlane_b32 s68, v58, 6
    v_readlane_b32 s71, v59, 6
    s_nop 0
    s_cmp_lt_u32 s65, s68
    s_cbranch_scc0 L_ov_31
    s_mov_b32 s96, 6
    s_add_u32 s65, s65, s71
    s_branch L_ovf_pick
L_ov_31:
    s_sub_u32 s65, s65, s68
    v_readlane_b32 s68, v58, 7
    v_readlane_b32 s71, v59, 7
    s_nop 0
    s_cmp_lt_u32 s65, s68
    s_cbranch_scc0 L_ov_32
    s_mov_b32 s96, 7
    s_add_u32 s65, s65, s71
    s_branch L_ovf_pick
L_ov_32:
    s_sub_u32 s65, s65, s68
    s_branch L_ovf_done
L_ovf_pick:
    v_readlane_b32 s68, v54, s96
    s_nop 1
    s_not_b32 s68, s68
L_ovf_bit:
    s_ff1_i32_b32 s73, s68
    s_bitset0_b32 s68, s73
    s_sub_u32 s65, s65, 1
    s_cbranch_scc0 L_ovf_bit
    s_lshl_b32 s69, s73, 3
    s_or_b32 s69, s69, s96
    s_branch L_ovf_done
S_epi:
    s_lshl_b32 s68, s3, 11
    v_add_u32 v52, s68, v2
    ds_write_b128 v52, v[44:47] offset:0
    ds_write_b128 v52, v[48:51] offset:1024
    v_and_b32 v54, 60, v0
    v_lshlrev_b32 v54, 2, v54
    v_and_b32 v7, 3, v0
    v_lshl_add_u32 v53, v7, 9, v54
    s_lshl_b32 s68, s3, 2
    v_add_u32 v53, s68, v53
    s_add_u32 s72, s49, s60
    s_waitcnt lgkmcnt(0)
    s_barrier
    ds_read2st64_b32 v[12:13], v53 offset0:0 offset1:1
    ds_read2st64_b32 v[14:15], v53 offset0:8 offset1:9
    ds_read2st64_b32 v[16:17], v53 offset0:16 offset1:17
    ds_read2st64_b32 v[18:19], v53 offset0:24 offset1:25
    s_add_u32 s68, s50, s60
    s_add_u32 s69, s51, s60
    s_add_u32 s70, s52, s61
    v_lshlrev_b32 v54, 4, v54
    s_waitcnt lgkmcnt(3)
    v_mul_f32 v12, s28, v12
    v_mul_f32 v13, s28, v13
    s_waitcnt lgkmcnt(2)
    v_fmac_f32 v12, s29, v14
    v_fmac_f32 v13, s29, v15
    s_waitcnt lgkmcnt(1)
    v_fmac_f32 v12, s30, v16
    v_fmac_f32 v13, s30, v17
    s_waitcnt lgkmcnt(0)
    v_fmac_f32 v12, s31, v18
    v_fmac_f32 v13, s31, v19
    v_cvt_pk_bf16_f32 v20, v12, v13
    v_min_u32 v20, -2, v20
    s_nop 1
    v_mov_b32_dpp v21, v20 quad_perm:[1,1,1,1] row_mask:0xf bank_mask:0xf
    v_mov_b32_dpp v22, v20 quad_perm:[2,2,2,2] row_mask:0xf bank_mask:0xf
    v_mov_b32_dpp v23, v20 quad_perm:[3,3,3,3] row_mask:0xf bank_mask:0xf
    s_mov_b32 exec_lo, 0x11111111
    s_mov_b32 exec_hi, 0x11111111
    s_cmp_eq_u32 s99, 0
    s_cbranch_scc1 L_sl_33
    buffer_store_dwordx4 v[20:23], v54, s[24:27], s72 offen
    s_branch L_sl_34
L_sl_33:
    buffer_store_dwordx4 v[20:23], v54, s[24:27], s72 offen sc1
L_sl_34:
    s_mov_b64 exec, -1
    v_and_b32 v16, 31, v0
    v_lshlrev_b32 v16, 7, v16
    s_mov_b32 exec_lo, -1
    s_mov_b32 exec_hi, 0
    buffer_load_dwordx2 v[12:13], v16, s[24:27], s70 offen sc1
    s_mov_b64 exec, -1
    buffer_load_dwordx4 v[28:31], v2, s[24:27], s68 offen offset:0 sc1
    buffer_load_dwordx4 v[32:35], v2, s[24:27], s68 offen offset:1024 sc1
    buffer_load_dwordx4 v[36:39], v2, s[24:27], s68 offen offset:2048 sc1
    buffer_load_dwordx4 v[40:43], v2, s[24:27], s68 offen offset:3072 sc1
    buffer_load_dwordx4 v[44:47], v2, s[24:27], s69 offen offset:0 sc1
    buffer_load_dwordx4 v[48:51], v2, s[24:27], s69 offen offset:1024 sc1
    buffer_load_dwordx4 v[52:55], v2, s[24:27], s69 offen offset:2048 sc1
    buffer_load_dwordx4 v[56:59], v2, s[24:27], s69 offen offset:3072 sc1
    s_mov_b32 s96, 0
    s_barrier
    s_lshl_b32 s73, s3, 10
    v_add_u32 v17, s73, v2
    v_and_b32 v7, 48, v0
    v_and_b32 v11, 7, v0
    v_lshl_add_u32 v11, v11, 6, v7
    v_lshrrev_b32 v8, 3, v0
    v_lshlrev_b32 v8, 9, v8
    v_and_b32 v7, 7, v0
    v_lshl_add_u32 v8, v7, 4, v8
    v_lshrrev_b32 v9, 5, v0
    v_mul_u32_u24 v9, 4608, v9
    v_and_b32 v7, 31, v0
    v_lshl_add_u32 v9, v7, 4, v9
    v_and_b32 v10, 7, v0
    v_mul_u32_u24 v10, 4608, v10
    s_mov_b32 s98, 0
L_retry_35:
    s_cmp_ge_i32 s100, 0
    s_cbranch_scc1 L_w0_38
    s_waitcnt vmcnt(0)
    s_branch L_w2_40
L_w0_38:
    s_getreg_b32 s97, hwreg(HW_REG_IB_STS)
    s_bfe_u32 s66, s97, 0x20016
    s_and_b32 s97, s97, 15
    s_lshl_b32 s66, s66, 4
    s_or_b32 s97, s97, s66
    s_cmp_le_u32 s97, s96
    s_cbranch_scc1 L_w1_39
    s_sub_i32 s97, s97, 9
    s_max_i32 s97, s97, s96
    s_cmp_gt_i32 s97, s100
    s_cbranch_scc1 L_w0_38
    s_swappc_b64 s[90:91], s[88:89]
    s_branch L_w0_38
L_w1_39:
    s_lshl_b32 s66, s96, 3
    s_add_u32 s66, s66, WT-L_pc
    s_add_u32 s92, s94, s66
    s_addc_u32 s93, s95, 0
    s_swappc_b64 s[90:91], s[92:93]
L_w2_40:
    s_bitcmp1_b32 s64, 5
    s_cbranch_scc1 L_mb_41
    v_mfma_f32_16x16x32_bf16 v[20:23], a[192:195], v[28:31], 0
    v_mfma_f32_16x16x32_bf16 v[20:23], a[196:199], v[32:35], v[20:23]
    v_mfma_f32_16x16x32_bf16 v[20:23], a[200:203], v[36:39], v[20:23]
    v_mfma_f32_16x16x32_bf16 v[20:23], a[204:207], v[40:43], v[20:23]
    v_mfma_f32_16x16x32_bf16 v[24:27], a[192:195], v[44:47], 0
    v_mfma_f32_16x16x32_bf16 v[24:27], a[196:199], v[48:51], v[24:27]
    v_mfma_f32_16x16x32_bf16 v[24:27], a[200:203], v[52:55], v[24:27]
    v_mfma_f32_16x16x32_bf16 v[24:27], a[204:207], v[56:59], v[24:27]
    s_branch L_me_42
L_mb_41:
    s_nop 2
    v_mfma_f32_16x16x32_bf16 v[20:23], a[208:211], v[28:31], 0
    v_mfma_f32_16x16x32_bf16 v[20:23], a[212:215], v[32:35], v[20:23]
    v_mfma_f32_16x16x32_bf16 v[20:23], a[216:219], v[36:39], v[20:23]
    v_mfma_f32_16x16x32_bf16 v[20:23], a[220:223], v[40:43], v[20:23]
    v_mfma_f32_16x16x32_bf16 v[24:27], a[208:211], v[44:47], 0
    v_mfma_f32_16x16x32_bf16 v[24:27], a[212:215], v[48:51], v[24:27]
    v_mfma_f32_16x16x32_bf16 v[24:27], a[216:219], v[52:55], v[24:27]
    v_mfma_f32_16x16x32_bf16 v[24:27], a[220:223], v[56:59], v[24:27]
    s_nop 0
L_me_42:
    v_max_u32 v7, v28, v29
    v_max3_u32 v7, v30, v31, v7
    v_max3_u32 v7, v32, v33, v7
    v_max3_u32 v7, v34, v35, v7
    v_max3_u32 v7, v36, v37, v7
    v_max3_u32 v7, v38, v39, v7
    v_max3_u32 v7, v40, v41, v7
    v_max3_u32 v7, v42, v43, v7
    v_max3_u32 v7, v44, v45, v7
    v_max3_u32 v7, v46, v47, v7
    v_max3_u32 v7, v48, v49, v7
    v_max3_u32 v7, v50, v51, v7
    v_max3_u32 v7, v52, v53, v7
    v_max3_u32 v7, v54, v55, v7
    v_max3_u32 v7, v56, v57, v7
    v_max3_u32 v7, v58, v59, v7
    v_cmp_eq_u32 vcc, -1, v7
    v_max_u32 v7, v12, v13
    v_cmp_eq_u32 s[84:85], -1, v7
    s_nop 0
    s_and_b32 s84, s84, -1
    s_mov_b32 s85, 0
    s_or_b64 s[92:93], s[84:85], vcc
    s_cbranch_scc0 L_ok_36
    s_min_i32 s100, s100, s80
    s_mov_b64 exec, s[84:85]
    s_cbranch_execz L_nos_37
    buffer_load_dwordx2 v[12:13], v16, s[24:27], s70 offen sc1
L_nos_37:
    s_mov_b64 exec, vcc
    s_cbranch_execz L_nol_43
    buffer_load_dwordx4 v[28:31], v2, s[24:27], s68 offen offset:0 sc1
    buffer_load_dwordx4 v[32:35], v2, s[24:27], s68 offen offset:1024 sc1
    buffer_load_dwordx4 v[36:39], v2, s[24:27], s68 offen offset:2048 sc1
    buffer_load_dwordx4 v[40:43], v2, s[24:27], s68 offen offset:3072 sc1
    buffer_load_dwordx4 v[44:47], v2, s[24:27], s69 offen offset:0 sc1
    buffer_load_dwordx4 v[48:51], v2, s[24:27], s69 offen offset:1024 sc1
    buffer_load_dwordx4 v[52:55], v2, s[24:27], s69 offen offset:2048 sc1
    buffer_load_dwordx4 v[56:59], v2, s[24:27], s69 offen offset:3072 sc1
L_nol_43:
    s_mov_b64 exec, -1
    s_mov_b32 s96, 0
    s_add_u32 s98, s98, 1
    s_cmp_lt_u32 s98, 1000000
    s_cbranch_scc1 L_retry_35
    s_branch L_abort
L_ok_36:
    v_max_f32_dpp v19, v12, v12 row_ror:8 row_mask:0xf bank_mask:0xf
    v_mov_b32 v7, v19
    s_nop 1
    v_permlane16_swap_b32 v19, v7
    v_max_f32 v19, v19, v7
    v_sub_f32 v12, v12, v19
    v_exp_f32 v12, v12
    s_nop 0
    v_mul_f32 v12, v12, v13
    s_nop 1
    v_add_f32_dpp v19, v12, v12 row_ror:8 row_mask:0xf bank_mask:0xf
    v_mov_b32 v7, v19
    s_nop 1
    v_permlane16_swap_b32 v19, v7
    v_add_f32 v19, v19, v7
    v_rcp_f32 v19, v19
    s_nop 0
    v_mul_f32 v12, v12, v19
    v_mov_b32 v13, v12
    s_nop 1
    v_permlane32_swap_b32 v12, v13
    v_mov_b32 v13, v12
    s_nop 1
    v_permlane16_swap_b32 v12, v13
    s_bitcmp0_b32 s7, 1
    s_cselect_b64 s[84:85], -1, 0
    v_cndmask_b32 v14, v12, v13, s[84:85]
    v_cndmask_b32 v15, v13, v12, s[84:85]
    s_add_u32 s68, s54, s62
    s_add_u32 s69, s55, s62
    v_mul_f32 v20, v20, v14
    v_mul_f32 v21, v21, v14
    v_mul_f32 v22, v22, v14
    v_mul_f32 v23, v23, v14
    v_fmac_f32 v20, v24, v15
    v_fmac_f32 v21, v25, v15
    v_fmac_f32 v22, v26, v15
    v_fmac_f32 v23, v27, v15
    v_add_f32_dpp v20, v20, v20 row_ror:8 row_mask:0xf bank_mask:0xf
    v_add_f32_dpp v21, v21, v21 row_ror:8 row_mask:0xf bank_mask:0xf
    v_add_f32_dpp v22, v22, v22 row_ror:8 row_mask:0xf bank_mask:0xf
    v_add_f32_dpp v23, v23, v23 row_ror:8 row_mask:0xf bank_mask:0xf
    ds_write_b128 v17, v[20:23]
    s_waitcnt lgkmcnt(0)
    s_barrier
    s_cmp_lg_u32 s3, 0
    s_cbranch_scc1 L_skip_44
    ds_read_b128 v[32:35], v17 offset:1024
    ds_read_b128 v[36:39], v17 offset:2048
    ds_read_b128 v[40:43], v17 offset:3072
    s_waitcnt lgkmcnt(2)
    v_pk_add_f32 v[20:21], v[20:21], v[32:33]
    v_pk_add_f32 v[22:23], v[22:23], v[34:35]
    s_waitcnt lgkmcnt(0)
    v_pk_add_f32 v[36:37], v[36:37], v[40:41]
    v_pk_add_f32 v[38:39], v[38:39], v[42:43]
    v_pk_add_f32 v[20:21], v[20:21], v[36:37]
    v_pk_add_f32 v[22:23], v[22:23], v[38:39]
    v_and_or_b32 v20, v20, -4, s82
    v_and_or_b32 v21, v21, -4, s82
    v_and_or_b32 v22, v22, -4, s82
    v_and_or_b32 v23, v23, -4, s82
    s_mov_b32 exec_lo, 0x00ff00ff
    s_mov_b32 exec_hi, 0x00ff00ff
    buffer_store_dwordx4 v[20:23], v11, s[24:27], s68 offen sc1
    s_mov_b64 exec, -1
L_skip_44:
    s_bitcmp1_b32 s64, 2
    s_cbranch_scc1 L_fin
    v_bfe_u32 v5, v0, 2, 1
    v_mul_u32_u24 v5, 144, v5
    v_bfe_u32 v7, v0, 3, 2
    v_lshl_add_u32 v5, v7, 5, v5
    v_and_b32 v7, 3, v0
    v_lshl_add_u32 v5, v7, 3, v5
    s_mul_i32 s72, s3, 288
    v_add_u32 v5, s72, v5
    v_and_b32 v54, 7, v0
    v_mul_u32_u24 v6, 144, v54
    v_and_b32 v7, 48, v0
    v_add_u32 v6, v7, v6
    v_lshl_add_u32 v54, v54, 9, v7
    v_and_b32 v7, 8, v0
    v_lshl_add_u32 v54, v7, 3, v54
    s_add_u32 s72, s69, 0
    buffer_load_dwordx4 v[28:31], v8, s[24:27], s72 offen sc1
    s_add_u32 s72, s69, 4096
    buffer_load_dwordx4 v[32:35], v8, s[24:27], s72 offen sc1
    s_add_u32 s72, s69, 8192
    buffer_load_dwordx4 v[36:39], v8, s[24:27], s72 offen sc1
    s_add_u32 s72, s69, 12288
    buffer_load_dwordx4 v[40:43], v8, s[24:27], s72 offen sc1
    s_mov_b32 s96, 0
    s_mov_b32 s98, 0
L_retry_45:
    s_cmp_ge_i32 s101, 0
    s_cbranch_scc1 L_w0_48
    s_waitcnt vmcnt(0)
    s_branch L_w2_50
L_w0_48:
    s_getreg_b32 s97, hwreg(HW_REG_IB_STS)
    s_bfe_u32 s66, s97, 0x20016
    s_and_b32 s97, s97, 15
    s_lshl_b32 s66, s66, 4
    s_or_b32 s97, s97, s66
    s_cmp_le_u32 s97, s96
    s_cbranch_scc1 L_w1_49
    s_sub_i32 s97, s97, 4
    s_max_i32 s97, s97, s96
    s_cmp_gt_i32 s97, s101
    s_cbranch_scc1 L_w0_48
    s_swappc_b64 s[90:91], s[88:89]
    s_branch L_w0_48
L_w1_49:
    s_lshl_b32 s66, s96, 3
    s_add_u32 s66, s66, WT-L_pc
    s_add_u32 s92, s94, s66
    s_addc_u32 s93, s95, 0
    s_swappc_b64 s[90:91], s[92:93]
L_w2_50:
    v_or_b32 v7, v28, v29
    v_or3_b32 v7, v30, v31, v7
    v_or3_b32 v7, v32, v33, v7
    v_or3_b32 v7, v34, v35, v7
    v_or3_b32 v7, v36, v37, v7
    v_or3_b32 v7, v38, v39, v7
    v_or3_b32 v7, v40, v41, v7
    v_or3_b32 v7, v42, v43, v7
    v_and_b32 v7, s63, v7
    v_cmp_ne_u32 vcc, 0, v7
    s_nop 0
    s_cbranch_vccz L_ok_46
    s_min_i32 s101, s101, s80
    s_mov_b64 exec, vcc
    s_cbranch_execz L_nol_51
    s_add_u32 s72, s69, 0
    buffer_load_dwordx4 v[28:31], v8, s[24:27], s72 offen sc1
    s_add_u32 s72, s69, 4096
    buffer_load_dwordx4 v[32:35], v8, s[24:27], s72 offen sc1
    s_add_u32 s72, s69, 8192
    buffer_load_dwordx4 v[36:39], v8, s[24:27], s72 offen sc1
    s_add_u32 s72, s69, 12288
    buffer_load_dwordx4 v[40:43], v8, s[24:27], s72 offen sc1
L_nol_51:
    s_mov_b64 exec, -1
    s_mov_b32 s96, 0
    s_add_u32 s98, s98, 1
    s_cmp_lt_u32 s98, 1000000
    s_cbranch_scc1 L_retry_45
    s_branch L_abort
L_ok_46:
    v_pk_add_f32 v[28:29], v[28:29], v[32:33]
    v_pk_add_f32 v[30:31], v[30:31], v[34:35]
    v_pk_add_f32 v[36:37], v[36:37], v[40:41]
    v_pk_add_f32 v[38:39], v[38:39], v[42:43]
    v_pk_add_f32 v[28:29], v[28:29], v[36:37]
    v_pk_add_f32 v[30:31], v[30:31], v[38:39]
    v_mov_b32 v32, v28
    v_mov_b32 v33, v29
    v_mov_b32 v34, v30
    v_mov_b32 v35, v31
    v_permlane32_swap_b32 v28, v32
    v_permlane32_swap_b32 v29, v33
    v_permlane32_swap_b32 v30, v34
    v_permlane32_swap_b32 v31, v35
    v_pk_add_f32 v[28:29], v[28:29], v[32:33]
    v_pk_add_f32 v[30:31], v[30:31], v[34:35]
    v_cvt_pk_bf16_f32 v32, v28, v29
    v_cvt_pk_bf16_f32 v33, v30, v31
    v_lshlrev_b32 v36, 16, v64
    v_and_b32 v37, 0xffff0000, v64
    v_lshlrev_b32 v28, 16, v32
    v_and_b32 v29, 0xffff0000, v32
    v_lshlrev_b32 v38, 16, v65
    v_and_b32 v39, 0xffff0000, v65
    v_lshlrev_b32 v30, 16, v33
    v_and_b32 v31, 0xffff0000, v33
    v_pk_add_f32 v[28:29], v[28:29], v[36:37]
    v_pk_add_f32 v[30:31], v[30:31], v[38:39]
    v_cvt_pk_bf16_f32 v64, v28, v29
    v_cvt_pk_bf16_f32 v65, v30, v31
    s_bitcmp1_b32 s64, 1
    s_cbranch_scc1 L_out
S_w2:
    ds_write_b64 v5, v[64:65] offset:8192
    v_lshlrev_b32 v28, 16, v64
    v_and_b32 v29, 0xffff0000, v64
    v_lshlrev_b32 v30, 16, v65
    v_and_b32 v31, 0xffff0000, v65
    v_add_f32 v32, v28, v29
    v_add_f32 v33, v30, v31
    v_add_f32 v32, v32, v33
    s_waitcnt lgkmcnt(0)
    s_barrier
    ds_read_b128 v[12:15], v6 offset:8192
    ds_read_b128 v[16:19], v6 offset:8256
    v_add_f32_dpp v32, v32, v32 quad_perm:[1,0,3,2] row_mask:0xf bank_mask:0xf
    s_nop 1
    v_add_f32_dpp v32, v32, v32 quad_perm:[2,3,0,1] row_mask:0xf bank_mask:0xf
    s_nop 1
    v_add_f32_dpp v32, v32, v32 row_ror:8 row_mask:0xf bank_mask:0xf
    v_mov_b32 v33, v32
    s_nop 1
    v_permlane16_swap_b32 v32, v33
    v_add_f32 v32, v32, v33
    s_bitcmp1_b32 s64, 6
    s_cbranch_scc1 L_mb_52
    s_waitcnt lgkmcnt(1)
    v_mfma_f32_16x16x32_bf16 v[20:23], a[224:227], v[12:15], 0
    v_mfma_f32_16x16x32_bf16 v[24:27], a[228:231], v[12:15], 0
    s_waitcnt lgkmcnt(0)
    v_mfma_f32_16x16x32_bf16 v[20:23], a[232:235], v[16:19], v[20:23]
    v_mfma_f32_16x16x32_bf16 v[24:27], a[236:239], v[16:19], v[24:27]
    s_branch L_me_53
L_mb_52:
    s_waitcnt lgkmcnt(1)
    s_nop 4
    v_mfma_f32_16x16x32_bf16 v[20:23], a[240:243], v[12:15], 0
    v_mfma_f32_16x16x32_bf16 v[24:27], a[244:247], v[12:15], 0
    s_waitcnt lgkmcnt(0)
    v_mfma_f32_16x16x32_bf16 v[20:23], a[248:251], v[16:19], v[20:23]
    v_mfma_f32_16x16x32_bf16 v[24:27], a[252:255], v[16:19], v[24:27]
    s_nop 0
L_me_53:
    v_mul_f32 v34, 0x3c800000, v32
    v_sub_f32 v28, v28, v34
    v_sub_f32 v29, v29, v34
    v_sub_f32 v30, v30, v34
    v_sub_f32 v31, v31, v34
    v_mul_f32 v35, v28, v28
    v_fmac_f32 v35, v29, v29
    v_fmac_f32 v35, v30, v30
    v_fmac_f32 v35, v31, v31
    v_mov_b32_dpp v20, v24 row_shr:8 row_mask:0xf bank_mask:0xc
    v_mov_b32_dpp v21, v25 row_shr:8 row_mask:0xf bank_mask:0xc
    v_mov_b32_dpp v22, v26 row_shr:8 row_mask:0xf bank_mask:0xc
    v_mov_b32_dpp v23, v27 row_shr:8 row_mask:0xf bank_mask:0xc
    v_and_or_b32 v20, v20, -4, s83
    v_and_or_b32 v21, v21, -4, s83
    v_and_or_b32 v22, v22, -4, s83
    v_and_or_b32 v23, v23, -4, s83
    s_cmp_eq_u32 s99, 0
    s_cbranch_scc1 L_sl_54
    buffer_store_dwordx4 v[20:23], v54, s[24:27], s56 offen
    s_branch L_sl_55
L_sl_54:
    buffer_store_dwordx4 v[20:23], v54, s[24:27], s56 offen sc1
L_sl_55:
    v_and_b32 v36, 4, v0
    v_lshlrev_b32 v36, 4, v36
    v_and_b32 v37, 8, v0
    v_lshl_add_u32 v36, v37, 2, v36
    v_and_b32 v37, 3, v0
    v_lshl_add_u32 v36, v37, 3, v36
    v_add_f32_dpp v35, v35, v35 quad_perm:[1,0,3,2] row_mask:0xf bank_mask:0xf
    s_nop 1
    v_add_f32_dpp v35, v35, v35 quad_perm:[2,3,0,1] row_mask:0xf bank_mask:0xf
    s_nop 1
    v_add_f32_dpp v35, v35, v35 row_ror:8 row_mask:0xf bank_mask:0xf
    v_mov_b32 v33, v35
    s_nop 1
    v_permlane16_swap_b32 v35, v33
    v_add_f32 v35, v35, v33
    v_and_or_b32 v34, v34, -4, s83
    v_and_or_b32 v35, v35, -4, s83
    s_mov_b64 exec, 0xffff
    s_cmp_eq_u32 s99, 0
    s_cbranch_scc1 L_sl_56
    buffer_store_dwordx2 v[34:35], v36, s[24:27], s57 offen
    s_branch L_sl_57
L_sl_56:
    buffer_store_dwordx2 v[34:35], v36, s[24:27], s57 offen sc1
L_sl_57:
    s_mov_b64 exec, -1
    s_bitcmp1_b32 s64, 3
    s_cbranch_scc0 S_q
    s_setpc_b64 s[86:87]
S_q:
    v_bfe_u32 v52, v0, 3, 2
    v_lshlrev_b32 v52, 6, v52
    v_and_b32 v7, 3, v0
    v_lshl_add_u32 v52, v7, 4, v52
    v_lshlrev_b32 v53, 8, v7
    v_bfe_u32 v7, v0, 2, 1
    v_lshl_add_u32 v52, v7, 1, v52
    s_lshl_b32 s72, s3, 8
    v_add_u32 v52, s72, v52
    v_lshrrev_b32 v7, 2, v0
    v_lshl_add_u32 v53, v7, 4, v53
    s_mov_b32 exec_lo, 0xff
    s_mov_b32 exec_hi, 0
    buffer_load_dwordx2 v[12:13], v10, s[24:27], s59 offen sc1
    s_mov_b64 exec, -1
    s_add_u32 s72, s58, 0
    buffer_load_dwordx4 v[28:31], v9, s[24:27], s72 offen sc1
    s_add_u32 s72, s58, 9216
    buffer_load_dwordx4 v[32:35], v9, s[24:27], s72 offen sc1
    s_add_u32 s72, s58, 18432
    buffer_load_dwordx4 v[36:39], v9, s[24:27], s72 offen sc1
    s_add_u32 s72, s58, 27648
    buffer_load_dwordx4 v[40:43], v9, s[24:27], s72 offen sc1
    s_mov_b32 s96, 0
S_q1:
    s_mov_b32 s98, 0
L_retry_58:
    s_cmp_ge_i32 s5, 0
    s_cbranch_scc1 L_w0_61
    s_waitcnt vmcnt(0)
    s_branch L_w2_63
L_w0_61:
    s_getreg_b32 s97, hwreg(HW_REG_IB_STS)
    s_bfe_u32 s66, s97, 0x20016
    s_and_b32 s97, s97, 15
    s_lshl_b32 s66, s66, 4
    s_or_b32 s97, s97, s66
    s_cmp_le_u32 s97, s96
    s_cbranch_scc1 L_w1_62
    s_sub_i32 s97, s97, 5
    s_max_i32 s97, s97, s96
    s_cmp_gt_i32 s97, s5
    s_cbranch_scc1 L_w0_61
    s_swappc_b64 s[90:91], s[88:89]
    s_branch L_w0_61
L_w1_62:
    s_lshl_b32 s66, s96, 3
    s_add_u32 s66, s66, WT-L_pc
    s_add_u32 s92, s94, s66
    s_addc_u32 s93, s95, 0
    s_swappc_b64 s[90:91], s[92:93]
L_w2_63:
    v_or_b32 v7, v28, v29
    v_or3_b32 v7, v30, v31, v7
    v_or3_b32 v7, v32, v33, v7
    v_or3_b32 v7, v34, v35, v7
    v_or3_b32 v7, v36, v37, v7
    v_or3_b32 v7, v38, v39, v7
    v_or3_b32 v7, v40, v41, v7
    v_or3_b32 v7, v42, v43, v7
    v_and_b32 v7, s78, v7
    v_cmp_ne_u32 vcc, 0, v7
    v_or_b32 v7, v12, v13
    v_and_b32 v7, s78, v7
    v_cmp_ne_u32 s[84:85], 0, v7
    s_nop 0
    s_and_b32 s84, s84, 0xff
    s_mov_b32 s85, 0
    s_or_b64 s[92:93], s[84:85], vcc
    s_cbranch_scc0 L_ok_59
    s_min_i32 s5, s5, s80
    s_mov_b64 exec, s[84:85]
    s_cbranch_execz L_nos_60
    buffer_load_dwordx2 v[12:13], v10, s[24:27], s59 offen sc1
L_nos_60:
    s_mov_b64 exec, vcc
    s_cbranch_execz L_nol_64
    s_add_u32 s72, s58, 0
    buffer_load_dwordx4 v[28:31], v9, s[24:27], s72 offen sc1
    s_add_u32 s72, s58, 9216
    buffer_load_dwordx4 v[32:35], v9, s[24:27], s72 offen sc1
    s_add_u32 s72, s58, 18432
    buffer_load_dwordx4 v[36:39], v9, s[24:27], s72 offen sc1
    s_add_u32 s72, s58, 27648
    buffer_load_dwordx4 v[40:43], v9, s[24:27], s72 offen sc1
L_nol_64:
    s_mov_b64 exec, -1
    s_mov_b32 s96, 0
    s_add_u32 s98, s98, 1
    s_cmp_lt_u32 s98, 1000000
    s_cbranch_scc1 L_retry_58
    s_branch L_abort
L_ok_59:
    v_mul_f32 v14, 0x3e000000, v12
    v_mov_b32 v7, 0x3727c5ac
    s_nop 0
    v_add_f32_dpp v14, v14, v14 quad_perm:[1,0,3,2] row_mask:0xf bank_mask:0xf
    v_pk_add_f32 v[28:29], v[28:29], v[32:33]
    v_pk_add_f32 v[30:31], v[30:31], v[34:35]
    v_add_f32_dpp v14, v14, v14 quad_perm:[2,3,0,1] row_mask:0xf bank_mask:0xf
    v_pk_add_f32 v[36:37], v[36:37], v[40:41]
    v_pk_add_f32 v[38:39], v[38:39], v[42:43]
    v_add_f32_dpp v14, v14, v14 row_half_mirror row_mask:0xf bank_mask:0xf
    v_pk_add_f32 v[28:29], v[28:29], v[36:37]
    v_pk_add_f32 v[30:31], v[30:31], v[38:39]
    v_sub_f32 v15, v12, v14
    v_readfirstlane_b32 s68, v14
    v_mul_f32 v15, v15, v15
    v_fmac_f32 v13, 0x42800000, v15
    v_mov_b32 v32, v28
    v_mov_b32 v33, v29
    v_add_f32_dpp v13, v13, v13 quad_perm:[1,0,3,2] row_mask:0xf bank_mask:0xf
    v_mov_b32 v34, v30
    v_mov_b32 v35, v31
    v_add_f32_dpp v13, v13, v13 quad_perm:[2,3,0,1] row_mask:0xf bank_mask:0xf
    v_permlane32_swap_b32 v28, v32
    v_permlane32_swap_b32 v29, v33
    v_add_f32_dpp v13, v13, v13 row_half_mirror row_mask:0xf bank_mask:0xf
    v_permlane32_swap_b32 v30, v34
    v_permlane32_swap_b32 v31, v35
    v_fmac_f32 v7, 0x3b000000, v13
    v_rsq_f32 v7, v7
    v_pk_add_f32 v[28:29], v[28:29], v[32:33]
    v_pk_add_f32 v[30:31], v[30:31], v[34:35]
    v_readfirstlane_b32 s69, v7
    v_fma_f32 v28, -v60, s68, v28
    v_fma_f32 v29, -v61, s68, v29
    v_fma_f32 v30, -v62, s68, v30
    v_fma_f32 v31, -v63, s68, v31
    v_mul_f32 v28, s69, v28
    v_mul_f32 v29, s69, v29
    v_mul_f32 v30, s69, v30
    v_mul_f32 v31, s69, v31
    v_cvt_pk_bf16_f32 v28, v28, v29
    v_cvt_pk_bf16_f32 v29, v30, v31
    s_mov_b32 exec_hi, 0
    ds_write_b16 v52, v28 offset:9344
    ds_write_b16_d16_hi v52, v28 offset:9348
    ds_write_b16 v52, v29 offset:9352
    ds_write_b16_d16_hi v52, v29 offset:9356
    s_mov_b64 exec, -1
    v_mov_b32 v32, v60
    v_mov_b32 v33, v61
    v_mov_b32 v34, v62
    v_mov_b32 v35, v63
    v_permlane32_swap_b32 v32, v60
    v_permlane32_swap_b32 v33, v61
    v_permlane32_swap_b32 v34, v62
    v_permlane32_swap_b32 v35, v63
    s_mov_b32 exec_lo, 0
    v_mov_b32 v60, v32
    v_mov_b32 v61, v33
    v_mov_b32 v62, v34
    v_mov_b32 v63, v35
    s_mov_b64 exec, -1
    s_waitcnt lgkmcnt(0)
    s_barrier
    ds_read_b128 v[8:11], v53 offset:9344
L_flush_65:
    s_cmp_ge_u32 s65, s81
    s_cbranch_scc1 L_flushed_66
    s_swappc_b64 s[90:91], s[88:89]
    s_branch L_flush_65
L_flushed_66:
    s_waitcnt lgkmcnt(0)
    s_setpc_b64 s[86:87]
.p2align 6
WT:
    s_waitcnt vmcnt(0)
    s_setpc_b64 s[90:91]
    s_waitcnt vmcnt(1)
    s_setpc_b64 s[90:91]
    s_waitcnt vmcnt(2)
    s_setpc_b64 s[90:91]
    s_waitcnt vmcnt(3)
    s_setpc_b64 s[90:91]
    s_waitcnt vmcnt(4)
    s_setpc_b64 s[90:91]
    s_waitcnt vmcnt(5)
    s_setpc_b64 s[90:91]
    s_waitcnt vmcnt(6)
    s_setpc_b64 s[90:91]
    s_waitcnt vmcnt(7)
    s_setpc_b64 s[90:91]
    s_waitcnt vmcnt(8)
    s_setpc_b64 s[90:91]
    s_waitcnt vmcnt(9)
    s_setpc_b64 s[90:91]
    s_waitcnt vmcnt(10)
    s_setpc_b64 s[90:91]
    s_waitcnt vmcnt(11)
    s_setpc_b64 s[90:91]
    s_waitcnt vmcnt(12)
    s_setpc_b64 s[90:91]
    s_waitcnt vmcnt(13)
    s_setpc_b64 s[90:91]
    s_waitcnt vmcnt(14)
    s_setpc_b64 s[90:91]
    s_waitcnt vmcnt(15)
    s_setpc_b64 s[90:91]
    s_waitcnt vmcnt(16)
    s_setpc_b64 s[90:91]
    s_waitcnt vmcnt(17)
    s_setpc_b64 s[90:91]
    s_waitcnt vmcnt(18)
    s_setpc_b64 s[90:91]
    s_waitcnt vmcnt(19)
    s_setpc_b64 s[90:91]
    s_waitcnt vmcnt(20)
    s_setpc_b64 s[90:91]
    s_waitcnt vmcnt(21)
    s_setpc_b64 s[90:91]
    s_waitcnt vmcnt(22)
    s_setpc_b64 s[90:91]
    s_waitcnt vmcnt(23)
    s_setpc_b64 s[90:91]
    s_waitcnt vmcnt(24)
    s_setpc_b64 s[90:91]
    s_waitcnt vmcnt(25)
    s_setpc_b64 s[90:91]
    s_waitcnt vmcnt(26)
    s_setpc_b64 s[90:91]
    s_waitcnt vmcnt(27)
    s_setpc_b64 s[90:91]
    s_waitcnt vmcnt(28)
    s_setpc_b64 s[90:91]
    s_waitcnt vmcnt(29)
    s_setpc_b64 s[90:91]
    s_waitcnt vmcnt(30)
    s_setpc_b64 s[90:91]
    s_waitcnt vmcnt(31)
    s_setpc_b64 s[90:91]
    s_waitcnt vmcnt(32)
    s_setpc_b64 s[90:91]
    s_waitcnt vmcnt(33)
    s_setpc_b64 s[90:91]
    s_waitcnt vmcnt(34)
    s_setpc_b64 s[90:91]
    s_waitcnt vmcnt(35)
    s_setpc_b64 s[90:91]
    s_waitcnt vmcnt(36)
    s_setpc_b64 s[90:91]
    s_waitcnt vmcnt(37)
    s_setpc_b64 s[90:91]
    s_waitcnt vmcnt(38)
    s_setpc_b64 s[90:91]
    s_waitcnt vmcnt(39)
    s_setpc_b64 s[90:91]
    s_waitcnt vmcnt(40)
    s_setpc_b64 s[90:91]
    s_waitcnt vmcnt(41)
    s_setpc_b64 s[90:91]
    s_waitcnt vmcnt(42)
    s_setpc_b64 s[90:91]
    s_waitcnt vmcnt(43)
    s_setpc_b64 s[90:91]
    s_waitcnt vmcnt(44)
    s_setpc_b64 s[90:91]
    s_waitcnt vmcnt(45)
    s_setpc_b64 s[90:91]
    s_waitcnt vmcnt(46)
    s_setpc_b64 s[90:91]
    s_waitcnt vmcnt(47)
    s_setpc_b64 s[90:91]
    s_waitcnt vmcnt(48)
    s_setpc_b64 s[90:91]
    s_waitcnt vmcnt(49)
    s_setpc_b64 s[90:91]
    s_waitcnt vmcnt(50)
    s_setpc_b64 s[90:91]
    s_waitcnt vmcnt(51)
    s_setpc_b64 s[90:91]
    s_waitcnt vmcnt(52)
    s_setpc_b64 s[90:91]
    s_waitcnt vmcnt(53)
    s_setpc_b64 s[90:91]
    s_waitcnt vmcnt(54)
    s_setpc_b64 s[90:91]
    s_waitcnt vmcnt(55)
    s_setpc_b64 s[90:91]
    s_waitcnt vmcnt(56)
    s_setpc_b64 s[90:91]
    s_waitcnt vmcnt(57)
    s_setpc_b64 s[90:91]
    s_waitcnt vmcnt(58)
    s_setpc_b64 s[90:91]
    s_waitcnt vmcnt(59)
    s_setpc_b64 s[90:91]
    s_waitcnt vmcnt(60)
    s_setpc_b64 s[90:91]
    s_waitcnt vmcnt(61)
    s_setpc_b64 s[90:91]
    s_waitcnt vmcnt(62)
    s_setpc_b64 s[90:91]
    s_waitcnt vmcnt(63)
    s_setpc_b64 s[90:91]
S_sm:
    v_max_f32 v28, v12, v13
    v_max3_f32 v28, v14, v15, v28
    v_max3_f32 v28, v16, v17, v28
    v_max3_f32 v28, v18, v19, v28
    v_max3_f32 v28, v20, v21, v28
    v_max3_f32 v28, v22, v23, v28
    v_max3_f32 v28, v24, v25, v28
    v_max3_f32 v28, v26, v27, v28
    s_nop 1
    v_max_f32_dpp v28, v28, v28 row_ror:4 row_mask:0xf bank_mask:0xf
    s_nop 1
    v_max_f32_dpp v28, v28, v28 row_ror:8 row_mask:0xf bank_mask:0xf
    v_mov_b32 v29, v28
    s_nop 1
    v_permlane16_swap_b32 v28, v29
    v_max_f32 v28, v28, v29
    v_mov_b32 v29, v28
    s_nop 1
    v_permlane32_swap_b32 v28, v29
    v_max_f32 v28, v28, v29
    v_mul_f32 v5, s76, v28
    v_fma_f32 v12, v12, s76, -v5
    v_fma_f32 v13, v13, s76, -v5
    v_fma_f32 v14, v14, s76, -v5
    v_fma_f32 v15, v15, s76, -v5
    v_fma_f32 v16, v16, s76, -v5
    v_fma_f32 v17, v17, s76, -v5
    v_fma_f32 v18, v18, s76, -v5
    v_fma_f32 v19, v19, s76, -v5
    v_fma_f32 v20, v20, s76, -v5
    v_fma_f32 v21, v21, s76, -v5
    v_fma_f32 v22, v22, s76, -v5
    v_fma_f32 v23, v23, s76, -v5
    v_fma_f32 v24, v24, s76, -v5
    v_fma_f32 v25, v25, s76, -v5
    v_fma_f32 v26, v26, s76, -v5
    v_fma_f32 v27, v27, s76, -v5
    v_exp_f32 v12, v12
    v_exp_f32 v13, v13
    v_exp_f32 v14, v14
    v_exp_f32 v15, v15
    v_exp_f32 v16, v16
    v_exp_f32 v17, v17
    v_exp_f32 v18, v18
    v_exp_f32 v19, v19
    v_exp_f32 v20, v20
    v_exp_f32 v21, v21
    v_exp_f32 v22, v22
    v_exp_f32 v23, v23
    v_exp_f32 v24, v24
    v_exp_f32 v25, v25
    v_exp_f32 v26, v26
    v_exp_f32 v27, v27
    v_pk_add_f32 v[32:33], v[12:13], v[14:15]
    v_pk_add_f32 v[34:35], v[16:17], v[18:19]
    v_pk_add_f32 v[36:37], v[20:21], v[22:23]
    v_pk_add_f32 v[38:39], v[24:25], v[26:27]
    v_cvt_pk_bf16_f32 v12, v12, v13
    v_cvt_pk_bf16_f32 v13, v14, v15
    v_cvt_pk_bf16_f32 v14, v16, v17
    v_cvt_pk_bf16_f32 v15, v18, v19
    v_cvt_pk_bf16_f32 v16, v20, v21
    v_cvt_pk_bf16_f32 v17, v22, v23
    v_cvt_pk_bf16_f32 v18, v24, v25
    v_cvt_pk_bf16_f32 v19, v26, v27
    v_pk_add_f32 v[32:33], v[32:33], v[34:35]
    v_pk_add_f32 v[32:33], v[32:33], v[36:37]
    v_pk_add_f32 v[32:33], v[32:33], v[38:39]
    v_add_f32 v6, v32, v33
    v_and_b32 v30, 3, v0
    v_lshlrev_b32 v30, 4, v30
    s_lshl_b32 s68, s3, 2
    v_add_u32 v30, s68, v30
    ds_write_b32 v30, v5 offset:10368
    v_add_f32_dpp v6, v6, v6 row_ror:4 row_mask:0xf bank_mask:0xf
    s_nop 1
    v_add_f32_dpp v6, v6, v6 row_ror:8 row_mask:0xf bank_mask:0xf
    v_mov_b32 v29, v6
    s_nop 1
    v_permlane16_swap_b32 v6, v29
    v_add_f32 v6, v6, v29
    v_mov_b32 v29, v6
    s_nop 1
    v_permlane32_swap_b32 v6, v29
    v_add_f32 v6, v6, v29
    ds_write_b32 v30, v6 offset:10432
    s_setpc_b64 s[86:87]
S_sm2:
    v_and_b32 v10, 3, v0
    v_lshlrev_b32 v10, 4, v10
    s_waitcnt lgkmcnt(0)
    s_barrier
    ds_read_b128 v[52:55], v10 offset:10368
    ds_read_b128 v[56:59], v10 offset:10432
    v_lshlrev_b32 v11, 3, v0
    s_add_u32 s68, s53, s61
    s_waitcnt lgkmcnt(1)
    v_max3_f32 v8, v52, v53, v54
    v_max_f32 v8, v8, v55
    v_sub_f32 v52, v52, v8
    v_sub_f32 v53, v53, v8
    v_sub_f32 v54, v54, v8
    v_sub_f32 v55, v55, v8
    v_exp_f32 v52, v52
    v_exp_f32 v53, v53
    v_exp_f32 v54, v54
    v_exp_f32 v55, v55
    s_waitcnt lgkmcnt(0)
    v_mul_f32 v9, v52, v56
    v_fmac_f32 v9, v53, v57
    v_fmac_f32 v9, v54, v58
    v_fmac_f32 v9, v55, v59
    v_rcp_f32 v7, v9
    v_min_u32 v8, -2, v8
    v_min_u32 v9, -2, v9
    v_mul_f32 v52, v52, v7
    v_mul_f32 v53, v53, v7
    v_mul_f32 v54, v54, v7
    v_mul_f32 v55, v55, v7
    v_readlane_b32 s28, v52, s3
    v_readlane_b32 s29, v53, s3
    v_readlane_b32 s30, v54, s3
    v_readlane_b32 s31, v55, s3
    s_cmp_lg_u32 s3, 0
    s_cbranch_scc1 L_skip_67
    s_mov_b64 exec, 0xffff
    s_cmp_eq_u32 s99, 0
    s_cbranch_scc1 L_sl_68
    buffer_store_dwordx2 v[8:9], v11, s[24:27], s68 offen
    s_branch L_sl_69
L_sl_68:
    buffer_store_dwordx2 v[8:9], v11, s[24:27], s68 offen sc1
L_sl_69:
    s_mov_b64 exec, -1
L_skip_67:
    s_setpc_b64 s[86:87]
NB_bar_0:
    s_mov_b32 s48, 32768
    buffer_load_dwordx4 v[108:111], v2, s[12:15], s48 offen offset:2048
    buffer_load_dwordx4 v[112:115], v2, s[12:15], s48 offen offset:3072
    s_add_u32 s65, s65, 1
    s_add_u32 s96, s96, 2
    s_add_u32 s88, s88, NB_bar_1-NB_bar_0
    s_addc_u32 s89, s89, 0
    s_mov_b32 s66, 1
    s_setpc_b64 s[90:91]
NB_bar_1:
    s_mov_b32 s48, 49152
    buffer_load_dwordx4 v[116:119], v2, s[12:15], s48 offen offset:0
    buffer_load_dwordx4 v[120:123], v2, s[12:15], s48 offen offset:1024
    s_add_u32 s65, s65, 1
    s_add_u32 s96, s96, 2
    s_add_u32 s88, s88, NB_bar_2-NB_bar_1
    s_addc_u32 s89, s89, 0
    s_mov_b32 s66, 1
    s_setpc_b64 s[90:91]
NB_bar_2:
    s_mov_b32 s48, 49152
    buffer_load_dwordx4 v[124:127], v2, s[12:15], s48 offen offset:2048
    buffer_load_dwordx4 v[128:131], v2, s[12:15], s48 offen offset:3072
    s_add_u32 s65, s65, 1
    s_add_u32 s96, s96, 2
    s_add_u32 s88, s88, NB_bar_3-NB_bar_2
    s_addc_u32 s89, s89, 0
    s_mov_b32 s66, 1
    s_setpc_b64 s[90:91]
NB_bar_3:
    s_mov_b32 s48, 65536
    buffer_load_dwordx4 v[132:135], v2, s[12:15], s48 offen offset:0
    buffer_load_dwordx4 v[136:139], v2, s[12:15], s48 offen offset:1024
    s_add_u32 s65, s65, 1
    s_add_u32 s96, s96, 2
    s_add_u32 s88, s88, NB_bar_4-NB_bar_3
    s_addc_u32 s89, s89, 0
    s_mov_b32 s66, 1
    s_setpc_b64 s[90:91]
NB_bar_4:
    s_mov_b32 s48, 65536
    buffer_load_dwordx4 v[140:143], v2, s[12:15], s48 offen offset:2048
    buffer_load_dwordx4 v[144:147], v2, s[12:15], s48 offen offset:3072
    s_add_u32 s65, s65, 1
    s_add_u32 s96, s96, 2
    s_add_u32 s88, s88, NB_bar_5-NB_bar_4
    s_addc_u32 s89, s89, 0
    s_mov_b32 s66, 1
    s_setpc_b64 s[90:91]
NB_bar_5:
    s_mov_b32 s48, 81920
    buffer_load_dwordx4 v[148:151], v2, s[12:15], s48 offen offset:0
    buffer_load_dwordx4 v[152:155], v2, s[12:15], s48 offen offset:1024
    s_add_u32 s65, s65, 1
    s_add_u32 s96, s96, 2
    s_add_u32 s88, s88, NB_bar_6-NB_bar_5
    s_addc_u32 s89, s89, 0
    s_mov_b32 s66, 1
    s_setpc_b64 s[90:91]
NB_bar_6:
    s_mov_b32 s48, 81920
    buffer_load_dwordx4 v[156:159], v2, s[12:15], s48 offen offset:2048
    buffer_load_dwordx4 v[160:163], v2, s[12:15], s48 offen offset:3072
    s_add_u32 s65, s65, 1
    s_add_u32 s96, s96, 2
    s_add_u32 s88, s88, NB_bar_7-NB_bar_6
    s_addc_u32 s89, s89, 0
    s_mov_b32 s66, 1
    s_setpc_b64 s[90:91]
NB_bar_7:
    s_mov_b32 s48, 98304
    buffer_load_dwordx4 v[164:167], v2, s[12:15], s48 offen offset:0
    buffer_load_dwordx4 v[168:171], v2, s[12:15], s48 offen offset:1024
    s_add_u32 s65, s65, 1
    s_add_u32 s96, s96, 2
    s_add_u32 s88, s88, NB_bar_8-NB_bar_7
    s_addc_u32 s89, s89, 0
    s_mov_b32 s66, 1
    s_setpc_b64 s[90:91]
NB_bar_8:
    s_mov_b32 s48, 98304
    buffer_load_dwordx4 v[172:175], v2, s[12:15], s48 offen offset:2048
    buffer_load_dwordx4 v[176:179], v2, s[12:15], s48 offen offset:3072
    s_add_u32 s65, s65, 1
    s_add_u32 s96, s96, 2
    s_add_u32 s88, s88, NB_bar_9-NB_bar_8
    s_addc_u32 s89, s89, 0
    s_mov_b32 s66, 1
    s_setpc_b64 s[90:91]
NB_bar_9:
    s_mov_b32 s48, 114688
    buffer_load_dwordx4 v[180:183], v2, s[12:15], s48 offen offset:0
    buffer_load_dwordx4 v[184:187], v2, s[12:15], s48 offen offset:1024
    s_add_u32 s65, s65, 1
    s_add_u32 s96, s96, 2
    s_add_u32 s88, s88, NB_bar_10-NB_bar_9
    s_addc_u32 s89, s89, 0
    s_mov_b32 s66, 1
    s_setpc_b64 s[90:91]
NB_bar_10:
    s_mov_b32 s66, 0
    s_mov_b32 s100, -2
    s_mov_b32 s101, -2
    s_mov_b32 s5, -2
    s_setpc_b64 s[90:91]
NB_pre_0:
    s_mov_b32 s66, 0
    s_mov_b32 s100, -2
    s_mov_b32 s101, -2
    s_mov_b32 s5, -2
    s_setpc_b64 s[90:91]
NB_g0_0:
    s_mov_b32 s48, 49152
    buffer_load_dwordx4 a[120:123], v1, s[16:19], s48 offen offset:2048
    buffer_load_dwordx4 a[124:127], v1, s[16:19], s48 offen offset:3072
    s_add_u32 s65, s65, 1
    s_add_u32 s96, s96, 2
    s_add_u32 s88, s88, NB_g0_1-NB_g0_0
    s_addc_u32 s89, s89, 0
    s_mov_b32 s66, 1
    s_setpc_b64 s[90:91]
NB_g0_1:
    s_mov_b32 s48, 65536
    buffer_load_dwordx4 a[128:131], v1, s[16:19], s48 offen offset:0
    buffer_load_dwordx4 a[132:135], v1, s[16:19], s48 offen offset:1024
    s_add_u32 s65, s65, 1
    s_add_u32 s96, s96, 2
    s_add_u32 s88, s88, NB_g0_2-NB_g0_1
    s_addc_u32 s89, s89, 0
    s_mov_b32 s66, 1
    s_setpc_b64 s[90:91]
NB_g0_2:
    s_mov_b32 s48, 65536
    buffer_load_dwordx4 a[136:139], v1, s[16:19], s48 offen offset:2048
    buffer_load_dwordx4 a[140:143], v1, s[16:19], s48 offen offset:3072
    s_add_u32 s65, s65, 1
    s_add_u32 s96, s96, 2
    s_add_u32 s88, s88, NB_g0_3-NB_g0_2
    s_addc_u32 s89, s89, 0
    s_mov_b32 s66, 1
    s_setpc_b64 s[90:91]
NB_g0_3:
    s_mov_b32 s48, 81920
    buffer_load_dwordx4 v[96:99], v1, s[16:19], s48 offen offset:0
    buffer_load_dwordx4 v[100:103], v1, s[16:19], s48 offen offset:1024
    s_add_u32 s65, s65, 1
    s_add_u32 s96, s96, 2
    s_add_u32 s88, s88, NB_g0_4-NB_g0_3
    s_addc_u32 s89, s89, 0
    s_mov_b32 s66, 1
    s_setpc_b64 s[90:91]
NB_g0_4:
    s_mov_b32 s48, 81920
    buffer_load_dwordx4 v[104:107], v1, s[16:19], s48 offen offset:2048
    buffer_load_dwordx4 v[108:111], v1, s[16:19], s48 offen offset:3072
    s_add_u32 s65, s65, 1
    s_add_u32 s96, s96, 2
    s_add_u32 s88, s88, NB_g0_5-NB_g0_4
    s_addc_u32 s89, s89, 0
    s_mov_b32 s66, 1
    s_setpc_b64 s[90:91]
NB_g0_5:
    s_mov_b32 s48, 98304
    buffer_load_dwordx4 v[112:115], v1, s[16:19], s48 offen offset:0
    buffer_load_dwordx4 v[116:119], v1, s[16:19], s48 offen offset:1024
    s_add_u32 s65, s65, 1
    s_add_u32 s96, s96, 2
    s_add_u32 s88, s88, NB_g0_6-NB_g0_5
    s_addc_u32 s89, s89, 0
    s_mov_b32 s66, 1
    s_setpc_b64 s[90:91]
NB_g0_6:
    s_mov_b32 s48, 98304
    buffer_load_dwordx4 v[120:123], v1, s[16:19], s48 offen offset:2048
    buffer_load_dwordx4 v[124:127], v1, s[16:19], s48 offen offset:3072
    s_add_u32 s65, s65, 1
    s_add_u32 s96, s96, 2
    s_add_u32 s88, s88, NB_g0_7-NB_g0_6
    s_addc_u32 s89, s89, 0
    s_mov_b32 s66, 1
    s_setpc_b64 s[90:91]
NB_g0_7:
    s_mov_b32 s48, 114688
    buffer_load_dwordx4 v[128:131], v1, s[16:19], s48 offen offset:0
    buffer_load_dwordx4 v[132:135], v1, s[16:19], s48 offen offset:1024
    s_add_u32 s65, s65, 1
    s_add_u32 s96, s96, 2
    s_add_u32 s88, s88, NB_g0_8-NB_g0_7
    s_addc_u32 s89, s89, 0
    s_mov_b32 s66, 1
    s_setpc_b64 s[90:91]
NB_g0_8:
    s_mov_b32 s48, 114688
    buffer_load_dwordx4 v[136:139], v1, s[16:19], s48 offen offset:2048
    buffer_load_dwordx4 v[140:143], v1, s[16:19], s48 offen offset:3072
    s_add_u32 s65, s65, 1
    s_add_u32 s96, s96, 2
    s_add_u32 s88, s88, NB_g0_9-NB_g0_8
    s_addc_u32 s89, s89, 0
    s_mov_b32 s66, 1
    s_setpc_b64 s[90:91]
NB_g0_9:
    s_mov_b32 s48, 131072
    buffer_load_dwordx4 v[144:147], v1, s[16:19], s48 offen offset:0
    buffer_load_dwordx4 v[148:151], v1, s[16:19], s48 offen offset:1024
    s_add_u32 s65, s65, 1
    s_add_u32 s96, s96, 2
    s_add_u32 s88, s88, NB_g0_10-NB_g0_9
    s_addc_u32 s89, s89, 0
    s_mov_b32 s66, 1
    s_setpc_b64 s[90:91]
NB_g0_10:
    s_mov_b32 s48, 131072
    buffer_load_dwordx4 v[152:155], v1, s[16:19], s48 offen offset:2048
    buffer_load_dwordx4 v[156:159], v1, s[16:19], s48 offen offset:3072
    s_add_u32 s65, s65, 1
    s_add_u32 s96, s96, 2
    s_add_u32 s88, s88, NB_g0_11-NB_g0_10
    s_addc_u32 s89, s89, 0
    s_mov_b32 s66, 1
    s_setpc_b64 s[90:91]
NB_g0_11:
    s_mov_b32 s48, 147456
    buffer_load_dwordx4 v[160:163], v1, s[16:19], s48 offen offset:0
    buffer_load_dwordx4 v[164:167], v1, s[16:19], s48 offen offset:1024 nt
    s_add_u32 s65, s65, 1
    s_add_u32 s96, s96, 2
    s_add_u32 s88, s88, NB_g0_12-NB_g0_11
    s_addc_u32 s89, s89, 0
    s_mov_b32 s66, 1
    s_setpc_b64 s[90:91]
NB_g0_12:
    s_mov_b32 s48, 147456
    buffer_load_dwordx4 v[168:171], v1, s[16:19], s48 offen offset:2048 nt
    buffer_load_dwordx4 v[172:175], v1, s[16:19], s48 offen offset:3072 nt
    s_add_u32 s65, s65, 1
    s_add_u32 s96, s96, 2
    s_add_u32 s88, s88, NB_g0_13-NB_g0_12
    s_addc_u32 s89, s89, 0
    s_mov_b32 s66, 1
    s_setpc_b64 s[90:91]
NB_g0_13:
    s_mov_b32 s48, 163840
    buffer_load_dwordx4 v[176:179], v1, s[16:19], s48 offen offset:0 nt
    buffer_load_dwordx4 v[180:183], v1, s[16:19], s48 offen offset:1024 nt
    s_add_u32 s65, s65, 1
    s_add_u32 s96, s96, 2
    s_add_u32 s88, s88, NB_g0_14-NB_g0_13
    s_addc_u32 s89, s89, 0
    s_mov_b32 s66, 1
    s_setpc_b64 s[90:91]
NB_g0_14:
    s_mov_b32 s48, 163840
    buffer_load_dwordx4 v[184:187], v1, s[16:19], s48 offen offset:2048 nt
    buffer_load_dwordx4 v[188:191], v1, s[16:19], s48 offen offset:3072 nt
    s_add_u32 s65, s65, 1
    s_add_u32 s96, s96, 2
    s_add_u32 s88, s88, NB_g0_15-NB_g0_14
    s_addc_u32 s89, s89, 0
    s_mov_b32 s66, 1
    s_setpc_b64 s[90:91]
NB_g0_15:
    s_mov_b32 s48, 180224
    buffer_load_dwordx4 v[192:195], v1, s[16:19], s48 offen offset:0 nt
    buffer_load_dwordx4 v[196:199], v1, s[16:19], s48 offen offset:1024 nt
    s_add_u32 s65, s65, 1
    s_add_u32 s96, s96, 2
    s_add_u32 s88, s88, NB_g0_16-NB_g0_15
    s_addc_u32 s89, s89, 0
    s_mov_b32 s66, 1
    s_setpc_b64 s[90:91]
NB_g0_16:
    s_mov_b32 s48, 180224
    buffer_load_dwordx4 v[200:203], v1, s[16:19], s48 offen offset:2048 nt
    buffer_load_dwordx4 v[204:207], v1, s[16:19], s48 offen offset:3072 nt
    s_add_u32 s65, s65, 1
    s_add_u32 s96, s96, 2
    s_add_u32 s88, s88, NB_g0_17-NB_g0_16
    s_addc_u32 s89, s89, 0
    s_mov_b32 s66, 1
    s_setpc_b64 s[90:91]
NB_g0_17:
    s_mov_b32 s48, 196608
    buffer_load_dwordx4 v[208:211], v1, s[16:19], s48 offen offset:0 nt
    buffer_load_dwordx4 v[212:215], v1, s[16:19], s48 offen offset:1024 nt
    s_add_u32 s65, s65, 1
    s_add_u32 s96, s96, 2
    s_add_u32 s88, s88, NB_g0_18-NB_g0_17
    s_addc_u32 s89, s89, 0
    s_mov_b32 s66, 1
    s_setpc_b64 s[90:91]
NB_g0_18:
    s_mov_b32 s48, 196608
    buffer_load_dwordx4 v[216:219], v1, s[16:19], s48 offen offset:2048 nt
    buffer_load_dwordx4 v[220:223], v1, s[16:19], s48 offen offset:3072 nt
    s_add_u32 s65, s65, 1
    s_add_u32 s96, s96, 2
    s_add_u32 s88, s88, NB_g0_19-NB_g0_18
    s_addc_u32 s89, s89, 0
    s_mov_b32 s66, 1
    s_setpc_b64 s[90:91]
NB_g0_19:
    s_mov_b32 s48, 212992
    buffer_load_dwordx4 v[224:227], v1, s[16:19], s48 offen offset:0 nt
    buffer_load_dwordx4 v[228:231], v1, s[16:19], s48 offen offset:1024 nt
    s_add_u32 s65, s65, 1
    s_add_u32 s96, s96, 2
    s_add_u32 s88, s88, NB_g0_20-NB_g0_19
    s_addc_u32 s89, s89, 0
    s_mov_b32 s66, 1
    s_setpc_b64 s[90:91]
NB_g0_20:
    s_mov_b32 s48, 212992
    buffer_load_dwordx4 v[232:235], v1, s[16:19], s48 offen offset:2048 nt
    buffer_load_dwordx4 v[236:239], v1, s[16:19], s48 offen offset:3072 nt
    s_add_u32 s65, s65, 1
    s_add_u32 s96, s96, 2
    s_add_u32 s88, s88, NB_g0_21-NB_g0_20
    s_addc_u32 s89, s89, 0
    s_mov_b32 s66, 1
    s_setpc_b64 s[90:91]
NB_g0_21:
    s_mov_b32 s48, 229376
    buffer_load_dwordx4 v[240:243], v1, s[16:19], s48 offen offset:0 nt
    buffer_load_dwordx4 v[244:247], v1, s[16:19], s48 offen offset:1024 nt
    s_add_u32 s65, s65, 1
    s_add_u32 s96, s96, 2
    s_add_u32 s88, s88, NB_g0_22-NB_g0_21
    s_addc_u32 s89, s89, 0
    s_mov_b32 s66, 1
    s_setpc_b64 s[90:91]
NB_g0_22:
    s_mov_b32 s48, 229376
    buffer_load_dwordx4 v[248:251], v1, s[16:19], s48 offen offset:2048 nt
    buffer_load_dwordx4 v[252:255], v1, s[16:19], s48 offen offset:3072 nt
    s_add_u32 s65, s65, 1
    s_add_u32 s96, s96, 2
    s_add_u32 s88, s88, NB_g0_23-NB_g0_22
    s_addc_u32 s89, s89, 0
    s_mov_b32 s66, 1
    s_setpc_b64 s[90:91]
NB_g0_23:
    v_lshlrev_b32 v7, 3, v2
    s_mov_b64 exec, 0xff
    s_mov_b32 s48, 245760
    buffer_load_dword v4, v7, s[16:19], s48 offen offset:0
    s_mov_b32 s48, 245760
    buffer_load_dword v4, v7, s[16:19], s48 offen offset:1024
    s_mov_b64 exec, -1
    s_add_u32 s65, s65, 1
    s_add_u32 s96, s96, 2
    s_add_u32 s88, s88, NB_g0_24-NB_g0_23
    s_addc_u32 s89, s89, 0
    s_mov_b32 s66, 1
    s_setpc_b64 s[90:91]
NB_g0_24:
    v_lshlrev_b32 v7, 3, v2
    s_mov_b64 exec, 0xff
    s_mov_b32 s48, 245760
    buffer_load_dword v4, v7, s[16:19], s48 offen offset:2048
    s_mov_b32 s48, 245760
    buffer_load_dword v4, v7, s[16:19], s48 offen offset:3072
    s_mov_b64 exec, -1
    s_add_u32 s65, s65, 1
    s_add_u32 s96, s96, 2
    s_add_u32 s88, s88, NB_g0_25-NB_g0_24
    s_addc_u32 s89, s89, 0
    s_mov_b32 s66, 1
    s_setpc_b64 s[90:91]
NB_g0_25:
    v_lshlrev_b32 v7, 3, v2
    s_mov_b64 exec, 0xff
    s_mov_b32 s48, 0
    buffer_load_dword v4, v7, s[20:23], s48 offen offset:0
    s_mov_b32 s48, 0
    buffer_load_dword v4, v7, s[20:23], s48 offen offset:1024
    s_mov_b64 exec, -1
    s_add_u32 s65, s65, 1
    s_add_u32 s96, s96, 2
    s_add_u32 s88, s88, NB_g0_26-NB_g0_25
    s_addc_u32 s89, s89, 0
    s_mov_b32 s66, 1
    s_setpc_b64 s[90:91]
NB_g0_26:
    v_lshlrev_b32 v7, 3, v2
    s_mov_b64 exec, 0xff
    s_mov_b32 s48, 0
    buffer_load_dword v4, v7, s[20:23], s48 offen offset:2048
    s_mov_b32 s48, 0
    buffer_load_dword v4, v7, s[20:23], s48 offen offset:3072
    s_mov_b64 exec, -1
    s_add_u32 s65, s65, 1
    s_add_u32 s96, s96, 2
    s_add_u32 s88, s88, NB_g0_27-NB_g0_26
    s_addc_u32 s89, s89, 0
    s_mov_b32 s66, 1
    s_setpc_b64 s[90:91]
NB_g0_27:
    v_lshlrev_b32 v7, 3, v2
    s_mov_b64 exec, 0xff
    s_mov_b32 s48, 16384
    buffer_load_dword v4, v7, s[20:23], s48 offen offset:0
    s_mov_b32 s48, 16384
    buffer_load_dword v4, v7, s[20:23], s48 offen offset:1024
    s_mov_b64 exec, -1
    s_add_u32 s65, s65, 1
    s_add_u32 s96, s96, 2
    s_add_u32 s88, s88, NB_g0_28-NB_g0_27
    s_addc_u32 s89, s89, 0
    s_mov_b32 s66, 1
    s_setpc_b64 s[90:91]
NB_g0_28:
    v_lshlrev_b32 v7, 3, v2
    s_mov_b64 exec, 0xff
    s_mov_b32 s48, 16384
    buffer_load_dword v4, v7, s[20:23], s48 offen offset:2048
    s_mov_b32 s48, 16384
    buffer_load_dword v4, v7, s[20:23], s48 offen offset:3072
    s_mov_b64 exec, -1
    s_add_u32 s65, s65, 1
    s_add_u32 s96, s96, 2
    s_add_u32 s88, s88, NB_g0_29-NB_g0_28
    s_addc_u32 s89, s89, 0
    s_mov_b32 s66, 1
    s_setpc_b64 s[90:91]
NB_g0_29:
    v_lshlrev_b32 v7, 3, v2
    s_mov_b64 exec, 0xff
    s_mov_b32 s48, 32768
    buffer_load_dword v4, v7, s[20:23], s48 offen offset:0
    s_mov_b32 s48, 32768
    buffer_load_dword v4, v7, s[20:23], s48 offen offset:1024
    s_mov_b64 exec, -1
    s_add_u32 s65, s65, 1
    s_add_u32 s96, s96, 2
    s_add_u32 s88, s88, NB_g0_30-NB_g0_29
    s_addc_u32 s89, s89, 0
    s_mov_b32 s66, 1
    s_setpc_b64 s[90:91]
NB_g0_30:
    v_lshlrev_b32 v7, 3, v2
    s_mov_b64 exec, 0xff
    s_mov_b32 s48, 32768
    buffer_load_dword v4, v7, s[20:23], s48 offen offset:2048
    s_mov_b32 s48, 32768
    buffer_load_dword v4, v7, s[20:23], s48 offen offset:3072
    s_mov_b64 exec, -1
    s_add_u32 s65, s65, 1
    s_add_u32 s96, s96, 2
    s_add_u32 s88, s88, NB_g0_31-NB_g0_30
    s_addc_u32 s89, s89, 0
    s_mov_b32 s66, 1
    s_setpc_b64 s[90:91]
NB_g0_31:
    v_lshlrev_b32 v7, 3, v2
    s_mov_b64 exec, 0xff
    s_mov_b32 s48, 49152
    buffer_load_dword v4, v7, s[20:23], s48 offen offset:0
    s_mov_b32 s48, 49152
    buffer_load_dword v4, v7, s[20:23], s48 offen offset:1024
    s_mov_b64 exec, -1
    s_add_u32 s65, s65, 1
    s_add_u32 s96, s96, 2
    s_add_u32 s88, s88, NB_g0_32-NB_g0_31
    s_addc_u32 s89, s89, 0
    s_mov_b32 s66, 1
    s_setpc_b64 s[90:91]
NB_g0_32:
    v_lshlrev_b32 v7, 3, v2
    s_mov_b64 exec, 0xff
    s_mov_b32 s48, 49152
    buffer_load_dword v4, v7, s[20:23], s48 offen offset:2048
    s_mov_b32 s48, 49152
    buffer_load_dword v4, v7, s[20:23], s48 offen offset:3072
    s_mov_b64 exec, -1
    s_add_u32 s65, s65, 1
    s_add_u32 s96, s96, 2
    s_add_u32 s88, s88, NB_g0_33-NB_g0_32
    s_addc_u32 s89, s89, 0
    s_mov_b32 s66, 1
    s_setpc_b64 s[90:91]
NB_g0_33:
    v_lshlrev_b32 v7, 3, v2
    s_mov_b64 exec, 0xff
    s_mov_b32 s48, 65536
    buffer_load_dword v4, v7, s[20:23], s48 offen offset:0
    s_mov_b32 s48, 65536
    buffer_load_dword v4, v7, s[20:23], s48 offen offset:1024
    s_mov_b64 exec, -1
    s_add_u32 s65, s65, 1
    s_add_u32 s96, s96, 2
    s_add_u32 s88, s88, NB_g0_34-NB_g0_33
    s_addc_u32 s89, s89, 0
    s_mov_b32 s66, 1
    s_setpc_b64 s[90:91]
NB_g0_34:
    v_lshlrev_b32 v7, 3, v2
    s_mov_b64 exec, 0xff
    s_mov_b32 s48, 65536
    buffer_load_dword v4, v7, s[20:23], s48 offen offset:2048
    s_mov_b32 s48, 65536
    buffer_load_dword v4, v7, s[20:23], s48 offen offset:3072
    s_mov_b64 exec, -1
    s_add_u32 s65, s65, 1
    s_add_u32 s96, s96, 2
    s_add_u32 s88, s88, NB_g0_35-NB_g0_34
    s_addc_u32 s89, s89, 0
    s_mov_b32 s66, 1
    s_setpc_b64 s[90:91]
NB_g0_35:
    v_lshlrev_b32 v7, 3, v2
    s_mov_b64 exec, 0xff
    s_mov_b32 s48, 81920
    buffer_load_dword v4, v7, s[20:23], s48 offen offset:0
    s_mov_b32 s48, 81920
    buffer_load_dword v4, v7, s[20:23], s48 offen offset:1024
    s_mov_b64 exec, -1
    s_add_u32 s65, s65, 1
    s_add_u32 s96, s96, 2
    s_add_u32 s88, s88, NB_g0_36-NB_g0_35
    s_addc_u32 s89, s89, 0
    s_mov_b32 s66, 1
    s_setpc_b64 s[90:91]
NB_g0_36:
    v_lshlrev_b32 v7, 3, v2
    s_mov_b64 exec, 0xff
    s_mov_b32 s48, 81920
    buffer_load_dword v4, v7, s[20:23], s48 offen offset:2048
    s_mov_b32 s48, 81920
    buffer_load_dword v4, v7, s[20:23], s48 offen offset:3072
    s_mov_b64 exec, -1
    s_add_u32 s65, s65, 1
    s_add_u32 s96, s96, 2
    s_add_u32 s88, s88, NB_g0_37-NB_g0_36
    s_addc_u32 s89, s89, 0
    s_mov_b32 s66, 1
    s_setpc_b64 s[90:91]
NB_g0_37:
    v_lshlrev_b32 v7, 3, v2
    s_mov_b64 exec, 0xff
    s_mov_b32 s48, 98304
    buffer_load_dword v4, v7, s[20:23], s48 offen offset:0
    s_mov_b32 s48, 98304
    buffer_load_dword v4, v7, s[20:23], s48 offen offset:1024
    s_mov_b64 exec, -1
    s_add_u32 s65, s65, 1
    s_add_u32 s96, s96, 2
    s_add_u32 s88, s88, NB_g0_38-NB_g0_37
    s_addc_u32 s89, s89, 0
    s_mov_b32 s66, 1
    s_setpc_b64 s[90:91]
NB_g0_38:
    v_lshlrev_b32 v7, 3, v2
    s_mov_b64 exec, 0xff
    s_mov_b32 s48, 98304
    buffer_load_dword v4, v7, s[20:23], s48 offen offset:2048
    s_mov_b32 s48, 98304
    buffer_load_dword v4, v7, s[20:23], s48 offen offset:3072
    s_mov_b64 exec, -1
    s_add_u32 s65, s65, 1
    s_add_u32 s96, s96, 2
    s_add_u32 s88, s88, NB_g0_39-NB_g0_38
    s_addc_u32 s89, s89, 0
    s_mov_b32 s66, 1
    s_setpc_b64 s[90:91]
NB_g0_39:
    s_mov_b32 s66, 0
    s_mov_b32 s100, -2
    s_mov_b32 s101, -2
    s_mov_b32 s5, -2
    s_setpc_b64 s[90:91]
NB_g1_0:
    s_mov_b32 s48, 0
    buffer_load_dwordx4 v[104:107], v2, s[12:15], s48 offen offset:0 nt
    buffer_load_dwordx4 v[108:111], v2, s[12:15], s48 offen offset:1024 nt
    s_add_u32 s65, s65, 1
    s_add_u32 s96, s96, 2
    s_add_u32 s88, s88, NB_g1_1-NB_g1_0
    s_addc_u32 s89, s89, 0
    s_mov_b32 s66, 1
    s_setpc_b64 s[90:91]
NB_g1_1:
    s_mov_b32 s48, 0
    buffer_load_dwordx4 v[112:115], v2, s[12:15], s48 offen offset:2048 nt
    buffer_load_dwordx4 v[116:119], v2, s[12:15], s48 offen offset:3072 nt
    s_add_u32 s65, s65, 1
    s_add_u32 s96, s96, 2
    s_add_u32 s88, s88, NB_g1_2-NB_g1_1
    s_addc_u32 s89, s89, 0
    s_mov_b32 s66, 1
    s_setpc_b64 s[90:91]
NB_g1_2:
    s_mov_b32 s48, 16384
    buffer_load_dwordx4 v[120:123], v2, s[12:15], s48 offen offset:0 nt
    buffer_load_dwordx4 v[124:127], v2, s[12:15], s48 offen offset:1024 nt
    s_add_u32 s65, s65, 1
    s_add_u32 s96, s96, 2
    s_add_u32 s88, s88, NB_g1_3-NB_g1_2
    s_addc_u32 s89, s89, 0
    s_mov_b32 s66, 1
    s_setpc_b64 s[90:91]
NB_g1_3:
    s_mov_b32 s48, 16384
    buffer_load_dwordx4 v[128:131], v2, s[12:15], s48 offen offset:2048 nt
    buffer_load_dwordx4 a[124:127], v2, s[12:15], s48 offen offset:3072 nt
    s_add_u32 s65, s65, 1
    s_add_u32 s96, s96, 2
    s_add_u32 s88, s88, NB_g1_4-NB_g1_3
    s_addc_u32 s89, s89, 0
    s_mov_b32 s66, 1
    s_setpc_b64 s[90:91]
NB_g1_4:
    v_lshlrev_b32 v7, 3, v2
    s_mov_b64 exec, 0xff
    s_mov_b32 s48, 32768
    buffer_load_dword v4, v7, s[12:15], s48 offen offset:0
    s_mov_b32 s48, 32768
    buffer_load_dword v4, v7, s[12:15], s48 offen offset:1024
    s_mov_b64 exec, -1
    s_add_u32 s65, s65, 1
    s_add_u32 s96, s96, 2
    s_add_u32 s88, s88, NB_g1_5-NB_g1_4
    s_addc_u32 s89, s89, 0
    s_mov_b32 s66, 1
    s_setpc_b64 s[90:91]
NB_g1_5:
    v_lshlrev_b32 v7, 3, v2
    s_mov_b64 exec, 0xff
    s_mov_b32 s48, 32768
    buffer_load_dword v4, v7, s[12:15], s48 offen offset:2048
    s_mov_b32 s48, 32768
    buffer_load_dword v4, v7, s[12:15], s48 offen offset:3072
    s_mov_b64 exec, -1
    s_add_u32 s65, s65, 1
    s_add_u32 s96, s96, 2
    s_add_u32 s88, s88, NB_g1_6-NB_g1_5
    s_addc_u32 s89, s89, 0
    s_mov_b32 s66, 1
    s_setpc_b64 s[90:91]
NB_g1_6:
    v_lshlrev_b32 v7, 3, v2
    s_mov_b64 exec, 0xff
    s_mov_b32 s48, 49152
    buffer_load_dword v4, v7, s[12:15], s48 offen offset:0
    s_mov_b32 s48, 49152
    buffer_load_dword v4, v7, s[12:15], s48 offen offset:1024
    s_mov_b64 exec, -1
    s_add_u32 s65, s65, 1
    s_add_u32 s96, s96, 2
    s_add_u32 s88, s88, NB_g1_7-NB_g1_6
    s_addc_u32 s89, s89, 0
    s_mov_b32 s66, 1
    s_setpc_b64 s[90:91]
NB_g1_7:
    v_lshlrev_b32 v7, 3, v2
    s_mov_b64 exec, 0xff
    s_mov_b32 s48, 49152
    buffer_load_dword v4, v7, s[12:15], s48 offen offset:2048
    s_mov_b32 s48, 49152
    buffer_load_dword v4, v7, s[12:15], s48 offen offset:3072
    s_mov_b64 exec, -1
    s_add_u32 s65, s65, 1
    s_add_u32 s96, s96, 2
    s_add_u32 s88, s88, NB_g1_8-NB_g1_7
    s_addc_u32 s89, s89, 0
    s_mov_b32 s66, 1
    s_setpc_b64 s[90:91]
NB_g1_8:
    s_mov_b32 s66, 0
    s_mov_b32 s100, -2
    s_mov_b32 s101, -2
    s_mov_b32 s5, -2
    s_setpc_b64 s[90:91]
NB_g2_0:
    s_mov_b32 s48, 65536
    s_add_u32 m0, s77, 20480
    s_nop 0
    buffer_load_dwordx4 v1, s[16:19], s48 offen offset:0 nt lds
    s_add_u32 m0, s77, 20480
    s_nop 0
    buffer_load_dwordx4 v1, s[16:19], s48 offen offset:1024 nt lds
    s_add_u32 s65, s65, 1
    s_add_u32 s96, s96, 2
    s_add_u32 s88, s88, NB_g2_1-NB_g2_0
    s_addc_u32 s89, s89, 0
    s_mov_b32 s66, 1
    s_setpc_b64 s[90:91]
NB_g2_1:
    s_mov_b32 s48, 65536
    s_add_u32 m0, s77, 20480
    s_nop 0
    buffer_load_dwordx4 v1, s[16:19], s48 offen offset:2048 nt lds
    s_add_u32 m0, s77, 20480
    s_nop 0
    buffer_load_dwordx4 v1, s[16:19], s48 offen offset:3072 nt lds
    s_add_u32 s65, s65, 1
    s_add_u32 s96, s96, 2
    s_add_u32 s88, s88, NB_g2_2-NB_g2_1
    s_addc_u32 s89, s89, 0
    s_mov_b32 s66, 1
    s_setpc_b64 s[90:91]
NB_g2_2:
    s_mov_b32 s48, 81920
    s_add_u32 m0, s77, 24576
    s_nop 0
    buffer_load_dwordx4 v1, s[16:19], s48 offen offset:0 nt lds
    s_add_u32 m0, s77, 24576
    s_nop 0
    buffer_load_dwordx4 v1, s[16:19], s48 offen offset:1024 nt lds
    s_add_u32 s65, s65, 1
    s_add_u32 s96, s96, 2
    s_add_u32 s88, s88, NB_g2_3-NB_g2_2
    s_addc_u32 s89, s89, 0
    s_mov_b32 s66, 1
    s_setpc_b64 s[90:91]
NB_g2_3:
    s_mov_b32 s48, 81920
    s_add_u32 m0, s77, 24576
    s_nop 0
    buffer_load_dwordx4 v1, s[16:19], s48 offen offset:2048 nt lds
    s_add_u32 m0, s77, 24576
    s_nop 0
    buffer_load_dwordx4 v1, s[16:19], s48 offen offset:3072 nt lds
    s_add_u32 s65, s65, 1
    s_add_u32 s96, s96, 2
    s_add_u32 s88, s88, NB_g2_4-NB_g2_3
    s_addc_u32 s89, s89, 0
    s_mov_b32 s66, 1
    s_setpc_b64 s[90:91]
NB_g2_4:
    s_mov_b32 s48, 98304
    s_add_u32 m0, s77, 28672
    s_nop 0
    buffer_load_dwordx4 v1, s[16:19], s48 offen offset:0 nt lds
    s_add_u32 m0, s77, 28672
    s_nop 0
    buffer_load_dwordx4 v1, s[16:19], s48 offen offset:1024 nt lds
    s_add_u32 s65, s65, 1
    s_add_u32 s96, s96, 2
    s_add_u32 s88, s88, NB_g2_5-NB_g2_4
    s_addc_u32 s89, s89, 0
    s_mov_b32 s66, 1
    s_setpc_b64 s[90:91]
NB_g2_5:
    s_mov_b32 s48, 98304
    s_add_u32 m0, s77, 28672
    s_nop 0
    buffer_load_dwordx4 v1, s[16:19], s48 offen offset:2048 nt lds
    s_add_u32 m0, s77, 28672
    s_nop 0
    buffer_load_dwordx4 v1, s[16:19], s48 offen offset:3072 nt lds
    s_add_u32 s65, s65, 1
    s_add_u32 s96, s96, 2
    s_add_u32 s88, s88, NB_g2_6-NB_g2_5
    s_addc_u32 s89, s89, 0
    s_mov_b32 s66, 1
    s_setpc_b64 s[90:91]
NB_g2_6:
    s_mov_b32 s48, 114688
    s_add_u32 m0, s77, 32768
    s_nop 0
    buffer_load_dwordx4 v1, s[16:19], s48 offen offset:0 nt lds
    s_add_u32 m0, s77, 32768
    s_nop 0
    buffer_load_dwordx4 v1, s[16:19], s48 offen offset:1024 nt lds
    s_add_u32 s65, s65, 1
    s_add_u32 s96, s96, 2
    s_add_u32 s88, s88, NB_g2_7-NB_g2_6
    s_addc_u32 s89, s89, 0
    s_mov_b32 s66, 1
    s_setpc_b64 s[90:91]
NB_g2_7:
    s_mov_b32 s48, 114688
    s_add_u32 m0, s77, 32768
    s_nop 0
    buffer_load_dwordx4 v1, s[16:19], s48 offen offset:2048 nt lds
    s_add_u32 m0, s77, 32768
    s_nop 0
    buffer_load_dwordx4 v1, s[16:19], s48 offen offset:3072 nt lds
    s_add_u32 s65, s65, 1
    s_add_u32 s96, s96, 2
    s_add_u32 s88, s88, NB_g2_8-NB_g2_7
    s_addc_u32 s89, s89, 0
    s_mov_b32 s66, 1
    s_setpc_b64 s[90:91]
NB_g2_8:
    s_mov_b32 s48, 131072
    s_add_u32 m0, s77, 36864
    s_nop 0
    buffer_load_dwordx4 v1, s[16:19], s48 offen offset:0 nt lds
    s_add_u32 m0, s77, 36864
    s_nop 0
    buffer_load_dwordx4 v1, s[16:19], s48 offen offset:1024 nt lds
    s_add_u32 s65, s65, 1
    s_add_u32 s96, s96, 2
    s_add_u32 s88, s88, NB_g2_9-NB_g2_8
    s_addc_u32 s89, s89, 0
    s_mov_b32 s66, 1
    s_setpc_b64 s[90:91]
NB_g2_9:
    s_mov_b32 s48, 131072
    s_add_u32 m0, s77, 36864
    s_nop 0
    buffer_load_dwordx4 v1, s[16:19], s48 offen offset:2048 nt lds
    s_add_u32 m0, s77, 36864
    s_nop 0
    buffer_load_dwordx4 v1, s[16:19], s48 offen offset:3072 nt lds
    s_add_u32 s65, s65, 1
    s_add_u32 s96, s96, 2
    s_add_u32 s88, s88, NB_g2_10-NB_g2_9
    s_addc_u32 s89, s89, 0
    s_mov_b32 s66, 1
    s_setpc_b64 s[90:91]
NB_g2_10:
    s_mov_b32 s48, 147456
    s_add_u32 m0, s77, 40960
    s_nop 0
    buffer_load_dwordx4 v1, s[16:19], s48 offen offset:0 nt lds
    s_mov_b32 s48, 0
    buffer_load_dwordx4 v[68:71], v2, s[20:23], s48 offen offset:0 nt
    s_add_u32 s65, s65, 1
    s_add_u32 s96, s96, 2
    s_add_u32 s88, s88, NB_g2_11-NB_g2_10
    s_addc_u32 s89, s89, 0
    s_mov_b32 s66, 1
    s_setpc_b64 s[90:91]
NB_g2_11:
    s_mov_b32 s48, 0
    buffer_load_dwordx4 v[72:75], v2, s[20:23], s48 offen offset:1024 nt
    buffer_load_dwordx4 v[76:79], v2, s[20:23], s48 offen offset:2048 nt
    s_add_u32 s65, s65, 1
    s_add_u32 s96, s96, 2
    s_add_u32 s88, s88, NB_g2_12-NB_g2_11
    s_addc_u32 s89, s89, 0
    s_mov_b32 s66, 1
    s_setpc_b64 s[90:91]
NB_g2_12:
    s_mov_b32 s48, 0
    buffer_load_dwordx4 v[80:83], v2, s[20:23], s48 offen offset:3072 nt
    s_mov_b32 s48, 16384
    buffer_load_dwordx4 v[84:87], v2, s[20:23], s48 offen offset:0 nt
    s_add_u32 s65, s65, 1
    s_add_u32 s96, s96, 2
    s_add_u32 s88, s88, NB_g2_13-NB_g2_12
    s_addc_u32 s89, s89, 0
    s_mov_b32 s66, 1
    s_setpc_b64 s[90:91]
NB_g2_13:
    s_mov_b32 s48, 16384
    buffer_load_dwordx4 v[88:91], v2, s[20:23], s48 offen offset:1024 nt
    buffer_load_dwordx4 v[92:95], v2, s[20:23], s48 offen offset:2048 nt
    s_add_u32 s65, s65, 1
    s_add_u32 s96, s96, 2
    s_add_u32 s88, s88, NB_g2_14-NB_g2_13
    s_addc_u32 s89, s89, 0
    s_mov_b32 s66, 1
    s_setpc_b64 s[90:91]
NB_g2_14:
    s_mov_b32 s48, 16384
    buffer_load_dwordx4 v[104:107], v2, s[20:23], s48 offen offset:3072 nt
    s_mov_b32 s48, 32768
    buffer_load_dwordx4 v[108:111], v2, s[20:23], s48 offen offset:0 nt
    s_add_u32 s65, s65, 1
    s_add_u32 s96, s96, 2
    s_add_u32 s88, s88, NB_g2_15-NB_g2_14
    s_addc_u32 s89, s89, 0
    s_mov_b32 s66, 1
    s_setpc_b64 s[90:91]
NB_g2_15:
    s_mov_b32 s48, 32768
    buffer_load_dwordx4 v[112:115], v2, s[20:23], s48 offen offset:1024 nt
    buffer_load_dwordx4 v[116:119], v2, s[20:23], s48 offen offset:2048 nt
    s_add_u32 s65, s65, 1
    s_add_u32 s96, s96, 2
    s_add_u32 s88, s88, NB_g2_16-NB_g2_15
    s_addc_u32 s89, s89, 0
    s_mov_b32 s66, 1
    s_setpc_b64 s[90:91]
NB_g2_16:
    s_mov_b32 s48, 32768
    buffer_load_dwordx4 v[120:123], v2, s[20:23], s48 offen offset:3072 nt
    s_mov_b32 s48, 49152
    buffer_load_dwordx4 v[124:127], v2, s[20:23], s48 offen offset:0 nt
    s_add_u32 s65, s65, 1
    s_add_u32 s96, s96, 2
    s_add_u32 s88, s88, NB_g2_17-NB_g2_16
    s_addc_u32 s89, s89, 0
    s_mov_b32 s66, 1
    s_setpc_b64 s[90:91]
NB_g2_17:
    s_mov_b32 s48, 49152
    buffer_load_dwordx4 v[128:131], v2, s[20:23], s48 offen offset:1024 nt
    buffer_load_dwordx4 a[12:15], v2, s[20:23], s48 offen offset:2048 nt
    s_add_u32 s65, s65, 1
    s_add_u32 s96, s96, 2
    s_add_u32 s88, s88, NB_g2_18-NB_g2_17
    s_addc_u32 s89, s89, 0
    s_mov_b32 s66, 1
    s_setpc_b64 s[90:91]
NB_g2_18:
    s_mov_b32 s48, 49152
    buffer_load_dwordx4 a[16:19], v2, s[20:23], s48 offen offset:3072 nt
    s_mov_b32 s48, 65536
    buffer_load_dwordx4 a[20:23], v2, s[20:23], s48 offen offset:0 nt
    s_add_u32 s65, s65, 1
    s_add_u32 s96, s96, 2
    s_add_u32 s88, s88, NB_g2_19-NB_g2_18
    s_addc_u32 s89, s89, 0
    s_mov_b32 s66, 1
    s_setpc_b64 s[90:91]
NB_g2_19:
    s_mov_b32 s66, 0
    s_mov_b32 s100, -2
    s_mov_b32 s101, -2
    s_mov_b32 s5, -2
    s_setpc_b64 s[90:91]
NB_g3_0:
    s_mov_b32 s66, 0
    s_mov_b32 s100, -2
    s_mov_b32 s101, -2
    s_mov_b32 s5, -2
    s_setpc_b64 s[90:91]
.section .rodata,"a"
.p2align 6
.amdhsa_kernel interleave_layers__gqa_block_cached__gqa_block_cached__decode_kernel
  .amdhsa_next_free_vgpr 512
  .amdhsa_next_free_sgpr 102
  .amdhsa_accum_offset 256
  .amdhsa_group_segment_fixed_size 0
  .amdhsa_kernarg_size 104
  .amdhsa_user_sgpr_count 2
  .amdhsa_user_sgpr_kernarg_segment_ptr 1
  .amdhsa_system_sgpr_workgroup_id_x 1
  .amdhsa_float_denorm_mode_32 3
.end_amdhsa_kernel
```
